```python
import torch

def _softmax(x, axis=-1):
    return torch.softmax(x, dim=axis)

def _gelu(x):
    return torch.nn.functional.gelu(x, approximate='tanh')

def _silu(x):
    return torch.nn.functional.silu(x)

def _sigmoid(x):
    return torch.sigmoid(x)

def _layernorm(x, axis=-1, eps=1e-05):
    m = x.mean(dim=axis, keepdim=True)
    v = x.var(dim=axis, keepdim=True, unbiased=False)
    return (x - m) / torch.sqrt(v + eps)

def _scatter_add(tgt, idx, src, axis=0):
    return tgt.clone().index_add_(axis, idx, src)

def _segment_sum(src, seg, n):
    out = torch.zeros((n,) + src.shape[1:], dtype=src.dtype)
    return out.index_add_(0, seg, src)

def _pad(x, pw):
    flat = tuple((v for pair in reversed(pw) for v in pair))
    return torch.nn.functional.pad(x, flat)
kernel_name = 'recurrent_scan__ssm_conv_s4d__mixer_gmlp__prompt'

def setup_inputs():

    _w = lambda a: (lambda t: t.to(torch.bfloat16) if t.is_floating_point() else t)(torch.as_tensor(a))

    def _A_setup():
        Bsz, L, D, N = (1, 2048, 448, 256)
        return {'u': _w((lambda *s: torch.randn(*s, dtype=torch.bfloat16) * 0.05)(Bsz, L, D)), 'log_A_real': _w((lambda *s: torch.randn(*s, dtype=torch.bfloat16) * 6.4)(D, N) * 0.5), 'A_imag': _w((lambda *s: torch.randn(*s, dtype=torch.bfloat16) * 0.05)(D, N) * 3.14), 'C_real': _w((lambda *s: torch.randn(*s, dtype=torch.bfloat16) * 0.05)(D, N) / N ** 0.5), 'C_imag': _w((lambda *s: torch.randn(*s, dtype=torch.bfloat16) * 0.05)(D, N) / N ** 0.5), 'log_dt': _w((lambda *s: torch.randn(*s, dtype=torch.bfloat16) * 0.05)(D) * 0.5 - 4.0), 'D_skip': _w((lambda *s: torch.randn(*s, dtype=torch.bfloat16) * 0.05)(D))}
    _A_in = _A_setup()

    def _B_setup():
        B, S, D, F = (1, 2048, 448, 1792)
        Fh = F // 2
        return {'x': _w((lambda *s: torch.randn(*s, dtype=torch.bfloat16) * 0.05)(B, S, D)), 'w_in': _w((lambda *s: torch.randn(*s, dtype=torch.bfloat16) * 0.4)(D, 2 * Fh)), 'w_sp': _w(0.01 * (lambda *s: torch.randn(*s, dtype=torch.bfloat16) * 0.4)(S, S)), 'b_sp': _w(1.0 + 0.01 * (lambda *s: torch.randn(*s, dtype=torch.bfloat16) * 0.05)(S)), 'w_out': _w((lambda *s: torch.randn(*s, dtype=torch.bfloat16) * 0.05)(Fh, D))}
    _B_in = _B_setup()
    return {'A_u': _A_in['u'], 'A_log_A_real': _A_in['log_A_real'], 'A_A_imag': _A_in['A_imag'], 'A_C_real': _A_in['C_real'], 'A_C_imag': _A_in['C_imag'], 'A_log_dt': _A_in['log_dt'], 'A_D_skip': _A_in['D_skip'], 'B_x': _B_in['x'], 'B_w_in': _B_in['w_in'], 'B_w_sp': _B_in['w_sp'], 'B_b_sp': _B_in['b_sp'], 'B_w_out': _B_in['w_out']}

def reference(A_u, A_log_A_real, A_A_imag, A_C_real, A_C_imag, A_log_dt, A_D_skip, B_x, B_w_in, B_w_sp, B_b_sp, B_w_out):

    def _A_ref(u, log_A_real, A_imag, C_real, C_imag, log_dt, D_skip):
        L = u.shape[1]
        dt = torch.exp(log_dt)
        A = -torch.exp(log_A_real) + 1j * A_imag
        C = (C_real + 1j * C_imag) * dt[:, None]
        pos = (lambda x, dt: x.to(dt))(torch.arange(L), log_dt.dtype)
        P = torch.exp((A * dt[:, None])[:, :, None] * pos[None, None, :])
        K = 2.0 * torch.einsum('dn,dnl->dl', C, P).real
        L2 = 2 * L
        u_t = (lambda x, *d: x.permute(*d))(u, 0, 2, 1)
        Kf = (lambda x, *a, **k: torch.fft.rfft(x.float(), *a, **k))(K, L2)
        Uf = (lambda x, *a, **k: torch.fft.rfft(x.float(), *a, **k))(u_t, L2)
        y = (lambda x, *a, **k: torch.fft.irfft(x, *a, **k).to(torch.bfloat16))(Uf * Kf[None, :, :], L2)[:, :, :L]
        y = (lambda x, *d: x.permute(*d))(y, 0, 2, 1)
        return y + u * D_skip[None, None, :]

    def _B_ref(x, w_in, w_sp, b_sp, w_out):
        B, S, D = x.shape
        F = w_in.shape[-1]
        Fh = F // 2
        z = _gelu(torch.einsum('bsd,df->bsf', x, w_in))
        z1 = z[..., :Fh].clone()
        z2 = _layernorm(z[..., Fh:], axis=-1)
        g = torch.einsum('ts,bsf->btf', w_sp, z2) + b_sp[None, :, None]
        return torch.einsum('bsf,fd->bsd', z1 * g, w_out)
    x = A_u
    xn = _layernorm(x, axis=-1)
    s = _A_ref(xn, A_log_A_real, A_A_imag, A_C_real, A_C_imag, A_log_dt, A_D_skip)
    g = _silu(_B_ref(xn, B_w_in, B_w_sp, B_b_sp, B_w_out))
    return x + s * g
```

```asm
; @launch grid=(480,1,1) block=(256,1,1) lds=81920
.amdgcn_target "amdgcn-amd-amdhsa--gfx950"
.text
.globl recurrent_scan__ssm_conv_s4d__mixer_gmlp__prompt_kernel
.p2align 8
.type recurrent_scan__ssm_conv_s4d__mixer_gmlp__prompt_kernel,@function
recurrent_scan__ssm_conv_s4d__mixer_gmlp__prompt_kernel:
    s_cmp_ge_u32 s2, 480
    s_cbranch_scc1 L_end
    s_cmp_ge_u32 s2, 256
    s_cbranch_scc1 L_side
    s_load_dwordx2 s[4:5], s[0:1], 0
    s_load_dwordx2 s[6:7], s[0:1], 64
    s_load_dwordx2 s[14:15], s[0:1], 112
    s_load_dwordx4 s[8:11], s[0:1], 72
    s_load_dwordx2 s[12:13], s[0:1], 96
    s_getpc_b64 s[98:99]
L_pc:
    s_lshr_b32 s3, s2, 3
    s_and_b32 s3, s3, 31
    s_lshl_b32 s3, s3, 12
    v_and_b32 v219, 31, v0
    v_lshlrev_b32 v219, 7, v219
    v_add_u32 v219, s3, v219
    v_min_u32 v219, L_last-L_pc, v219
    v_cmp_gt_u32 vcc, 32, v0
    s_nop 0
    s_and_saveexec_b64 s[100:101], vcc
    s_cbranch_execz L_nopf
    global_load_dword v219, v219, s[98:99]
L_nopf:
    s_mov_b64 exec, -1
    s_setprio 2
    v_lshrrev_b32 v24, 6, v0
    v_and_b32 v32, 63, v0
    v_readfirstlane_b32 s38, v24
    v_and_b32 v2, 15, v0
    v_lshrrev_b32 v3, 4, v32
    v_lshlrev_b32 v1, 4, v32
    s_and_b32 s46, s2, 7
    s_lshr_b32 s47, s2, 5
    s_lshr_b32 s50, s46, 1
    s_lshl_b32 s39, s50, 3
    s_add_u32 s39, s39, s47
    s_and_b32 s51, s46, 1
    s_lshl_b32 s40, s51, 2
    s_bfe_u32 s48, s2, 0x20003
    s_add_u32 s40, s40, s48
    s_and_b32 s48, s47, 1
    s_sub_u32 s45, s40, s48
    s_lshl_b32 s48, s45, 1
    s_add_u32 s48, s48, s47
    s_add_u32 s48, s48, 2
    s_mul_i32 s49, s48, 37
    s_lshr_b32 s49, s49, 8
    s_mul_i32 s49, s49, 7
    s_sub_u32 s48, s48, s49
    s_lshl_b32 s56, s48, 7
    s_mul_i32 s57, s48, 229376
    v_lshrrev_b32 v24, 3, v32
    v_and_b32 v25, 3, v24
    v_xor_b32 v25, v25, v0
    v_and_b32 v25, 7, v25
    v_lshlrev_b32 v25, 4, v25
    v_mul_u32_u24 v4, 896, v24
    s_lshl_b32 s48, s39, 2
    s_add_u32 s48, s48, s38
    s_mul_i32 s48, s48, 14336
    v_add3_u32 v4, v4, v25, s48
    v_xor_b32 v5, 64, v4
    v_add_u32 v5, 6144, v5
    s_and_b32 s41, s38, 1
    s_lshr_b32 s42, s38, 1
    s_lshl_b32 s48, s41, 3
    v_lshl_or_b32 v26, v3, 1, s48
    v_xor_b32 v26, v26, v2
    v_mul_u32_u24 v27, 3584, v3
    s_mul_i32 s46, s38, 28672
    s_lshl_b32 s49, s45, 8
    s_add_u32 s49, s49, s46
    s_add_u32 s49, s49, 1792
    v_lshl_add_u32 v6, v26, 4, v27
    v_add_u32 v6, s49, v6
    v_add_u32 v7, 13312, v6
    s_lshl_b32 s55, s38, 11
    s_waitcnt lgkmcnt(0)
    s_mov_b32 s16, s4
    s_and_b32 s17, s5, 0xffff
    s_mov_b32 s18, 0x1c0000
    s_mov_b32 s19, 0x20000
    s_mov_b32 s20, s6
    s_and_b32 s21, s7, 0xffff
    s_mov_b32 s22, 0x188000
    s_mov_b32 s23, 0x20000
    s_cmp_ge_u32 s45, 7
    s_cbranch_scc1 L_sp0
    s_add_u32 m0, s55, 65536
    s_nop 0
    buffer_load_dwordx4 v4, s[16:19], s56 offen lds
    buffer_load_dwordx4 v5, s[16:19], s56 offen offset:1024 lds
    s_add_u32 m0, s55, 32768
    s_nop 0
    buffer_load_dwordx4 v6, s[20:23], s57 offen lds
    buffer_load_dwordx4 v7, s[20:23], s57 offen offset:1024 lds
    s_add_u32 m0, s55, 73728
    s_add_u32 s57, s57, 114688
    buffer_load_dwordx4 v6, s[20:23], s57 offen lds
    buffer_load_dwordx4 v7, s[20:23], s57 offen offset:1024 lds
    s_branch L_pro2
L_sp0:
    s_add_u32 m0, s55, 0
    s_nop 0
    buffer_load_dwordx4 v4, s[16:19], s56 offen lds
    buffer_load_dwordx4 v5, s[16:19], s56 offen offset:1024 lds
    s_add_u32 m0, s55, 24576
    s_add_u32 s56, s56, 128
    s_cmp_eq_u32 s56, 896
    s_cselect_b32 s56, 0, s56
    buffer_load_dwordx4 v4, s[16:19], s56 offen lds
    buffer_load_dwordx4 v5, s[16:19], s56 offen offset:1024 lds
    s_add_u32 m0, s55, 32768
    s_add_u32 s56, s56, 128
    s_cmp_eq_u32 s56, 896
    s_cselect_b32 s56, 0, s56
    buffer_load_dwordx4 v4, s[16:19], s56 offen lds
    buffer_load_dwordx4 v5, s[16:19], s56 offen offset:1024 lds
    s_add_u32 m0, s55, 40960
    s_add_u32 s56, s56, 128
    s_cmp_eq_u32 s56, 896
    s_cselect_b32 s56, 0, s56
    buffer_load_dwordx4 v4, s[16:19], s56 offen lds
    buffer_load_dwordx4 v5, s[16:19], s56 offen offset:1024 lds
    s_add_u32 m0, s55, 57344
    s_add_u32 s56, s56, 128
    s_cmp_eq_u32 s56, 896
    s_cselect_b32 s56, 0, s56
    buffer_load_dwordx4 v4, s[16:19], s56 offen lds
    buffer_load_dwordx4 v5, s[16:19], s56 offen offset:1024 lds
    s_add_u32 m0, s55, 65536
    s_add_u32 s56, s56, 128
    s_cmp_eq_u32 s56, 896
    s_cselect_b32 s56, 0, s56
    buffer_load_dwordx4 v4, s[16:19], s56 offen lds
    buffer_load_dwordx4 v5, s[16:19], s56 offen offset:1024 lds
    s_add_u32 m0, s55, 73728
    s_add_u32 s56, s56, 128
    s_cmp_eq_u32 s56, 896
    s_cselect_b32 s56, 0, s56
    buffer_load_dwordx4 v4, s[16:19], s56 offen lds
    buffer_load_dwordx4 v5, s[16:19], s56 offen offset:1024 lds
L_pro2:
    s_load_dwordx2 s[36:37], s[14:15], 0
    s_mov_b32 s24, s14
    s_and_b32 s25, s15, 0xffff
    s_mov_b32 s26, 0x1400000
    s_mov_b32 s27, 0x20000
    s_mov_b32 s28, s8
    s_and_b32 s29, s9, 0xffff
    s_mov_b32 s30, 0x800000
    s_mov_b32 s31, 0x20000
    v_lshl_add_u32 v16, v24, 12, v25
    v_xor_b32 v17, 64, v16
    v_min_u32 v26, 13, v26
    s_mul_i32 s49, s40, 224
    s_add_u32 s49, s49, s46
    v_lshl_add_u32 v8, v26, 4, v27
    v_add_u32 v8, s49, v8
    v_add_u32 v9, 13312, v8
    s_min_u32 s43, s40, 6
    s_lshl_b32 s44, s39, 1
    s_add_u32 s44, s44, s41
    s_lshl_b32 s53, s39, 18
    s_lshl_b32 s48, s38, 16
    s_add_u32 s54, s53, s48
    s_lshl_b32 s48, s40, 1
    s_and_b32 s49, s39, 4
    s_add_u32 s48, s48, s49
    s_add_u32 s48, s48, s51
    s_and_b32 s48, s48, 7
    s_lshl_b32 s60, s48, 8
    s_lshl_b32 s58, s41, 11
    s_add_u32 s58, s58, s53
    s_lshl_b32 s48, s42, 17
    s_add_u32 s58, s58, s48
    v_and_b32 v24, 7, v2
    v_xor_b32 v24, v24, v3
    v_lshlrev_b32 v24, 4, v24
    v_lshrrev_b32 v25, 2, v2
    v_and_b32 v26, 3, v0
    v_lshl_add_u32 v24, v25, 10, v24
    v_lshl_add_u32 v24, v26, 7, v24
    s_lshl_b32 s48, s41, 12
    v_add_u32 v10, s48, v24
    v_xor_b32 v11, 64, v10
    v_add_u32 v12, 40960, v10
    v_add_u32 v13, 40960, v11
    v_lshl_add_u32 v14, v25, 3, v26
    v_lshlrev_b32 v27, 11, v3
    v_lshl_add_u32 v27, v25, 8, v27
    v_lshl_add_u32 v27, v26, 3, v27
    v_xor_b32 v28, s42, v3
    v_and_b32 v28, 1, v28
    v_lshl_add_u32 v28, v28, 2, v25
    v_lshl_add_u32 v240, v28, 5, v27
    s_lshl_b32 s48, s41, 6
    v_xor_b32 v240, s48, v240
    v_xor_b32 v241, 32, v240
    v_xor_b32 v242, 64, v240
    v_xor_b32 v243, 96, v240
    v_add_u32 v244, 40960, v240
    v_add_u32 v245, 40960, v241
    v_add_u32 v246, 40960, v242
    v_add_u32 v247, 40960, v243
    v_mov_b32 v20, 0x3f803f80
    v_mov_b32 v21, 0x3f803f80
    v_mov_b32 v22, 0x3f803f80
    v_mov_b32 v23, 0x3f803f80
    v_and_b32 v24, 7, v2
    v_lshl_add_u32 v24, v3, 3, v24
    v_lshlrev_b32 v18, 4, v24
    v_lshrrev_b32 v24, 3, v2
    v_lshl_add_u32 v19, v24, 9, v18
    v_lshl_add_u32 v24, v3, 2, v25
    v_and_b32 v26, 1, v0
    v_lshl_add_u32 v24, v24, 1, v26
    v_lshlrev_b32 v15, 4, v24
    s_lshl_b32 s59, s44, 9
    s_add_u32 s59, s59, 0x8000
    v_and_b32 v24, 1, v3
    v_lshl_add_u32 v24, v24, 7, s60
    v_lshrrev_b32 v25, 1, v3
    v_lshl_add_u32 v24, v25, 11, v24
    v_lshl_add_u32 v127, v2, 12, v24
    s_cmp_ge_u32 s45, 7
    s_cbranch_scc1 L_spare
    s_add_u32 m0, s55, 0
    s_add_u32 s56, s56, 128
    s_cmp_eq_u32 s56, 896
    s_cselect_b32 s56, 0, s56
    buffer_load_dwordx4 v4, s[16:19], s56 offen lds
    buffer_load_dwordx4 v5, s[16:19], s56 offen offset:1024 lds
    s_add_u32 m0, s55, 40960
    s_mul_i32 s57, s56, 1792
    buffer_load_dwordx4 v6, s[20:23], s57 offen lds
    buffer_load_dwordx4 v7, s[20:23], s57 offen offset:1024 lds
    s_add_u32 m0, s55, 8192
    s_add_u32 s57, s57, 114688
    buffer_load_dwordx4 v6, s[20:23], s57 offen lds
    buffer_load_dwordx4 v7, s[20:23], s57 offen offset:1024 lds
    s_waitcnt vmcnt(6)
    s_waitcnt lgkmcnt(0)
    s_barrier
    ds_read_b128 v[128:131], v12 offset:24576
    ds_read_b128 v[132:135], v12 offset:25088
    ds_read_b64_tr_b16 v[24:25], v240 offset:32768
    ds_read_b64_tr_b16 v[26:27], v240 offset:33792
    ds_read_b64_tr_b16 v[28:29], v241 offset:32768
    ds_read_b64_tr_b16 v[30:31], v241 offset:33792
    ds_read_b64_tr_b16 v[32:33], v242 offset:32768
    ds_read_b64_tr_b16 v[34:35], v242 offset:33792
    ds_read_b64_tr_b16 v[36:37], v243 offset:32768
    ds_read_b64_tr_b16 v[38:39], v243 offset:33792
    ds_read_b128 v[136:139], v13 offset:24576
    ds_read_b128 v[140:143], v13 offset:25088
    s_waitcnt lgkmcnt(8)
    v_mfma_f32_16x16x32_bf16 v[56:59], v[128:131], v[24:27], 0
    ds_read_b64_tr_b16 v[40:41], v244 offset:32768
    ds_read_b64_tr_b16 v[42:43], v244 offset:33792
    v_mfma_f32_16x16x32_bf16 v[60:63], v[132:135], v[24:27], 0
    ds_read_b64_tr_b16 v[44:45], v245 offset:32768
    ds_read_b64_tr_b16 v[46:47], v245 offset:33792
    v_mfma_f32_16x16x32_bf16 v[88:91], v[20:23], v[24:27], 0
    ds_read_b64_tr_b16 v[48:49], v246 offset:32768
    ds_read_b64_tr_b16 v[50:51], v246 offset:33792
    s_waitcnt lgkmcnt(12)
    v_mfma_f32_16x16x32_bf16 v[64:67], v[128:131], v[28:31], 0
    ds_read_b64_tr_b16 v[52:53], v247 offset:32768
    ds_read_b64_tr_b16 v[54:55], v247 offset:33792
    v_mfma_f32_16x16x32_bf16 v[68:71], v[132:135], v[28:31], 0
    s_add_u32 m0, s55, 49152
    s_add_u32 s56, s56, 128
    s_cmp_eq_u32 s56, 896
    s_cselect_b32 s56, 0, s56
    buffer_load_dwordx4 v4, s[16:19], s56 offen lds
    v_mfma_f32_16x16x32_bf16 v[92:95], v[20:23], v[28:31], 0
    buffer_load_dwordx4 v5, s[16:19], s56 offen offset:1024 lds
    s_waitcnt lgkmcnt(12)
    v_mfma_f32_16x16x32_bf16 v[72:75], v[128:131], v[32:35], 0
    s_add_u32 m0, s55, 16384
    s_mul_i32 s57, s56, 1792
    buffer_load_dwordx4 v6, s[20:23], s57 offen lds
    v_mfma_f32_16x16x32_bf16 v[76:79], v[132:135], v[32:35], 0
    buffer_load_dwordx4 v7, s[20:23], s57 offen offset:1024 lds
    s_waitcnt lgkmcnt(10)
    v_mfma_f32_16x16x32_bf16 v[80:83], v[128:131], v[36:39], 0
    s_add_u32 m0, s55, 57344
    s_add_u32 s57, s57, 114688
    buffer_load_dwordx4 v6, s[20:23], s57 offen lds
    v_mfma_f32_16x16x32_bf16 v[84:87], v[132:135], v[36:39], 0
    s_waitcnt lgkmcnt(6)
    v_mfma_f32_16x16x32_bf16 v[56:59], v[136:139], v[40:43], v[56:59]
    v_mfma_f32_16x16x32_bf16 v[60:63], v[140:143], v[40:43], v[60:63]
    s_waitcnt vmcnt(5)
    s_waitcnt lgkmcnt(0)
    s_barrier
    ds_read_b128 v[144:147], v10 offset:0
    ds_read_b128 v[148:151], v10 offset:512
    v_mfma_f32_16x16x32_bf16 v[88:91], v[20:23], v[40:43], v[88:91]
    ds_read_b64_tr_b16 v[24:25], v244 offset:0
    ds_read_b64_tr_b16 v[26:27], v244 offset:1024
    v_mfma_f32_16x16x32_bf16 v[64:67], v[136:139], v[44:47], v[64:67]
    ds_read_b64_tr_b16 v[28:29], v245 offset:0
    ds_read_b64_tr_b16 v[30:31], v245 offset:1024
    v_mfma_f32_16x16x32_bf16 v[68:71], v[140:143], v[44:47], v[68:71]
    ds_read_b64_tr_b16 v[32:33], v246 offset:0
    ds_read_b64_tr_b16 v[34:35], v246 offset:1024
    v_mfma_f32_16x16x32_bf16 v[92:95], v[20:23], v[44:47], v[92:95]
    ds_read_b64_tr_b16 v[36:37], v247 offset:0
    ds_read_b64_tr_b16 v[38:39], v247 offset:1024
    v_mfma_f32_16x16x32_bf16 v[72:75], v[136:139], v[48:51], v[72:75]
    buffer_load_dwordx4 v7, s[20:23], s57 offen offset:1024 lds
    v_mfma_f32_16x16x32_bf16 v[76:79], v[140:143], v[48:51], v[76:79]
    s_add_u32 m0, s55, 24576
    s_add_u32 s56, s56, 128
    s_cmp_eq_u32 s56, 896
    s_cselect_b32 s56, 0, s56
    buffer_load_dwordx4 v4, s[16:19], s56 offen lds
    v_mfma_f32_16x16x32_bf16 v[80:83], v[136:139], v[52:55], v[80:83]
    buffer_load_dwordx4 v5, s[16:19], s56 offen offset:1024 lds
    v_mfma_f32_16x16x32_bf16 v[84:87], v[140:143], v[52:55], v[84:87]
    s_add_u32 s36, s36, 2
    s_addc_u32 s37, s37, 0
    s_or_b32 s36, s36, 1
    ds_read_b128 v[152:155], v11 offset:0
    ds_read_b128 v[156:159], v11 offset:512
    s_waitcnt lgkmcnt(8)
    v_mfma_f32_16x16x32_bf16 v[56:59], v[144:147], v[24:27], v[56:59]
    ds_read_b64_tr_b16 v[40:41], v240 offset:8192
    ds_read_b64_tr_b16 v[42:43], v240 offset:9216
    v_mfma_f32_16x16x32_bf16 v[60:63], v[148:151], v[24:27], v[60:63]
    ds_read_b64_tr_b16 v[44:45], v241 offset:8192
    ds_read_b64_tr_b16 v[46:47], v241 offset:9216
    v_mfma_f32_16x16x32_bf16 v[88:91], v[20:23], v[24:27], v[88:91]
    ds_read_b64_tr_b16 v[48:49], v242 offset:8192
    ds_read_b64_tr_b16 v[50:51], v242 offset:9216
    s_waitcnt lgkmcnt(12)
    v_mfma_f32_16x16x32_bf16 v[64:67], v[144:147], v[28:31], v[64:67]
    ds_read_b64_tr_b16 v[52:53], v243 offset:8192
    ds_read_b64_tr_b16 v[54:55], v243 offset:9216
    v_mfma_f32_16x16x32_bf16 v[68:71], v[148:151], v[28:31], v[68:71]
    s_add_u32 m0, s55, 65536
    s_mul_i32 s57, s56, 1792
    buffer_load_dwordx4 v6, s[20:23], s57 offen lds
    v_mfma_f32_16x16x32_bf16 v[92:95], v[20:23], v[28:31], v[92:95]
    buffer_load_dwordx4 v7, s[20:23], s57 offen offset:1024 lds
    s_waitcnt lgkmcnt(12)
    v_mfma_f32_16x16x32_bf16 v[72:75], v[144:147], v[32:35], v[72:75]
    s_add_u32 m0, s55, 32768
    s_add_u32 s57, s57, 114688
    buffer_load_dwordx4 v6, s[20:23], s57 offen lds
    v_mfma_f32_16x16x32_bf16 v[76:79], v[148:151], v[32:35], v[76:79]
    buffer_load_dwordx4 v7, s[20:23], s57 offen offset:1024 lds
    s_waitcnt lgkmcnt(10)
    v_mfma_f32_16x16x32_bf16 v[80:83], v[144:147], v[36:39], v[80:83]
    s_add_u32 m0, s55, 73728
    s_add_u32 s56, s56, 128
    s_cmp_eq_u32 s56, 896
    s_cselect_b32 s56, 0, s56
    buffer_load_dwordx4 v4, s[16:19], s56 offen lds
    v_mfma_f32_16x16x32_bf16 v[84:87], v[148:151], v[36:39], v[84:87]
    s_waitcnt lgkmcnt(6)
    v_mfma_f32_16x16x32_bf16 v[56:59], v[152:155], v[40:43], v[56:59]
    v_mfma_f32_16x16x32_bf16 v[60:63], v[156:159], v[40:43], v[60:63]
    s_waitcnt vmcnt(7)
    s_waitcnt lgkmcnt(0)
    s_barrier
    ds_read_b128 v[160:163], v12 offset:8192
    ds_read_b128 v[164:167], v12 offset:8704
    v_mfma_f32_16x16x32_bf16 v[88:91], v[20:23], v[40:43], v[88:91]
    ds_read_b64_tr_b16 v[24:25], v240 offset:16384
    ds_read_b64_tr_b16 v[26:27], v240 offset:17408
    v_mfma_f32_16x16x32_bf16 v[64:67], v[152:155], v[44:47], v[64:67]
    ds_read_b64_tr_b16 v[28:29], v241 offset:16384
    ds_read_b64_tr_b16 v[30:31], v241 offset:17408
    v_mfma_f32_16x16x32_bf16 v[68:71], v[156:159], v[44:47], v[68:71]
    ds_read_b64_tr_b16 v[32:33], v242 offset:16384
    ds_read_b64_tr_b16 v[34:35], v242 offset:17408
    v_mfma_f32_16x16x32_bf16 v[92:95], v[20:23], v[44:47], v[92:95]
    ds_read_b64_tr_b16 v[36:37], v243 offset:16384
    ds_read_b64_tr_b16 v[38:39], v243 offset:17408
    v_mfma_f32_16x16x32_bf16 v[72:75], v[152:155], v[48:51], v[72:75]
    buffer_load_dwordx4 v5, s[16:19], s56 offen offset:1024 lds
    v_mfma_f32_16x16x32_bf16 v[76:79], v[156:159], v[48:51], v[76:79]
    s_add_u32 m0, s55, 0
    s_mul_i32 s57, s56, 1792
    buffer_load_dwordx4 v6, s[20:23], s57 offen lds
    v_mfma_f32_16x16x32_bf16 v[80:83], v[152:155], v[52:55], v[80:83]
    buffer_load_dwordx4 v7, s[20:23], s57 offen offset:1024 lds
    v_mfma_f32_16x16x32_bf16 v[84:87], v[156:159], v[52:55], v[84:87]
    ds_read_b128 v[168:171], v13 offset:8192
    ds_read_b128 v[172:175], v13 offset:8704
    s_waitcnt lgkmcnt(8)
    v_mfma_f32_16x16x32_bf16 v[56:59], v[160:163], v[24:27], v[56:59]
    ds_read_b64_tr_b16 v[40:41], v244 offset:16384
    ds_read_b64_tr_b16 v[42:43], v244 offset:17408
    v_mfma_f32_16x16x32_bf16 v[60:63], v[164:167], v[24:27], v[60:63]
    ds_read_b64_tr_b16 v[44:45], v245 offset:16384
    ds_read_b64_tr_b16 v[46:47], v245 offset:17408
    v_mfma_f32_16x16x32_bf16 v[88:91], v[20:23], v[24:27], v[88:91]
    ds_read_b64_tr_b16 v[48:49], v246 offset:16384
    ds_read_b64_tr_b16 v[50:51], v246 offset:17408
    s_waitcnt lgkmcnt(12)
    v_mfma_f32_16x16x32_bf16 v[64:67], v[160:163], v[28:31], v[64:67]
    ds_read_b64_tr_b16 v[52:53], v247 offset:16384
    ds_read_b64_tr_b16 v[54:55], v247 offset:17408
    v_mfma_f32_16x16x32_bf16 v[68:71], v[164:167], v[28:31], v[68:71]
    s_add_u32 m0, s55, 40960
    s_add_u32 s57, s57, 114688
    buffer_load_dwordx4 v6, s[20:23], s57 offen lds
    v_mfma_f32_16x16x32_bf16 v[92:95], v[20:23], v[28:31], v[92:95]
    buffer_load_dwordx4 v7, s[20:23], s57 offen offset:1024 lds
    s_waitcnt lgkmcnt(12)
    v_mfma_f32_16x16x32_bf16 v[72:75], v[160:163], v[32:35], v[72:75]
    s_add_u32 m0, s55, 8192
    s_add_u32 s56, s56, 128
    s_cmp_eq_u32 s56, 896
    s_cselect_b32 s56, 0, s56
    buffer_load_dwordx4 v4, s[16:19], s56 offen lds
    v_mfma_f32_16x16x32_bf16 v[76:79], v[164:167], v[32:35], v[76:79]
    buffer_load_dwordx4 v5, s[16:19], s56 offen offset:1024 lds
    s_waitcnt lgkmcnt(10)
    v_mfma_f32_16x16x32_bf16 v[80:83], v[160:163], v[36:39], v[80:83]
    v_mfma_f32_16x16x32_bf16 v[84:87], v[164:167], v[36:39], v[84:87]
    s_waitcnt lgkmcnt(6)
    v_mfma_f32_16x16x32_bf16 v[56:59], v[168:171], v[40:43], v[56:59]
    v_mfma_f32_16x16x32_bf16 v[60:63], v[172:175], v[40:43], v[60:63]
    s_waitcnt vmcnt(8)
    s_waitcnt lgkmcnt(0)
    s_barrier
    ds_read_b128 v[176:179], v10 offset:24576
    ds_read_b128 v[180:183], v10 offset:25088
    v_mfma_f32_16x16x32_bf16 v[88:91], v[20:23], v[40:43], v[88:91]
    ds_read_b64_tr_b16 v[24:25], v244 offset:24576
    ds_read_b64_tr_b16 v[26:27], v244 offset:25600
    v_mfma_f32_16x16x32_bf16 v[64:67], v[168:171], v[44:47], v[64:67]
    ds_read_b64_tr_b16 v[28:29], v245 offset:24576
    ds_read_b64_tr_b16 v[30:31], v245 offset:25600
    v_mfma_f32_16x16x32_bf16 v[68:71], v[172:175], v[44:47], v[68:71]
    ds_read_b64_tr_b16 v[32:33], v246 offset:24576
    ds_read_b64_tr_b16 v[34:35], v246 offset:25600
    v_mfma_f32_16x16x32_bf16 v[92:95], v[20:23], v[44:47], v[92:95]
    ds_read_b64_tr_b16 v[36:37], v247 offset:24576
    ds_read_b64_tr_b16 v[38:39], v247 offset:25600
    v_mfma_f32_16x16x32_bf16 v[72:75], v[168:171], v[48:51], v[72:75]
    s_add_u32 m0, s55, 49152
    s_mul_i32 s57, s56, 1792
    buffer_load_dwordx4 v6, s[20:23], s57 offen lds
    v_mfma_f32_16x16x32_bf16 v[76:79], v[172:175], v[48:51], v[76:79]
    buffer_load_dwordx4 v7, s[20:23], s57 offen offset:1024 lds
    v_mfma_f32_16x16x32_bf16 v[80:83], v[168:171], v[52:55], v[80:83]
    s_add_u32 m0, s55, 16384
    s_add_u32 s57, s57, 114688
    buffer_load_dwordx4 v6, s[20:23], s57 offen lds
    v_mfma_f32_16x16x32_bf16 v[84:87], v[172:175], v[52:55], v[84:87]
    ds_read_b128 v[184:187], v11 offset:24576
    ds_read_b128 v[188:191], v11 offset:25088
    s_waitcnt lgkmcnt(8)
    v_mfma_f32_16x16x32_bf16 v[56:59], v[176:179], v[24:27], v[56:59]
    ds_read_b64_tr_b16 v[40:41], v240 offset:32768
    ds_read_b64_tr_b16 v[42:43], v240 offset:33792
    v_mfma_f32_16x16x32_bf16 v[60:63], v[180:183], v[24:27], v[60:63]
    ds_read_b64_tr_b16 v[44:45], v241 offset:32768
    ds_read_b64_tr_b16 v[46:47], v241 offset:33792
    v_mfma_f32_16x16x32_bf16 v[88:91], v[20:23], v[24:27], v[88:91]
    ds_read_b64_tr_b16 v[48:49], v242 offset:32768
    ds_read_b64_tr_b16 v[50:51], v242 offset:33792
    s_waitcnt lgkmcnt(12)
    v_mfma_f32_16x16x32_bf16 v[64:67], v[176:179], v[28:31], v[64:67]
    ds_read_b64_tr_b16 v[52:53], v243 offset:32768
    ds_read_b64_tr_b16 v[54:55], v243 offset:33792
    v_mfma_f32_16x16x32_bf16 v[68:71], v[180:183], v[28:31], v[68:71]
    buffer_load_dwordx4 v7, s[20:23], s57 offen offset:1024 lds
    v_mfma_f32_16x16x32_bf16 v[92:95], v[20:23], v[28:31], v[92:95]
    s_add_u32 m0, s55, 57344
    s_add_u32 s56, s56, 128
    s_cmp_eq_u32 s56, 896
    s_cselect_b32 s56, 0, s56
    buffer_load_dwordx4 v4, s[16:19], s56 offen lds
    s_waitcnt lgkmcnt(12)
    v_mfma_f32_16x16x32_bf16 v[72:75], v[176:179], v[32:35], v[72:75]
    buffer_load_dwordx4 v5, s[16:19], s56 offen offset:1024 lds
    v_mfma_f32_16x16x32_bf16 v[76:79], v[180:183], v[32:35], v[76:79]
    s_waitcnt lgkmcnt(10)
    v_mfma_f32_16x16x32_bf16 v[80:83], v[176:179], v[36:39], v[80:83]
    v_mfma_f32_16x16x32_bf16 v[84:87], v[180:183], v[36:39], v[84:87]
    v_mov_b32 v5, v127
    s_waitcnt lgkmcnt(6)
    v_mfma_f32_16x16x32_bf16 v[56:59], v[184:187], v[40:43], v[56:59]
    v_mfma_f32_16x16x32_bf16 v[60:63], v[188:191], v[40:43], v[60:63]
    s_waitcnt vmcnt(8)
    s_waitcnt lgkmcnt(0)
    s_barrier
    ds_read_b128 v[192:195], v12 offset:32768
    ds_read_b128 v[196:199], v12 offset:33280
    v_mfma_f32_16x16x32_bf16 v[88:91], v[20:23], v[40:43], v[88:91]
    ds_read_b64_tr_b16 v[24:25], v240 offset:0
    ds_read_b64_tr_b16 v[26:27], v240 offset:1024
    v_mfma_f32_16x16x32_bf16 v[64:67], v[184:187], v[44:47], v[64:67]
    ds_read_b64_tr_b16 v[28:29], v241 offset:0
    ds_read_b64_tr_b16 v[30:31], v241 offset:1024
    v_mfma_f32_16x16x32_bf16 v[68:71], v[188:191], v[44:47], v[68:71]
    ds_read_b64_tr_b16 v[32:33], v242 offset:0
    ds_read_b64_tr_b16 v[34:35], v242 offset:1024
    v_mfma_f32_16x16x32_bf16 v[92:95], v[20:23], v[44:47], v[92:95]
    ds_read_b64_tr_b16 v[36:37], v243 offset:0
    ds_read_b64_tr_b16 v[38:39], v243 offset:1024
    v_mfma_f32_16x16x32_bf16 v[72:75], v[184:187], v[48:51], v[72:75]
    s_add_u32 m0, s55, 24576
    s_mul_i32 s57, s56, 1792
    buffer_load_dwordx4 v6, s[20:23], s57 offen lds
    v_mfma_f32_16x16x32_bf16 v[76:79], v[188:191], v[48:51], v[76:79]
    buffer_load_dwordx4 v7, s[20:23], s57 offen offset:1024 lds
    v_mfma_f32_16x16x32_bf16 v[80:83], v[184:187], v[52:55], v[80:83]
    s_add_u32 m0, s55, 65536
    s_add_u32 s57, s57, 114688
    buffer_load_dwordx4 v6, s[20:23], s57 offen lds
    v_mfma_f32_16x16x32_bf16 v[84:87], v[188:191], v[52:55], v[84:87]
    ds_read_b128 v[200:203], v13 offset:32768
    ds_read_b128 v[204:207], v13 offset:33280
    s_waitcnt lgkmcnt(8)
    v_mfma_f32_16x16x32_bf16 v[56:59], v[192:195], v[24:27], v[56:59]
    ds_read_b64_tr_b16 v[40:41], v244 offset:0
    ds_read_b64_tr_b16 v[42:43], v244 offset:1024
    v_mfma_f32_16x16x32_bf16 v[60:63], v[196:199], v[24:27], v[60:63]
    ds_read_b64_tr_b16 v[44:45], v245 offset:0
    ds_read_b64_tr_b16 v[46:47], v245 offset:1024
    v_mfma_f32_16x16x32_bf16 v[88:91], v[20:23], v[24:27], v[88:91]
    ds_read_b64_tr_b16 v[48:49], v246 offset:0
    ds_read_b64_tr_b16 v[50:51], v246 offset:1024
    s_waitcnt lgkmcnt(12)
    v_mfma_f32_16x16x32_bf16 v[64:67], v[192:195], v[28:31], v[64:67]
    ds_read_b64_tr_b16 v[52:53], v247 offset:0
    ds_read_b64_tr_b16 v[54:55], v247 offset:1024
    v_mfma_f32_16x16x32_bf16 v[68:71], v[196:199], v[28:31], v[68:71]
    buffer_load_dwordx4 v7, s[20:23], s57 offen offset:1024 lds
    v_mfma_f32_16x16x32_bf16 v[92:95], v[20:23], v[28:31], v[92:95]
    s_add_u32 m0, s55, 32768
    s_add_u32 s57, s57, 114688
    s_cmp_eq_u32 s57, 1605632
    s_cselect_b32 s57, 0, s57
    buffer_load_dwordx4 v8, s[20:23], s57 offen lds
    s_waitcnt lgkmcnt(12)
    v_mfma_f32_16x16x32_bf16 v[72:75], v[192:195], v[32:35], v[72:75]
    buffer_load_dwordx4 v9, s[20:23], s57 offen offset:1024 lds
    v_mfma_f32_16x16x32_bf16 v[76:79], v[196:199], v[32:35], v[76:79]
    s_waitcnt lgkmcnt(10)
    v_mfma_f32_16x16x32_bf16 v[80:83], v[192:195], v[36:39], v[80:83]
    v_mfma_f32_16x16x32_bf16 v[84:87], v[196:199], v[36:39], v[84:87]
    s_waitcnt lgkmcnt(6)
    v_mfma_f32_16x16x32_bf16 v[56:59], v[200:203], v[40:43], v[56:59]
    v_mfma_f32_16x16x32_bf16 v[60:63], v[204:207], v[40:43], v[60:63]
    s_waitcnt vmcnt(8)
    s_waitcnt lgkmcnt(0)
    s_barrier
    ds_read_b128 v[208:211], v10 offset:8192
    ds_read_b128 v[212:215], v10 offset:8704
    v_mfma_f32_16x16x32_bf16 v[88:91], v[20:23], v[40:43], v[88:91]
    ds_read_b64_tr_b16 v[24:25], v244 offset:8192
    ds_read_b64_tr_b16 v[26:27], v244 offset:9216
    v_mfma_f32_16x16x32_bf16 v[64:67], v[200:203], v[44:47], v[64:67]
    ds_read_b64_tr_b16 v[28:29], v245 offset:8192
    ds_read_b64_tr_b16 v[30:31], v245 offset:9216
    v_mfma_f32_16x16x32_bf16 v[68:71], v[204:207], v[44:47], v[68:71]
    ds_read_b64_tr_b16 v[32:33], v246 offset:8192
    ds_read_b64_tr_b16 v[34:35], v246 offset:9216
    v_mfma_f32_16x16x32_bf16 v[92:95], v[20:23], v[44:47], v[92:95]
    ds_read_b64_tr_b16 v[36:37], v247 offset:8192
    ds_read_b64_tr_b16 v[38:39], v247 offset:9216
    v_mfma_f32_16x16x32_bf16 v[72:75], v[200:203], v[48:51], v[72:75]
    buffer_load_dwordx4 v[248:251], v18, s[24:27], s59 offen sc1
    v_mfma_f32_16x16x32_bf16 v[76:79], v[204:207], v[48:51], v[76:79]
    s_add_u32 m0, s55, 73728
    s_add_u32 s57, s57, 114688
    buffer_load_dwordx4 v8, s[20:23], s57 offen lds
    v_mfma_f32_16x16x32_bf16 v[80:83], v[200:203], v[52:55], v[80:83]
    buffer_load_dwordx4 v9, s[20:23], s57 offen offset:1024 lds
    v_mfma_f32_16x16x32_bf16 v[84:87], v[204:207], v[52:55], v[84:87]
    ds_read_b128 v[216:219], v11 offset:8192
    ds_read_b128 v[220:223], v11 offset:8704
    s_waitcnt lgkmcnt(8)
    v_mfma_f32_16x16x32_bf16 v[56:59], v[208:211], v[24:27], v[56:59]
    ds_read_b64_tr_b16 v[40:41], v240 offset:16384
    ds_read_b64_tr_b16 v[42:43], v240 offset:17408
    v_mfma_f32_16x16x32_bf16 v[60:63], v[212:215], v[24:27], v[60:63]
    ds_read_b64_tr_b16 v[44:45], v241 offset:16384
    ds_read_b64_tr_b16 v[46:47], v241 offset:17408
    v_mfma_f32_16x16x32_bf16 v[88:91], v[20:23], v[24:27], v[88:91]
    ds_read_b64_tr_b16 v[48:49], v242 offset:16384
    ds_read_b64_tr_b16 v[50:51], v242 offset:17408
    s_waitcnt lgkmcnt(12)
    v_mfma_f32_16x16x32_bf16 v[64:67], v[208:211], v[28:31], v[64:67]
    ds_read_b64_tr_b16 v[52:53], v243 offset:16384
    ds_read_b64_tr_b16 v[54:55], v243 offset:17408
    v_mfma_f32_16x16x32_bf16 v[68:71], v[212:215], v[28:31], v[68:71]
    s_add_u32 m0, s55, 0
    s_add_u32 s57, s57, 114688
    s_cmp_eq_u32 s57, 1605632
    s_cselect_b32 s57, 0, s57
    buffer_load_dwordx4 v8, s[20:23], s57 offen lds
    v_mfma_f32_16x16x32_bf16 v[92:95], v[20:23], v[28:31], v[92:95]
    buffer_load_dwordx4 v9, s[20:23], s57 offen offset:1024 lds
    s_waitcnt lgkmcnt(12)
    v_mfma_f32_16x16x32_bf16 v[72:75], v[208:211], v[32:35], v[72:75]
    s_add_u32 m0, s55, 40960
    s_add_u32 s57, s57, 114688
    buffer_load_dwordx4 v8, s[20:23], s57 offen lds
    v_mfma_f32_16x16x32_bf16 v[76:79], v[212:215], v[32:35], v[76:79]
    buffer_load_dwordx4 v9, s[20:23], s57 offen offset:1024 lds
    s_waitcnt lgkmcnt(10)
    v_mfma_f32_16x16x32_bf16 v[80:83], v[208:211], v[36:39], v[80:83]
    v_mfma_f32_16x16x32_bf16 v[84:87], v[212:215], v[36:39], v[84:87]
    s_waitcnt lgkmcnt(6)
    v_mfma_f32_16x16x32_bf16 v[56:59], v[216:219], v[40:43], v[56:59]
    v_mfma_f32_16x16x32_bf16 v[60:63], v[220:223], v[40:43], v[60:63]
    s_waitcnt vmcnt(9)
    s_waitcnt lgkmcnt(0)
    s_barrier
    ds_read_b128 v[224:227], v12 offset:16384
    ds_read_b128 v[228:231], v12 offset:16896
    v_mfma_f32_16x16x32_bf16 v[88:91], v[20:23], v[40:43], v[88:91]
    ds_read_b64_tr_b16 v[24:25], v240 offset:24576
    ds_read_b64_tr_b16 v[26:27], v240 offset:25600
    v_mfma_f32_16x16x32_bf16 v[64:67], v[216:219], v[44:47], v[64:67]
    ds_read_b64_tr_b16 v[28:29], v241 offset:24576
    ds_read_b64_tr_b16 v[30:31], v241 offset:25600
    v_mfma_f32_16x16x32_bf16 v[68:71], v[220:223], v[44:47], v[68:71]
    ds_read_b64_tr_b16 v[32:33], v242 offset:24576
    ds_read_b64_tr_b16 v[34:35], v242 offset:25600
    v_mfma_f32_16x16x32_bf16 v[92:95], v[20:23], v[44:47], v[92:95]
    ds_read_b64_tr_b16 v[36:37], v243 offset:24576
    ds_read_b64_tr_b16 v[38:39], v243 offset:25600
    v_mfma_f32_16x16x32_bf16 v[72:75], v[216:219], v[48:51], v[72:75]
    s_add_u32 m0, s55, 8192
    s_add_u32 s57, s57, 114688
    s_cmp_eq_u32 s57, 1605632
    s_cselect_b32 s57, 0, s57
    buffer_load_dwordx4 v8, s[20:23], s57 offen lds
    v_mfma_f32_16x16x32_bf16 v[76:79], v[220:223], v[48:51], v[76:79]
    buffer_load_dwordx4 v9, s[20:23], s57 offen offset:1024 lds
    v_mfma_f32_16x16x32_bf16 v[80:83], v[216:219], v[52:55], v[80:83]
    s_add_u32 m0, s55, 49152
    s_add_u32 s57, s57, 114688
    buffer_load_dwordx4 v8, s[20:23], s57 offen lds
    v_mfma_f32_16x16x32_bf16 v[84:87], v[220:223], v[52:55], v[84:87]
    s_waitcnt vmcnt(9)
    v_cmp_ne_u64 s[62:63], v[250:251], s[36:37]
    s_nop 0
    s_cmp_eq_u64 s[62:63], 0
    s_cbranch_scc1 L_xs_ok
    s_mov_b32 s61, 16384
L_xs:
    buffer_load_dwordx4 v[248:251], v18, s[24:27], s59 offen sc1
    s_waitcnt vmcnt(0)
    v_cmp_ne_u64 s[62:63], v[250:251], s[36:37]
    s_nop 0
    s_cmp_eq_u64 s[62:63], 0
    s_cbranch_scc1 L_xs_ok
    s_sub_u32 s61, s61, 1
    s_cbranch_scc0 L_xs
L_xs_ok:
    ds_read_b128 v[232:235], v13 offset:16384
    ds_read_b128 v[236:239], v13 offset:16896
    s_waitcnt lgkmcnt(8)
    v_mfma_f32_16x16x32_bf16 v[56:59], v[224:227], v[24:27], v[56:59]
    ds_read_b64_tr_b16 v[40:41], v244 offset:24576
    ds_read_b64_tr_b16 v[42:43], v244 offset:25600
    v_mfma_f32_16x16x32_bf16 v[60:63], v[228:231], v[24:27], v[60:63]
    ds_read_b64_tr_b16 v[44:45], v245 offset:24576
    ds_read_b64_tr_b16 v[46:47], v245 offset:25600
    v_mfma_f32_16x16x32_bf16 v[88:91], v[20:23], v[24:27], v[88:91]
    ds_read_b64_tr_b16 v[48:49], v246 offset:24576
    ds_read_b64_tr_b16 v[50:51], v246 offset:25600
    s_waitcnt lgkmcnt(12)
    v_mfma_f32_16x16x32_bf16 v[64:67], v[224:227], v[28:31], v[64:67]
    ds_read_b64_tr_b16 v[52:53], v247 offset:24576
    ds_read_b64_tr_b16 v[54:55], v247 offset:25600
    v_mfma_f32_16x16x32_bf16 v[68:71], v[228:231], v[28:31], v[68:71]
    buffer_load_dwordx4 v9, s[20:23], s57 offen offset:1024 lds
    v_mfma_f32_16x16x32_bf16 v[92:95], v[20:23], v[28:31], v[92:95]
    s_add_u32 m0, s55, 16384
    s_add_u32 s57, s57, 114688
    s_cmp_eq_u32 s57, 1605632
    s_cselect_b32 s57, 0, s57
    buffer_load_dwordx4 v8, s[20:23], s57 offen lds
    s_waitcnt lgkmcnt(12)
    v_mfma_f32_16x16x32_bf16 v[72:75], v[224:227], v[32:35], v[72:75]
    buffer_load_dwordx4 v9, s[20:23], s57 offen offset:1024 lds
    v_mfma_f32_16x16x32_bf16 v[76:79], v[228:231], v[32:35], v[76:79]
    buffer_load_dword v4, v5, s[28:31], s54 offen
    s_waitcnt lgkmcnt(10)
    v_mfma_f32_16x16x32_bf16 v[80:83], v[224:227], v[36:39], v[80:83]
    v_rcp_f32 v251, v249
    v_mov_b32_dpp v104, v248 row_newbcast:0 row_mask:0xf bank_mask:0xf
    v_mfma_f32_16x16x32_bf16 v[84:87], v[228:231], v[36:39], v[84:87]
    v_mov_b32_dpp v105, v248 row_newbcast:1 row_mask:0xf bank_mask:0xf
    v_mov_b32_dpp v106, v248 row_newbcast:2 row_mask:0xf bank_mask:0xf
    v_mov_b32_dpp v107, v248 row_newbcast:3 row_mask:0xf bank_mask:0xf
    v_mov_b32_dpp v108, v248 row_newbcast:4 row_mask:0xf bank_mask:0xf
    v_mov_b32_dpp v109, v248 row_newbcast:5 row_mask:0xf bank_mask:0xf
    v_mov_b32_dpp v110, v248 row_newbcast:6 row_mask:0xf bank_mask:0xf
    v_mov_b32_dpp v111, v248 row_newbcast:7 row_mask:0xf bank_mask:0xf
    v_mul_f32 v250, 0xc0135761, v251
    v_mul_f32 v251, v251, v251
    v_mov_b32_dpp v112, v249 row_newbcast:0 row_mask:0xf bank_mask:0xf
    v_mov_b32_dpp v113, v249 row_newbcast:1 row_mask:0xf bank_mask:0xf
    v_mov_b32_dpp v114, v249 row_newbcast:2 row_mask:0xf bank_mask:0xf
    s_waitcnt lgkmcnt(6)
    v_mfma_f32_16x16x32_bf16 v[56:59], v[232:235], v[40:43], v[56:59]
    v_mfma_f32_16x16x32_bf16 v[60:63], v[236:239], v[40:43], v[60:63]
    s_waitcnt lgkmcnt(0)
    s_barrier
    v_mov_b32_dpp v115, v249 row_newbcast:3 row_mask:0xf bank_mask:0xf
    v_mov_b32_dpp v116, v249 row_newbcast:4 row_mask:0xf bank_mask:0xf
    v_mfma_f32_16x16x32_bf16 v[88:91], v[20:23], v[40:43], v[88:91]
    v_mov_b32_dpp v117, v249 row_newbcast:5 row_mask:0xf bank_mask:0xf
    v_mov_b32_dpp v118, v249 row_newbcast:6 row_mask:0xf bank_mask:0xf
    v_mfma_f32_16x16x32_bf16 v[64:67], v[232:235], v[44:47], v[64:67]
    v_mov_b32_dpp v119, v249 row_newbcast:7 row_mask:0xf bank_mask:0xf
    v_mul_f32 v251, v251, v250
    v_mfma_f32_16x16x32_bf16 v[68:71], v[236:239], v[44:47], v[68:71]
    v_mul_f32 v251, 0x3d372713, v251
    v_mov_b32_dpp v120, v250 row_newbcast:0 row_mask:0xf bank_mask:0xf
    v_mfma_f32_16x16x32_bf16 v[92:95], v[20:23], v[44:47], v[92:95]
    v_mov_b32_dpp v121, v250 row_newbcast:1 row_mask:0xf bank_mask:0xf
    v_mov_b32_dpp v122, v250 row_newbcast:2 row_mask:0xf bank_mask:0xf
    v_mfma_f32_16x16x32_bf16 v[72:75], v[232:235], v[48:51], v[72:75]
    v_mov_b32_dpp v123, v250 row_newbcast:3 row_mask:0xf bank_mask:0xf
    v_mov_b32_dpp v124, v250 row_newbcast:4 row_mask:0xf bank_mask:0xf
    v_mfma_f32_16x16x32_bf16 v[76:79], v[236:239], v[48:51], v[76:79]
    v_mov_b32_dpp v125, v250 row_newbcast:5 row_mask:0xf bank_mask:0xf
    v_mov_b32_dpp v126, v250 row_newbcast:6 row_mask:0xf bank_mask:0xf
    v_mfma_f32_16x16x32_bf16 v[80:83], v[232:235], v[52:55], v[80:83]
    v_mov_b32_dpp v127, v250 row_newbcast:7 row_mask:0xf bank_mask:0xf
    v_mov_b32_dpp v248, v251 row_newbcast:0 row_mask:0xf bank_mask:0xf
    v_mfma_f32_16x16x32_bf16 v[84:87], v[236:239], v[52:55], v[84:87]
    v_mov_b32_dpp v249, v251 row_newbcast:1 row_mask:0xf bank_mask:0xf
    v_mov_b32_dpp v250, v251 row_newbcast:2 row_mask:0xf bank_mask:0xf
    v_mov_b32_dpp v252, v251 row_newbcast:4 row_mask:0xf bank_mask:0xf
    v_mov_b32_dpp v253, v251 row_newbcast:5 row_mask:0xf bank_mask:0xf
    v_mov_b32_dpp v254, v251 row_newbcast:6 row_mask:0xf bank_mask:0xf
    v_mov_b32_dpp v255, v251 row_newbcast:7 row_mask:0xf bank_mask:0xf
    v_mov_b32_dpp v251, v251 row_newbcast:3 row_mask:0xf bank_mask:0xf
    s_lshl_b32 s47, s38, 9
    s_add_u32 s47, s47, 65536
    v_lshrrev_b32 v32, 2, v1
    v_add_u32 v32, s47, v32
    ds_write2_b32 v32, v88, v92 offset1:64
    v_xor_b32 v33, 512, v32
    s_lshl_b32 s47, s44, 13
    s_add_u32 s47, s47, 0x10000
    s_lshl_b32 s46, s45, 1
    s_add_u32 s46, s46, s42
    s_mul_i32 s52, s44, 14
    s_add_u32 s52, s52, s46
    s_lshl_b32 s52, s52, 12
    s_add_u32 s52, s52, 0x500000
    s_lshl_b32 s3, s41, 11
    s_add_u32 s52, s52, s3
    s_lshl_b32 s46, s46, 9
    s_add_u32 s46, s46, s47
    v_fma_f32 v56, v104, v88, v56
    v_fma_f32 v57, v105, v88, v57
    v_fma_f32 v58, v106, v88, v58
    v_fma_f32 v59, v107, v88, v59
    v_fma_f32 v60, v108, v88, v60
    v_fma_f32 v61, v109, v88, v61
    v_fma_f32 v62, v110, v88, v62
    v_fma_f32 v63, v111, v88, v63
    v_mul_f32 v24, v56, v56
    v_mul_f32 v25, v57, v57
    v_mul_f32 v26, v58, v58
    v_mul_f32 v27, v59, v59
    v_mul_f32 v28, v60, v60
    v_mul_f32 v29, v61, v61
    v_mul_f32 v30, v62, v62
    v_mul_f32 v31, v63, v63
    v_fma_f32 v24, v24, v248, v120
    v_fma_f32 v25, v25, v249, v121
    v_fma_f32 v26, v26, v250, v122
    v_fma_f32 v27, v27, v251, v123
    v_fma_f32 v28, v28, v252, v124
    v_fma_f32 v29, v29, v253, v125
    v_fma_f32 v30, v30, v254, v126
    v_fma_f32 v31, v31, v255, v127
    v_mul_f32 v24, v24, v56
    v_mul_f32 v25, v25, v57
    v_mul_f32 v26, v26, v58
    v_mul_f32 v27, v27, v59
    v_mul_f32 v28, v28, v60
    v_mul_f32 v29, v29, v61
    v_mul_f32 v30, v30, v62
    v_mul_f32 v31, v31, v63
    v_exp_f32 v24, v24
    v_exp_f32 v25, v25
    v_exp_f32 v26, v26
    v_exp_f32 v27, v27
    v_exp_f32 v28, v28
    v_exp_f32 v29, v29
    v_exp_f32 v30, v30
    v_exp_f32 v31, v31
    v_fma_f32 v24, v24, v112, v112
    v_fma_f32 v25, v25, v113, v113
    v_fma_f32 v26, v26, v114, v114
    v_fma_f32 v27, v27, v115, v115
    v_fma_f32 v28, v28, v116, v116
    v_fma_f32 v29, v29, v117, v117
    v_fma_f32 v30, v30, v118, v118
    v_fma_f32 v31, v31, v119, v119
    v_rcp_f32 v24, v24
    v_rcp_f32 v25, v25
    v_rcp_f32 v26, v26
    v_rcp_f32 v27, v27
    v_rcp_f32 v28, v28
    v_rcp_f32 v29, v29
    v_rcp_f32 v30, v30
    v_rcp_f32 v31, v31
    v_mul_f32 v56, v56, v24
    v_mul_f32 v57, v57, v25
    v_mul_f32 v58, v58, v26
    v_mul_f32 v59, v59, v27
    v_mul_f32 v60, v60, v28
    v_mul_f32 v61, v61, v29
    v_mul_f32 v62, v62, v30
    v_mul_f32 v63, v63, v31
    v_mul_f32 v48, v56, v56
    v_mul_f32 v49, v57, v57
    v_mul_f32 v50, v58, v58
    v_mul_f32 v51, v59, v59
    v_mul_f32 v52, v60, v60
    v_mul_f32 v53, v61, v61
    v_mul_f32 v54, v62, v62
    v_mul_f32 v55, v63, v63
    s_waitcnt lgkmcnt(0)
    s_barrier
    ds_read_b32 v96, v33 offset:0
    ds_read_b32 v100, v33 offset:256
    v_pk_fma_f32 v[64:65], v[104:105], v[92:93], v[64:65] op_sel:[0,0,0] op_sel_hi:[1,0,1]
    v_pk_fma_f32 v[66:67], v[106:107], v[92:93], v[66:67] op_sel:[0,0,0] op_sel_hi:[1,0,1]
    v_pk_fma_f32 v[68:69], v[108:109], v[92:93], v[68:69] op_sel:[0,0,0] op_sel_hi:[1,0,1]
    v_pk_fma_f32 v[70:71], v[110:111], v[92:93], v[70:71] op_sel:[0,0,0] op_sel_hi:[1,0,1]
    v_pk_mul_f32 v[24:25], v[64:65], v[64:65] op_sel:[0,0] op_sel_hi:[1,1]
    v_pk_mul_f32 v[26:27], v[66:67], v[66:67] op_sel:[0,0] op_sel_hi:[1,1]
    v_pk_mul_f32 v[28:29], v[68:69], v[68:69] op_sel:[0,0] op_sel_hi:[1,1]
    v_pk_mul_f32 v[30:31], v[70:71], v[70:71] op_sel:[0,0] op_sel_hi:[1,1]
    v_pk_fma_f32 v[24:25], v[24:25], v[248:249], v[120:121] op_sel:[0,0,0] op_sel_hi:[1,1,1]
    v_pk_fma_f32 v[26:27], v[26:27], v[250:251], v[122:123] op_sel:[0,0,0] op_sel_hi:[1,1,1]
    v_pk_fma_f32 v[28:29], v[28:29], v[252:253], v[124:125] op_sel:[0,0,0] op_sel_hi:[1,1,1]
    v_pk_fma_f32 v[30:31], v[30:31], v[254:255], v[126:127] op_sel:[0,0,0] op_sel_hi:[1,1,1]
    v_pk_mul_f32 v[24:25], v[24:25], v[64:65] op_sel:[0,0] op_sel_hi:[1,1]
    v_pk_mul_f32 v[26:27], v[26:27], v[66:67] op_sel:[0,0] op_sel_hi:[1,1]
    v_pk_mul_f32 v[28:29], v[28:29], v[68:69] op_sel:[0,0] op_sel_hi:[1,1]
    v_pk_mul_f32 v[30:31], v[30:31], v[70:71] op_sel:[0,0] op_sel_hi:[1,1]
    v_exp_f32 v24, v24
    v_exp_f32 v25, v25
    v_exp_f32 v26, v26
    v_exp_f32 v27, v27
    v_exp_f32 v28, v28
    v_exp_f32 v29, v29
    v_exp_f32 v30, v30
    v_exp_f32 v31, v31
    v_pk_fma_f32 v[24:25], v[24:25], v[112:113], v[112:113] op_sel:[0,0,0] op_sel_hi:[1,1,1]
    v_pk_fma_f32 v[26:27], v[26:27], v[114:115], v[114:115] op_sel:[0,0,0] op_sel_hi:[1,1,1]
    v_pk_fma_f32 v[28:29], v[28:29], v[116:117], v[116:117] op_sel:[0,0,0] op_sel_hi:[1,1,1]
    v_pk_fma_f32 v[30:31], v[30:31], v[118:119], v[118:119] op_sel:[0,0,0] op_sel_hi:[1,1,1]
    v_rcp_f32 v24, v24
    v_rcp_f32 v25, v25
    v_rcp_f32 v26, v26
    v_rcp_f32 v27, v27
    v_rcp_f32 v28, v28
    v_rcp_f32 v29, v29
    v_rcp_f32 v30, v30
    v_rcp_f32 v31, v31
    v_pk_mul_f32 v[64:65], v[64:65], v[24:25] op_sel:[0,0] op_sel_hi:[1,1]
    v_pk_mul_f32 v[66:67], v[66:67], v[26:27] op_sel:[0,0] op_sel_hi:[1,1]
    v_pk_mul_f32 v[68:69], v[68:69], v[28:29] op_sel:[0,0] op_sel_hi:[1,1]
    v_pk_mul_f32 v[70:71], v[70:71], v[30:31] op_sel:[0,0] op_sel_hi:[1,1]
    v_pk_fma_f32 v[48:49], v[64:65], v[64:65], v[48:49] op_sel:[0,0,0] op_sel_hi:[1,1,1]
    v_pk_fma_f32 v[50:51], v[66:67], v[66:67], v[50:51] op_sel:[0,0,0] op_sel_hi:[1,1,1]
    v_pk_fma_f32 v[52:53], v[68:69], v[68:69], v[52:53] op_sel:[0,0,0] op_sel_hi:[1,1,1]
    v_pk_fma_f32 v[54:55], v[70:71], v[70:71], v[54:55] op_sel:[0,0,0] op_sel_hi:[1,1,1]
    v_pk_add_f32 v[40:41], v[64:65], v[56:57] op_sel:[0,0] op_sel_hi:[1,1]
    v_pk_add_f32 v[42:43], v[66:67], v[58:59] op_sel:[0,0] op_sel_hi:[1,1]
    v_pk_add_f32 v[44:45], v[68:69], v[60:61] op_sel:[0,0] op_sel_hi:[1,1]
    v_pk_add_f32 v[46:47], v[70:71], v[62:63] op_sel:[0,0] op_sel_hi:[1,1]
    s_waitcnt lgkmcnt(0)
    v_pk_fma_f32 v[72:73], v[104:105], v[96:97], v[72:73] op_sel:[0,0,0] op_sel_hi:[1,0,1]
    v_pk_fma_f32 v[74:75], v[106:107], v[96:97], v[74:75] op_sel:[0,0,0] op_sel_hi:[1,0,1]
    v_pk_fma_f32 v[76:77], v[108:109], v[96:97], v[76:77] op_sel:[0,0,0] op_sel_hi:[1,0,1]
    v_pk_fma_f32 v[78:79], v[110:111], v[96:97], v[78:79] op_sel:[0,0,0] op_sel_hi:[1,0,1]
    v_pk_mul_f32 v[24:25], v[72:73], v[72:73] op_sel:[0,0] op_sel_hi:[1,1]
    v_pk_mul_f32 v[26:27], v[74:75], v[74:75] op_sel:[0,0] op_sel_hi:[1,1]
    v_pk_mul_f32 v[28:29], v[76:77], v[76:77] op_sel:[0,0] op_sel_hi:[1,1]
    v_pk_mul_f32 v[30:31], v[78:79], v[78:79] op_sel:[0,0] op_sel_hi:[1,1]
    v_pk_fma_f32 v[24:25], v[24:25], v[248:249], v[120:121] op_sel:[0,0,0] op_sel_hi:[1,1,1]
    v_pk_fma_f32 v[26:27], v[26:27], v[250:251], v[122:123] op_sel:[0,0,0] op_sel_hi:[1,1,1]
    v_pk_fma_f32 v[28:29], v[28:29], v[252:253], v[124:125] op_sel:[0,0,0] op_sel_hi:[1,1,1]
    v_pk_fma_f32 v[30:31], v[30:31], v[254:255], v[126:127] op_sel:[0,0,0] op_sel_hi:[1,1,1]
    v_pk_mul_f32 v[24:25], v[24:25], v[72:73] op_sel:[0,0] op_sel_hi:[1,1]
    v_pk_mul_f32 v[26:27], v[26:27], v[74:75] op_sel:[0,0] op_sel_hi:[1,1]
    v_pk_mul_f32 v[28:29], v[28:29], v[76:77] op_sel:[0,0] op_sel_hi:[1,1]
    v_pk_mul_f32 v[30:31], v[30:31], v[78:79] op_sel:[0,0] op_sel_hi:[1,1]
    v_exp_f32 v24, v24
    v_exp_f32 v25, v25
    v_exp_f32 v26, v26
    v_exp_f32 v27, v27
    v_exp_f32 v28, v28
    v_exp_f32 v29, v29
    v_exp_f32 v30, v30
    v_exp_f32 v31, v31
    v_pk_fma_f32 v[24:25], v[24:25], v[112:113], v[112:113] op_sel:[0,0,0] op_sel_hi:[1,1,1]
    v_pk_fma_f32 v[26:27], v[26:27], v[114:115], v[114:115] op_sel:[0,0,0] op_sel_hi:[1,1,1]
    v_pk_fma_f32 v[28:29], v[28:29], v[116:117], v[116:117] op_sel:[0,0,0] op_sel_hi:[1,1,1]
    v_pk_fma_f32 v[30:31], v[30:31], v[118:119], v[118:119] op_sel:[0,0,0] op_sel_hi:[1,1,1]
    v_rcp_f32 v24, v24
    v_rcp_f32 v25, v25
    v_rcp_f32 v26, v26
    v_rcp_f32 v27, v27
    v_rcp_f32 v28, v28
    v_rcp_f32 v29, v29
    v_rcp_f32 v30, v30
    v_rcp_f32 v31, v31
    v_pk_mul_f32 v[72:73], v[72:73], v[24:25] op_sel:[0,0] op_sel_hi:[1,1]
    v_pk_mul_f32 v[74:75], v[74:75], v[26:27] op_sel:[0,0] op_sel_hi:[1,1]
    v_pk_mul_f32 v[76:77], v[76:77], v[28:29] op_sel:[0,0] op_sel_hi:[1,1]
    v_pk_mul_f32 v[78:79], v[78:79], v[30:31] op_sel:[0,0] op_sel_hi:[1,1]
    v_pk_fma_f32 v[48:49], v[72:73], v[72:73], v[48:49] op_sel:[0,0,0] op_sel_hi:[1,1,1]
    v_pk_fma_f32 v[50:51], v[74:75], v[74:75], v[50:51] op_sel:[0,0,0] op_sel_hi:[1,1,1]
    v_pk_fma_f32 v[52:53], v[76:77], v[76:77], v[52:53] op_sel:[0,0,0] op_sel_hi:[1,1,1]
    v_pk_fma_f32 v[54:55], v[78:79], v[78:79], v[54:55] op_sel:[0,0,0] op_sel_hi:[1,1,1]
    v_pk_add_f32 v[40:41], v[72:73], v[40:41] op_sel:[0,0] op_sel_hi:[1,1]
    v_pk_add_f32 v[42:43], v[74:75], v[42:43] op_sel:[0,0] op_sel_hi:[1,1]
    v_pk_add_f32 v[44:45], v[76:77], v[44:45] op_sel:[0,0] op_sel_hi:[1,1]
    v_pk_add_f32 v[46:47], v[78:79], v[46:47] op_sel:[0,0] op_sel_hi:[1,1]
    v_pk_fma_f32 v[80:81], v[104:105], v[100:101], v[80:81] op_sel:[0,0,0] op_sel_hi:[1,0,1]
    v_pk_fma_f32 v[82:83], v[106:107], v[100:101], v[82:83] op_sel:[0,0,0] op_sel_hi:[1,0,1]
    v_pk_fma_f32 v[84:85], v[108:109], v[100:101], v[84:85] op_sel:[0,0,0] op_sel_hi:[1,0,1]
    v_pk_fma_f32 v[86:87], v[110:111], v[100:101], v[86:87] op_sel:[0,0,0] op_sel_hi:[1,0,1]
    v_pk_mul_f32 v[24:25], v[80:81], v[80:81] op_sel:[0,0] op_sel_hi:[1,1]
    v_pk_mul_f32 v[26:27], v[82:83], v[82:83] op_sel:[0,0] op_sel_hi:[1,1]
    v_pk_mul_f32 v[28:29], v[84:85], v[84:85] op_sel:[0,0] op_sel_hi:[1,1]
    v_pk_mul_f32 v[30:31], v[86:87], v[86:87] op_sel:[0,0] op_sel_hi:[1,1]
    v_pk_fma_f32 v[24:25], v[24:25], v[248:249], v[120:121] op_sel:[0,0,0] op_sel_hi:[1,1,1]
    v_pk_fma_f32 v[26:27], v[26:27], v[250:251], v[122:123] op_sel:[0,0,0] op_sel_hi:[1,1,1]
    v_pk_fma_f32 v[28:29], v[28:29], v[252:253], v[124:125] op_sel:[0,0,0] op_sel_hi:[1,1,1]
    v_pk_fma_f32 v[30:31], v[30:31], v[254:255], v[126:127] op_sel:[0,0,0] op_sel_hi:[1,1,1]
    v_pk_mul_f32 v[24:25], v[24:25], v[80:81] op_sel:[0,0] op_sel_hi:[1,1]
    v_pk_mul_f32 v[26:27], v[26:27], v[82:83] op_sel:[0,0] op_sel_hi:[1,1]
    v_pk_mul_f32 v[28:29], v[28:29], v[84:85] op_sel:[0,0] op_sel_hi:[1,1]
    v_pk_mul_f32 v[30:31], v[30:31], v[86:87] op_sel:[0,0] op_sel_hi:[1,1]
    v_exp_f32 v24, v24
    v_exp_f32 v25, v25
    v_exp_f32 v26, v26
    v_exp_f32 v27, v27
    v_exp_f32 v28, v28
    v_exp_f32 v29, v29
    v_exp_f32 v30, v30
    v_exp_f32 v31, v31
    v_pk_fma_f32 v[24:25], v[24:25], v[112:113], v[112:113] op_sel:[0,0,0] op_sel_hi:[1,1,1]
    v_pk_fma_f32 v[26:27], v[26:27], v[114:115], v[114:115] op_sel:[0,0,0] op_sel_hi:[1,1,1]
    v_pk_fma_f32 v[28:29], v[28:29], v[116:117], v[116:117] op_sel:[0,0,0] op_sel_hi:[1,1,1]
    v_pk_fma_f32 v[30:31], v[30:31], v[118:119], v[118:119] op_sel:[0,0,0] op_sel_hi:[1,1,1]
    v_rcp_f32 v24, v24
    v_rcp_f32 v25, v25
    v_rcp_f32 v26, v26
    v_rcp_f32 v27, v27
    v_rcp_f32 v28, v28
    v_rcp_f32 v29, v29
    v_rcp_f32 v30, v30
    v_rcp_f32 v31, v31
    v_pk_mul_f32 v[80:81], v[80:81], v[24:25] op_sel:[0,0] op_sel_hi:[1,1]
    v_pk_mul_f32 v[82:83], v[82:83], v[26:27] op_sel:[0,0] op_sel_hi:[1,1]
    v_pk_mul_f32 v[84:85], v[84:85], v[28:29] op_sel:[0,0] op_sel_hi:[1,1]
    v_pk_mul_f32 v[86:87], v[86:87], v[30:31] op_sel:[0,0] op_sel_hi:[1,1]
    v_pk_fma_f32 v[48:49], v[80:81], v[80:81], v[48:49] op_sel:[0,0,0] op_sel_hi:[1,1,1]
    v_pk_fma_f32 v[50:51], v[82:83], v[82:83], v[50:51] op_sel:[0,0,0] op_sel_hi:[1,1,1]
    v_pk_fma_f32 v[52:53], v[84:85], v[84:85], v[52:53] op_sel:[0,0,0] op_sel_hi:[1,1,1]
    v_pk_fma_f32 v[54:55], v[86:87], v[86:87], v[54:55] op_sel:[0,0,0] op_sel_hi:[1,1,1]
    v_pk_add_f32 v[40:41], v[80:81], v[40:41] op_sel:[0,0] op_sel_hi:[1,1]
    v_pk_add_f32 v[42:43], v[82:83], v[42:43] op_sel:[0,0] op_sel_hi:[1,1]
    v_pk_add_f32 v[44:45], v[84:85], v[44:45] op_sel:[0,0] op_sel_hi:[1,1]
    v_pk_add_f32 v[46:47], v[86:87], v[46:47] op_sel:[0,0] op_sel_hi:[1,1]
    v_mov_b32 v254, s36
    v_mov_b32 v255, s37
    v_add_f32_dpp v48, v48, v48 row_ror:8 row_mask:0xf bank_mask:0x3
    v_add_f32_dpp v40, v40, v40 row_ror:8 row_mask:0xf bank_mask:0x3
    v_add_f32_dpp v49, v49, v49 row_ror:8 row_mask:0xf bank_mask:0x3
    v_add_f32_dpp v41, v41, v41 row_ror:8 row_mask:0xf bank_mask:0x3
    v_add_f32_dpp v50, v50, v50 row_ror:8 row_mask:0xf bank_mask:0x3
    v_add_f32_dpp v42, v42, v42 row_ror:8 row_mask:0xf bank_mask:0x3
    v_add_f32_dpp v51, v51, v51 row_ror:8 row_mask:0xf bank_mask:0x3
    v_add_f32_dpp v43, v43, v43 row_ror:8 row_mask:0xf bank_mask:0x3
    v_add_f32_dpp v48, v52, v52 row_ror:8 row_mask:0xf bank_mask:0xc
    v_add_f32_dpp v40, v44, v44 row_ror:8 row_mask:0xf bank_mask:0xc
    v_add_f32_dpp v49, v53, v53 row_ror:8 row_mask:0xf bank_mask:0xc
    v_add_f32_dpp v41, v45, v45 row_ror:8 row_mask:0xf bank_mask:0xc
    v_add_f32_dpp v50, v54, v54 row_ror:8 row_mask:0xf bank_mask:0xc
    v_add_f32_dpp v42, v46, v46 row_ror:8 row_mask:0xf bank_mask:0xc
    v_add_f32_dpp v51, v55, v55 row_ror:8 row_mask:0xf bank_mask:0xc
    v_add_f32_dpp v43, v47, v47 row_ror:8 row_mask:0xf bank_mask:0xc
    v_add_f32_dpp v48, v48, v48 row_half_mirror row_mask:0xf bank_mask:0x5
    v_add_f32_dpp v40, v40, v40 row_half_mirror row_mask:0xf bank_mask:0x5
    v_add_f32_dpp v49, v49, v49 row_half_mirror row_mask:0xf bank_mask:0x5
    v_add_f32_dpp v41, v41, v41 row_half_mirror row_mask:0xf bank_mask:0x5
    v_add_f32_dpp v48, v50, v50 row_half_mirror row_mask:0xf bank_mask:0xa
    v_add_f32_dpp v40, v42, v42 row_half_mirror row_mask:0xf bank_mask:0xa
    v_add_f32_dpp v49, v51, v51 row_half_mirror row_mask:0xf bank_mask:0xa
    v_add_f32_dpp v41, v43, v43 row_half_mirror row_mask:0xf bank_mask:0xa
    s_mov_b32 vcc_lo, 0xaaaaaaaa
    s_mov_b32 vcc_hi, 0xaaaaaaaa
    v_add_f32_dpp v48, v48, v48 quad_perm:[2,3,0,1] row_mask:0xf bank_mask:0xf
    v_add_f32_dpp v40, v40, v40 quad_perm:[2,3,0,1] row_mask:0xf bank_mask:0xf
    v_add_f32_dpp v49, v49, v49 quad_perm:[2,3,0,1] row_mask:0xf bank_mask:0xf
    v_add_f32_dpp v41, v41, v41 quad_perm:[2,3,0,1] row_mask:0xf bank_mask:0xf
    v_add_f32_dpp v48, v48, v48 quad_perm:[1,0,3,2] row_mask:0xf bank_mask:0xf
    v_add_f32_dpp v40, v40, v40 quad_perm:[1,0,3,2] row_mask:0xf bank_mask:0xf
    v_add_f32_dpp v49, v49, v49 quad_perm:[1,0,3,2] row_mask:0xf bank_mask:0xf
    v_add_f32_dpp v41, v41, v41 quad_perm:[1,0,3,2] row_mask:0xf bank_mask:0xf
    v_cndmask_b32 v253, v48, v49, vcc
    v_cndmask_b32 v252, v40, v41, vcc
    s_mov_b32 exec_lo, 0x33333333
    s_mov_b32 exec_hi, 0x33333333
    buffer_store_dwordx4 v[252:255], v15, s[24:27], s46 offen sc1
    s_mov_b64 exec, -1
    s_waitcnt vmcnt(12)
    s_barrier
    ds_read_b64_tr_b16 v[24:25], v240 offset:32768
    ds_read_b64_tr_b16 v[26:27], v240 offset:33792
    ds_read_b64_tr_b16 v[28:29], v241 offset:32768
    ds_read_b64_tr_b16 v[30:31], v241 offset:33792
    ds_read_b64_tr_b16 v[32:33], v242 offset:32768
    ds_read_b64_tr_b16 v[34:35], v242 offset:33792
    ds_read_b64_tr_b16 v[36:37], v243 offset:32768
    ds_read_b64_tr_b16 v[38:39], v243 offset:33792
    v_cvt_pk_bf16_f32 v104, v56, v57
    v_cvt_pk_bf16_f32 v105, v58, v59
    v_cvt_pk_bf16_f32 v106, v60, v61
    v_cvt_pk_bf16_f32 v107, v62, v63
    v_cvt_pk_bf16_f32 v108, v64, v65
    v_cvt_pk_bf16_f32 v109, v66, v67
    v_cvt_pk_bf16_f32 v110, v68, v69
    v_cvt_pk_bf16_f32 v111, v70, v71
    v_cvt_pk_bf16_f32 v112, v72, v73
    v_cvt_pk_bf16_f32 v113, v74, v75
    v_cvt_pk_bf16_f32 v114, v76, v77
    v_cvt_pk_bf16_f32 v115, v78, v79
    v_cvt_pk_bf16_f32 v116, v80, v81
    v_cvt_pk_bf16_f32 v117, v82, v83
    v_cvt_pk_bf16_f32 v118, v84, v85
    v_cvt_pk_bf16_f32 v119, v86, v87
    s_add_u32 s46, s47, 4096
    ds_read_b64_tr_b16 v[40:41], v244 offset:32768
    ds_read_b64_tr_b16 v[42:43], v244 offset:33792
    s_waitcnt lgkmcnt(8)
    v_mfma_f32_16x16x32_bf16 v[56:59], v[24:27], v[128:131], 0
    ds_read_b64_tr_b16 v[44:45], v245 offset:32768
    ds_read_b64_tr_b16 v[46:47], v245 offset:33792
    v_mfma_f32_16x16x32_bf16 v[60:63], v[24:27], v[132:135], 0
    ds_read_b64_tr_b16 v[48:49], v246 offset:32768
    ds_read_b64_tr_b16 v[50:51], v246 offset:33792
    v_mfma_f32_16x16x32_bf16 v[88:91], v[24:27], v[20:23], 0
    ds_read_b64_tr_b16 v[52:53], v247 offset:32768
    ds_read_b64_tr_b16 v[54:55], v247 offset:33792
    s_waitcnt lgkmcnt(12)
    v_mfma_f32_16x16x32_bf16 v[64:67], v[28:31], v[128:131], 0
    s_add_u32 m0, s55, 57344
    s_add_u32 s57, s57, 114688
    buffer_load_dwordx4 v8, s[20:23], s57 offen lds
    v_mfma_f32_16x16x32_bf16 v[68:71], v[28:31], v[132:135], 0
    buffer_load_dwordx4 v9, s[20:23], s57 offen offset:1024 lds
    v_mfma_f32_16x16x32_bf16 v[92:95], v[28:31], v[20:23], 0
    s_add_u32 m0, s55, 24576
    s_add_u32 s57, s57, 114688
    s_cmp_eq_u32 s57, 1605632
    s_cselect_b32 s57, 0, s57
    buffer_load_dwordx4 v8, s[20:23], s57 offen lds
    s_waitcnt lgkmcnt(10)
    v_mfma_f32_16x16x32_bf16 v[72:75], v[32:35], v[128:131], 0
    buffer_load_dwordx4 v9, s[20:23], s57 offen offset:1024 lds
    v_mfma_f32_16x16x32_bf16 v[76:79], v[32:35], v[132:135], 0
    s_add_u32 m0, s55, 65536
    s_add_u32 s57, s57, 114688
    buffer_load_dwordx4 v8, s[20:23], s57 offen lds
    s_waitcnt lgkmcnt(8)
    v_mfma_f32_16x16x32_bf16 v[80:83], v[36:39], v[128:131], 0
    buffer_load_dwordx4 v9, s[20:23], s57 offen offset:1024 lds
    v_mfma_f32_16x16x32_bf16 v[84:87], v[36:39], v[132:135], 0
    s_waitcnt lgkmcnt(6)
    v_mfma_f32_16x16x32_bf16 v[56:59], v[40:43], v[136:139], v[56:59]
    v_mfma_f32_16x16x32_bf16 v[60:63], v[40:43], v[140:143], v[60:63]
    s_waitcnt vmcnt(14)
    s_waitcnt lgkmcnt(0)
    s_barrier
    ds_read_b64_tr_b16 v[24:25], v240 offset:0
    ds_read_b64_tr_b16 v[26:27], v240 offset:1024
    v_mfma_f32_16x16x32_bf16 v[88:91], v[40:43], v[20:23], v[88:91]
    ds_read_b64_tr_b16 v[28:29], v241 offset:0
    ds_read_b64_tr_b16 v[30:31], v241 offset:1024
    v_mfma_f32_16x16x32_bf16 v[64:67], v[44:47], v[136:139], v[64:67]
    ds_read_b64_tr_b16 v[32:33], v242 offset:0
    ds_read_b64_tr_b16 v[34:35], v242 offset:1024
    v_mfma_f32_16x16x32_bf16 v[68:71], v[44:47], v[140:143], v[68:71]
    ds_read_b64_tr_b16 v[36:37], v243 offset:0
    ds_read_b64_tr_b16 v[38:39], v243 offset:1024
    v_mfma_f32_16x16x32_bf16 v[92:95], v[44:47], v[20:23], v[92:95]
    v_lshlrev_b32 v120, 16, v104
    v_and_b32 v121, 0xffff0000, v104
    v_mfma_f32_16x16x32_bf16 v[72:75], v[48:51], v[136:139], v[72:75]
    v_lshlrev_b32 v122, 16, v105
    v_and_b32 v123, 0xffff0000, v105
    v_mfma_f32_16x16x32_bf16 v[76:79], v[48:51], v[140:143], v[76:79]
    v_lshlrev_b32 v124, 16, v106
    v_and_b32 v125, 0xffff0000, v106
    v_mfma_f32_16x16x32_bf16 v[80:83], v[52:55], v[136:139], v[80:83]
    v_lshlrev_b32 v126, 16, v107
    v_and_b32 v127, 0xffff0000, v107
    v_mfma_f32_16x16x32_bf16 v[84:87], v[52:55], v[140:143], v[84:87]
    ds_read_b64_tr_b16 v[40:41], v244 offset:0
    ds_read_b64_tr_b16 v[42:43], v244 offset:1024
    s_waitcnt lgkmcnt(8)
    v_mfma_f32_16x16x32_bf16 v[56:59], v[24:27], v[144:147], v[56:59]
    ds_read_b64_tr_b16 v[44:45], v245 offset:0
    ds_read_b64_tr_b16 v[46:47], v245 offset:1024
    v_mfma_f32_16x16x32_bf16 v[60:63], v[24:27], v[148:151], v[60:63]
    ds_read_b64_tr_b16 v[48:49], v246 offset:0
    ds_read_b64_tr_b16 v[50:51], v246 offset:1024
    v_mfma_f32_16x16x32_bf16 v[88:91], v[24:27], v[20:23], v[88:91]
    ds_read_b64_tr_b16 v[52:53], v247 offset:0
    ds_read_b64_tr_b16 v[54:55], v247 offset:1024
    s_waitcnt lgkmcnt(12)
    v_mfma_f32_16x16x32_bf16 v[64:67], v[28:31], v[144:147], v[64:67]
    v_mfma_f32_16x16x32_bf16 v[68:71], v[28:31], v[148:151], v[68:71]
    v_mfma_f32_16x16x32_bf16 v[92:95], v[28:31], v[20:23], v[92:95]
    s_waitcnt lgkmcnt(10)
    v_mfma_f32_16x16x32_bf16 v[72:75], v[32:35], v[144:147], v[72:75]
    v_mfma_f32_16x16x32_bf16 v[76:79], v[32:35], v[148:151], v[76:79]
    s_waitcnt lgkmcnt(8)
    v_mfma_f32_16x16x32_bf16 v[80:83], v[36:39], v[144:147], v[80:83]
    v_mfma_f32_16x16x32_bf16 v[84:87], v[36:39], v[148:151], v[84:87]
    s_waitcnt lgkmcnt(6)
    v_mfma_f32_16x16x32_bf16 v[56:59], v[40:43], v[152:155], v[56:59]
    v_mfma_f32_16x16x32_bf16 v[60:63], v[40:43], v[156:159], v[60:63]
    s_waitcnt vmcnt(10)
    s_waitcnt lgkmcnt(0)
    s_barrier
    ds_read_b64_tr_b16 v[24:25], v240 offset:8192
    ds_read_b64_tr_b16 v[26:27], v240 offset:9216
    v_mfma_f32_16x16x32_bf16 v[88:91], v[40:43], v[20:23], v[88:91]
    ds_read_b64_tr_b16 v[28:29], v241 offset:8192
    ds_read_b64_tr_b16 v[30:31], v241 offset:9216
    v_mfma_f32_16x16x32_bf16 v[64:67], v[44:47], v[152:155], v[64:67]
    ds_read_b64_tr_b16 v[32:33], v242 offset:8192
    ds_read_b64_tr_b16 v[34:35], v242 offset:9216
    v_mfma_f32_16x16x32_bf16 v[68:71], v[44:47], v[156:159], v[68:71]
    ds_read_b64_tr_b16 v[36:37], v243 offset:8192
    ds_read_b64_tr_b16 v[38:39], v243 offset:9216
    v_mfma_f32_16x16x32_bf16 v[92:95], v[44:47], v[20:23], v[92:95]
    v_mfma_f32_16x16x32_bf16 v[72:75], v[48:51], v[152:155], v[72:75]
    v_mfma_f32_16x16x32_bf16 v[76:79], v[48:51], v[156:159], v[76:79]
    v_mfma_f32_16x16x32_bf16 v[80:83], v[52:55], v[152:155], v[80:83]
    v_mfma_f32_16x16x32_bf16 v[84:87], v[52:55], v[156:159], v[84:87]
    ds_read_b64_tr_b16 v[40:41], v244 offset:8192
    ds_read_b64_tr_b16 v[42:43], v244 offset:9216
    s_waitcnt lgkmcnt(8)
    v_mfma_f32_16x16x32_bf16 v[56:59], v[24:27], v[160:163], v[56:59]
    ds_read_b64_tr_b16 v[44:45], v245 offset:8192
    ds_read_b64_tr_b16 v[46:47], v245 offset:9216
    v_mfma_f32_16x16x32_bf16 v[60:63], v[24:27], v[164:167], v[60:63]
    ds_read_b64_tr_b16 v[48:49], v246 offset:8192
    ds_read_b64_tr_b16 v[50:51], v246 offset:9216
    v_mfma_f32_16x16x32_bf16 v[88:91], v[24:27], v[20:23], v[88:91]
    ds_read_b64_tr_b16 v[52:53], v247 offset:8192
    ds_read_b64_tr_b16 v[54:55], v247 offset:9216
    s_waitcnt lgkmcnt(12)
    v_mfma_f32_16x16x32_bf16 v[64:67], v[28:31], v[160:163], v[64:67]
    v_lshlrev_b32 v152, 16, v108
    v_and_b32 v153, 0xffff0000, v108
    v_mfma_f32_16x16x32_bf16 v[68:71], v[28:31], v[164:167], v[68:71]
    v_lshlrev_b32 v154, 16, v109
    v_and_b32 v155, 0xffff0000, v109
    v_mfma_f32_16x16x32_bf16 v[92:95], v[28:31], v[20:23], v[92:95]
    v_lshlrev_b32 v156, 16, v110
    v_and_b32 v157, 0xffff0000, v110
    s_waitcnt lgkmcnt(10)
    v_mfma_f32_16x16x32_bf16 v[72:75], v[32:35], v[160:163], v[72:75]
    v_lshlrev_b32 v158, 16, v111
    v_and_b32 v159, 0xffff0000, v111
    v_mfma_f32_16x16x32_bf16 v[76:79], v[32:35], v[164:167], v[76:79]
    s_waitcnt lgkmcnt(8)
    v_mfma_f32_16x16x32_bf16 v[80:83], v[36:39], v[160:163], v[80:83]
    v_mfma_f32_16x16x32_bf16 v[84:87], v[36:39], v[164:167], v[84:87]
    s_waitcnt lgkmcnt(6)
    v_mfma_f32_16x16x32_bf16 v[56:59], v[40:43], v[168:171], v[56:59]
    v_mfma_f32_16x16x32_bf16 v[60:63], v[40:43], v[172:175], v[60:63]
    s_waitcnt vmcnt(4)
    s_waitcnt lgkmcnt(0)
    s_barrier
    ds_read_b64_tr_b16 v[24:25], v240 offset:16384
    ds_read_b64_tr_b16 v[26:27], v240 offset:17408
    v_mfma_f32_16x16x32_bf16 v[88:91], v[40:43], v[20:23], v[88:91]
    ds_read_b64_tr_b16 v[28:29], v241 offset:16384
    ds_read_b64_tr_b16 v[30:31], v241 offset:17408
    v_mfma_f32_16x16x32_bf16 v[64:67], v[44:47], v[168:171], v[64:67]
    ds_read_b64_tr_b16 v[32:33], v242 offset:16384
    ds_read_b64_tr_b16 v[34:35], v242 offset:17408
    v_mfma_f32_16x16x32_bf16 v[68:71], v[44:47], v[172:175], v[68:71]
    ds_read_b64_tr_b16 v[36:37], v243 offset:16384
    ds_read_b64_tr_b16 v[38:39], v243 offset:17408
    v_mfma_f32_16x16x32_bf16 v[92:95], v[44:47], v[20:23], v[92:95]
    s_add_u32 m0, s55, 32768
    s_add_u32 s57, s57, 114688
    s_cmp_eq_u32 s57, 1605632
    s_cselect_b32 s57, 0, s57
    buffer_load_dwordx4 v8, s[20:23], s57 offen lds
    v_mfma_f32_16x16x32_bf16 v[72:75], v[48:51], v[168:171], v[72:75]
    buffer_load_dwordx4 v9, s[20:23], s57 offen offset:1024 lds
    v_mfma_f32_16x16x32_bf16 v[76:79], v[48:51], v[172:175], v[76:79]
    s_add_u32 m0, s55, 73728
    s_add_u32 s57, s57, 114688
    buffer_load_dwordx4 v8, s[20:23], s57 offen lds
    v_mfma_f32_16x16x32_bf16 v[80:83], v[52:55], v[168:171], v[80:83]
    buffer_load_dwordx4 v9, s[20:23], s57 offen offset:1024 lds
    v_mfma_f32_16x16x32_bf16 v[84:87], v[52:55], v[172:175], v[84:87]
    v_lshlrev_b32 v160, 16, v112
    v_and_b32 v161, 0xffff0000, v112
    v_lshlrev_b32 v162, 16, v113
    v_and_b32 v163, 0xffff0000, v113
    v_lshlrev_b32 v164, 16, v114
    v_and_b32 v165, 0xffff0000, v114
    v_lshlrev_b32 v166, 16, v115
    v_and_b32 v167, 0xffff0000, v115
    ds_read_b64_tr_b16 v[40:41], v244 offset:16384
    ds_read_b64_tr_b16 v[42:43], v244 offset:17408
    s_waitcnt lgkmcnt(8)
    v_mfma_f32_16x16x32_bf16 v[56:59], v[24:27], v[176:179], v[56:59]
    ds_read_b64_tr_b16 v[44:45], v245 offset:16384
    ds_read_b64_tr_b16 v[46:47], v245 offset:17408
    v_mfma_f32_16x16x32_bf16 v[60:63], v[24:27], v[180:183], v[60:63]
    ds_read_b64_tr_b16 v[48:49], v246 offset:16384
    ds_read_b64_tr_b16 v[50:51], v246 offset:17408
    v_mfma_f32_16x16x32_bf16 v[88:91], v[24:27], v[20:23], v[88:91]
    ds_read_b64_tr_b16 v[52:53], v247 offset:16384
    ds_read_b64_tr_b16 v[54:55], v247 offset:17408
    s_waitcnt lgkmcnt(12)
    v_mfma_f32_16x16x32_bf16 v[64:67], v[28:31], v[176:179], v[64:67]
    buffer_load_dwordx4 v[128:131], v19, s[24:27], s47 offen offset:0 sc1
    v_mfma_f32_16x16x32_bf16 v[68:71], v[28:31], v[180:183], v[68:71]
    buffer_load_dwordx4 v[132:135], v19, s[24:27], s47 offen offset:1024 sc1
    v_mfma_f32_16x16x32_bf16 v[92:95], v[28:31], v[20:23], v[92:95]
    buffer_load_dwordx4 v[136:139], v19, s[24:27], s47 offen offset:2048 sc1
    s_waitcnt lgkmcnt(10)
    v_mfma_f32_16x16x32_bf16 v[72:75], v[32:35], v[176:179], v[72:75]
    buffer_load_dwordx4 v[140:143], v19, s[24:27], s47 offen offset:3072 sc1
    v_mfma_f32_16x16x32_bf16 v[76:79], v[32:35], v[180:183], v[76:79]
    buffer_load_dwordx4 v[144:147], v19, s[24:27], s46 offen offset:0 sc1
    s_waitcnt lgkmcnt(8)
    v_mfma_f32_16x16x32_bf16 v[80:83], v[36:39], v[176:179], v[80:83]
    buffer_load_dwordx4 v[148:151], v19, s[24:27], s46 offen offset:1024 sc1
    v_mfma_f32_16x16x32_bf16 v[84:87], v[36:39], v[180:183], v[84:87]
    v_lshlrev_b32 v168, 16, v116
    v_and_b32 v169, 0xffff0000, v116
    v_lshlrev_b32 v170, 16, v117
    v_and_b32 v171, 0xffff0000, v117
    v_lshlrev_b32 v172, 16, v118
    v_and_b32 v173, 0xffff0000, v118
    v_lshlrev_b32 v174, 16, v119
    v_and_b32 v175, 0xffff0000, v119
    buffer_load_dwordx4 v[248:251], v19, s[24:27], s46 offen offset:2048 sc1
    s_waitcnt lgkmcnt(6)
    v_mfma_f32_16x16x32_bf16 v[56:59], v[40:43], v[184:187], v[56:59]
    v_mfma_f32_16x16x32_bf16 v[60:63], v[40:43], v[188:191], v[60:63]
    s_waitcnt vmcnt(11)
    s_waitcnt lgkmcnt(0)
    s_barrier
    ds_read_b64_tr_b16 v[24:25], v240 offset:24576
    ds_read_b64_tr_b16 v[26:27], v240 offset:25600
    v_mfma_f32_16x16x32_bf16 v[88:91], v[40:43], v[20:23], v[88:91]
    ds_read_b64_tr_b16 v[28:29], v241 offset:24576
    ds_read_b64_tr_b16 v[30:31], v241 offset:25600
    v_mfma_f32_16x16x32_bf16 v[64:67], v[44:47], v[184:187], v[64:67]
    ds_read_b64_tr_b16 v[32:33], v242 offset:24576
    ds_read_b64_tr_b16 v[34:35], v242 offset:25600
    v_mfma_f32_16x16x32_bf16 v[68:71], v[44:47], v[188:191], v[68:71]
    ds_read_b64_tr_b16 v[36:37], v243 offset:24576
    ds_read_b64_tr_b16 v[38:39], v243 offset:25600
    v_mfma_f32_16x16x32_bf16 v[92:95], v[44:47], v[20:23], v[92:95]
    s_add_u32 m0, s55, 0
    s_add_u32 s57, s57, 114688
    s_cmp_eq_u32 s57, 1605632
    s_cselect_b32 s57, 0, s57
    buffer_load_dwordx4 v8, s[20:23], s57 offen lds
    v_mfma_f32_16x16x32_bf16 v[72:75], v[48:51], v[184:187], v[72:75]
    buffer_load_dwordx4 v9, s[20:23], s57 offen offset:1024 lds
    v_mfma_f32_16x16x32_bf16 v[76:79], v[48:51], v[188:191], v[76:79]
    s_add_u32 m0, s55, 40960
    s_add_u32 s57, s57, 114688
    buffer_load_dwordx4 v8, s[20:23], s57 offen lds
    v_mfma_f32_16x16x32_bf16 v[80:83], v[52:55], v[184:187], v[80:83]
    buffer_load_dwordx4 v9, s[20:23], s57 offen offset:1024 lds
    v_mfma_f32_16x16x32_bf16 v[84:87], v[52:55], v[188:191], v[84:87]
    s_lshl_b32 s51, s45, 5
    s_add_u32 s51, s51, s39
    s_lshl_b32 s51, s51, 7
    s_add_u32 s51, s51, 0xa0000
    s_waitcnt vmcnt(4)
    v_cmp_ne_u64 s[62:63], v[130:131], s[36:37]
    v_cmp_ne_u64 s[64:65], v[134:135], s[36:37]
    s_nop 0
    s_or_b64 s[62:63], s[62:63], s[64:65]
    v_cmp_ne_u64 s[64:65], v[138:139], s[36:37]
    s_nop 0
    s_or_b64 s[62:63], s[62:63], s[64:65]
    v_cmp_ne_u64 s[64:65], v[142:143], s[36:37]
    s_nop 0
    s_or_b64 s[62:63], s[62:63], s[64:65]
    v_cmp_ne_u64 s[64:65], v[146:147], s[36:37]
    s_nop 0
    s_or_b64 s[62:63], s[62:63], s[64:65]
    v_cmp_ne_u64 s[64:65], v[150:151], s[36:37]
    s_nop 0
    s_or_b64 s[62:63], s[62:63], s[64:65]
    v_cmp_ne_u64 s[64:65], v[250:251], s[36:37]
    s_nop 0
    s_or_b64 s[62:63], s[62:63], s[64:65]
    s_cmp_eq_u64 s[62:63], 0
    s_cbranch_scc1 L_h1_ok
    s_mov_b32 s61, 16384
L_h1:
    buffer_load_dwordx4 v[128:131], v19, s[24:27], s47 offen offset:0 sc1
    buffer_load_dwordx4 v[132:135], v19, s[24:27], s47 offen offset:1024 sc1
    buffer_load_dwordx4 v[136:139], v19, s[24:27], s47 offen offset:2048 sc1
    buffer_load_dwordx4 v[140:143], v19, s[24:27], s47 offen offset:3072 sc1
    buffer_load_dwordx4 v[144:147], v19, s[24:27], s46 offen offset:0 sc1
    buffer_load_dwordx4 v[148:151], v19, s[24:27], s46 offen offset:1024 sc1
    buffer_load_dwordx4 v[248:251], v19, s[24:27], s46 offen offset:2048 sc1
    s_waitcnt vmcnt(0)
    v_cmp_ne_u64 s[62:63], v[130:131], s[36:37]
    v_cmp_ne_u64 s[64:65], v[134:135], s[36:37]
    s_nop 0
    s_or_b64 s[62:63], s[62:63], s[64:65]
    v_cmp_ne_u64 s[64:65], v[138:139], s[36:37]
    s_nop 0
    s_or_b64 s[62:63], s[62:63], s[64:65]
    v_cmp_ne_u64 s[64:65], v[142:143], s[36:37]
    s_nop 0
    s_or_b64 s[62:63], s[62:63], s[64:65]
    v_cmp_ne_u64 s[64:65], v[146:147], s[36:37]
    s_nop 0
    s_or_b64 s[62:63], s[62:63], s[64:65]
    v_cmp_ne_u64 s[64:65], v[150:151], s[36:37]
    s_nop 0
    s_or_b64 s[62:63], s[62:63], s[64:65]
    v_cmp_ne_u64 s[64:65], v[250:251], s[36:37]
    s_nop 0
    s_or_b64 s[62:63], s[62:63], s[64:65]
    s_cmp_eq_u64 s[62:63], 0
    s_cbranch_scc1 L_h1_ok
    s_sub_u32 s61, s61, 1
    s_cbranch_scc0 L_h1
L_h1_ok:
    v_add_f32 v128, v128, v132
    v_add_f32 v129, v129, v133
    v_add_f32 v136, v136, v140
    v_add_f32 v137, v137, v141
    v_add_f32 v144, v144, v148
    v_add_f32 v145, v145, v149
    v_add_f32 v128, v128, v248
    v_add_f32 v129, v129, v249
    v_add_f32 v136, v136, v144
    v_add_f32 v137, v137, v145
    v_add_f32 v128, v128, v136
    v_add_f32 v129, v129, v137
    s_nop 0
    v_add_f32_dpp v128, v128, v128 row_ror:8 row_mask:0xf bank_mask:0xf
    v_add_f32_dpp v129, v129, v129 row_ror:8 row_mask:0xf bank_mask:0xf
    v_mul_f32 v130, 0x3a924925, v128
    v_mul_f32 v131, 0x3a924925, v129
    v_fma_f32 v131, -v130, v130, v131
    v_max_f32 v131, 0, v131
    v_cvt_pk_bf16_f32 v132, 0, v130
    v_cvt_pk_bf16_f32 v131, 0, v131
    v_add_f32 v131, 0x3727c5ac, v131
    v_cvt_pk_bf16_f32 v131, 0, v131
    v_sqrt_f32 v131, v131
    s_nop 0
    v_cvt_pk_bf16_f32 v131, 0, v131
    v_rcp_f32 v133, v131
    s_nop 0
    v_mul_f32 v132, -v132, v133
    s_nop 0
    v_mov_b32_dpp v136, v133 row_newbcast:0 row_mask:0xf bank_mask:0xf
    v_mov_b32_dpp v137, v133 row_newbcast:1 row_mask:0xf bank_mask:0xf
    v_mov_b32_dpp v138, v133 row_newbcast:2 row_mask:0xf bank_mask:0xf
    v_mov_b32_dpp v139, v133 row_newbcast:3 row_mask:0xf bank_mask:0xf
    v_mov_b32_dpp v140, v133 row_newbcast:4 row_mask:0xf bank_mask:0xf
    v_mov_b32_dpp v141, v133 row_newbcast:5 row_mask:0xf bank_mask:0xf
    v_mov_b32_dpp v142, v133 row_newbcast:6 row_mask:0xf bank_mask:0xf
    v_mov_b32_dpp v143, v133 row_newbcast:7 row_mask:0xf bank_mask:0xf
    v_mov_b32_dpp v144, v132 row_newbcast:0 row_mask:0xf bank_mask:0xf
    v_mov_b32_dpp v145, v132 row_newbcast:1 row_mask:0xf bank_mask:0xf
    v_mov_b32_dpp v146, v132 row_newbcast:2 row_mask:0xf bank_mask:0xf
    v_mov_b32_dpp v147, v132 row_newbcast:3 row_mask:0xf bank_mask:0xf
    v_mov_b32_dpp v148, v132 row_newbcast:4 row_mask:0xf bank_mask:0xf
    v_mov_b32_dpp v149, v132 row_newbcast:5 row_mask:0xf bank_mask:0xf
    v_mov_b32_dpp v150, v132 row_newbcast:6 row_mask:0xf bank_mask:0xf
    v_mov_b32_dpp v151, v132 row_newbcast:7 row_mask:0xf bank_mask:0xf
    v_fma_f32 v120, v120, v136, v144
    v_fma_f32 v121, v121, v137, v145
    v_fma_f32 v122, v122, v138, v146
    v_fma_f32 v123, v123, v139, v147
    v_fma_f32 v124, v124, v140, v148
    v_fma_f32 v125, v125, v141, v149
    v_fma_f32 v126, v126, v142, v150
    v_fma_f32 v127, v127, v143, v151
    v_cvt_pk_bf16_f32 v104, v120, v121
    v_cvt_pk_bf16_f32 v105, v122, v123
    v_cvt_pk_bf16_f32 v106, v124, v125
    v_cvt_pk_bf16_f32 v107, v126, v127
    buffer_store_dwordx4 v[104:107], v1, s[24:27], s52 offen offset:0 sc1
    v_fma_f32 v152, v152, v136, v144
    v_fma_f32 v153, v153, v137, v145
    v_fma_f32 v154, v154, v138, v146
    v_fma_f32 v155, v155, v139, v147
    v_fma_f32 v156, v156, v140, v148
    v_fma_f32 v157, v157, v141, v149
    v_fma_f32 v158, v158, v142, v150
    v_fma_f32 v159, v159, v143, v151
    v_cvt_pk_bf16_f32 v108, v152, v153
    v_cvt_pk_bf16_f32 v109, v154, v155
    v_cvt_pk_bf16_f32 v110, v156, v157
    v_cvt_pk_bf16_f32 v111, v158, v159
    buffer_store_dwordx4 v[108:111], v1, s[24:27], s52 offen offset:1024 sc1
    s_lshl_b32 s3, s41, 12
    s_sub_u32 s52, s52, s3
    v_fma_f32 v160, v160, v136, v144
    v_fma_f32 v161, v161, v137, v145
    v_fma_f32 v162, v162, v138, v146
    v_fma_f32 v163, v163, v139, v147
    v_fma_f32 v164, v164, v140, v148
    v_fma_f32 v165, v165, v141, v149
    v_fma_f32 v166, v166, v142, v150
    v_fma_f32 v167, v167, v143, v151
    v_cvt_pk_bf16_f32 v112, v160, v161
    v_cvt_pk_bf16_f32 v113, v162, v163
    v_cvt_pk_bf16_f32 v114, v164, v165
    v_cvt_pk_bf16_f32 v115, v166, v167
    buffer_store_dwordx4 v[112:115], v1, s[24:27], s52 offen offset:2048 sc1
    v_fma_f32 v168, v168, v136, v144
    v_fma_f32 v169, v169, v137, v145
    v_fma_f32 v170, v170, v138, v146
    v_fma_f32 v171, v171, v139, v147
    v_fma_f32 v172, v172, v140, v148
    v_fma_f32 v173, v173, v141, v149
    v_fma_f32 v174, v174, v142, v150
    v_fma_f32 v175, v175, v143, v151
    v_cvt_pk_bf16_f32 v116, v168, v169
    v_cvt_pk_bf16_f32 v117, v170, v171
    v_cvt_pk_bf16_f32 v118, v172, v173
    v_cvt_pk_bf16_f32 v119, v174, v175
    buffer_store_dwordx4 v[116:119], v1, s[24:27], s52 offen offset:3072 sc1
    s_mov_b32 s50, s38
    s_branch L_join
L_spare:
    s_load_dwordx2 s[46:47], s[0:1], 88
    s_min_u32 s51, s39, 27
    s_mul_i32 s52, s51, 37
    s_lshr_b32 s52, s52, 8
    s_mul_i32 s3, s52, 7
    s_sub_u32 s3, s51, s3
    s_mul_i32 s48, s52, 112
    s_lshl_b32 s52, s3, 5
    s_add_u32 s52, s52, s48
    s_cmp_ge_u32 s3, 3
    s_cselect_b32 s61, 352, 0
    s_add_u32 s52, s52, s61
    s_mul_i32 s61, s42, 432
    s_add_u32 s48, s48, s61
    s_add_u32 s48, s48, 96
    s_cmp_eq_u32 s3, 6
    s_cselect_b32 s52, s48, s52
    s_lshl_b32 s3, s38, 3
    s_add_u32 s52, s52, s3
    s_mul_i32 s52, s52, 896
    v_lshrrev_b32 v24, 7, v1
    v_mul_u32_u24 v24, 896, v24
    v_and_b32 v25, 0x70, v1
    v_add_u32 v6, v24, v25
    s_lshl_b32 s3, s42, 9
    v_add_u32 v28, s3, v10
    v_add_u32 v29, s3, v11
    v_add_u32 v30, s3, v12
    v_add_u32 v31, s3, v13
    s_lshl_b32 s3, s42, 6
    v_lshl_add_u32 v18, v14, 4, s3
    s_lshl_b32 s50, s38, 10
    s_waitcnt lgkmcnt(0)
    s_mov_b32 s32, s46
    s_and_b32 s33, s47, 0xffff
    s_mov_b32 s34, 0xc4000
    s_mov_b32 s35, 0x20000
    s_add_u32 m0, s50, 8192
    s_nop 0
    buffer_load_dwordx4 v6, s[32:35], s52 offen offset:0 lds
    s_add_u32 m0, s50, 12160
    s_nop 0
    buffer_load_dwordx4 v6, s[32:35], s52 offen offset:128 lds
    s_add_u32 m0, s50, 48896
    s_nop 0
    buffer_load_dwordx4 v6, s[32:35], s52 offen offset:256 lds
    s_add_u32 m0, s50, 52864
    s_nop 0
    buffer_load_dwordx4 v6, s[32:35], s52 offen offset:384 lds
    s_add_u32 m0, s50, 15872
    s_nop 0
    buffer_load_dwordx4 v6, s[32:35], s52 offen offset:512 lds
    s_add_u32 m0, s50, 19840
    s_nop 0
    buffer_load_dwordx4 v6, s[32:35], s52 offen offset:640 lds
    s_add_u32 s36, s36, 2
    s_addc_u32 s37, s37, 0
    s_or_b32 s36, s36, 1
    v_mov_b32 v254, s36
    v_mov_b32 v255, s37
    v_lshrrev_b32 v24, 2, v2
    v_and_b32 v25, 3, v0
    v_and_b32 v26, 1, v3
    v_lshl_add_u32 v26, v26, 2, v25
    v_lshl_add_u32 v26, v26, 3, v24
    v_and_b32 v25, 1, v0
    v_lshl_add_u32 v24, v25, 2, v24
    s_lshl_b32 s3, s38, 1
    v_xor_b32 v24, s3, v24
    v_lshlrev_b32 v24, 4, v24
    v_lshl_add_u32 v24, v26, 7, v24
    v_lshrrev_b32 v27, 1, v3
    v_lshl_add_u32 v48, v27, 3, v24
    v_xor_b32 v49, 16, v48
    v_add_u32 v50, 40960, v48
    v_add_u32 v51, 40960, v49
    v_and_b32 v26, 0x1f0, v1
    v_lshl_add_u32 v52, v27, 14, v26
    s_lshl_b32 s46, s38, 16
    s_lshl_b32 s3, s39, 9
    s_add_u32 s46, s46, s3
    s_add_u32 s46, s46, 0x900000
    v_lshrrev_b32 v24, 6, v1
    v_lshlrev_b32 v24, 7, v24
    v_and_b32 v25, 48, v1
    s_lshl_b32 s3, s42, 6
    s_lshl_b32 s49, s41, 3
    s_add_u32 s3, s3, s49
    v_add3_u32 v53, v24, v25, s3
    v_add_u32 v54, 40960, v53
    s_mul_i32 s47, s38, 28
    s_add_u32 s47, s47, s51
    s_lshl_b32 s47, s47, 10
    s_add_u32 s47, s47, 0x1100000
    s_lshl_b32 s51, s39, 7
    s_add_u32 s51, s51, 0xa8000
    v_and_b32 v24, 2, v0
    v_and_b32 v25, 12, v0
    v_and_b32 v26, 1, v0
    v_lshlrev_b32 v24, 11, v24
    v_lshl_add_u32 v24, v25, 3, v24
    v_lshl_add_u32 v55, v26, 3, v24
    s_and_b32 s3, s44, 31
    s_lshl_b32 s3, s3, 7
    s_lshr_b32 s61, s44, 5
    s_lshl_b32 s61, s61, 4
    s_add_u32 s61, s61, s3
    s_lshl_b32 s3, s42, 13
    s_add_u32 s61, s61, s3
    s_add_u32 s61, s61, 0x4000
    v_mov_b32 v5, v127
    s_mov_b32 s48, 0x3f803f80
    s_waitcnt vmcnt(6)
    s_barrier
    ds_read_b128 v[56:59], v28 offset:0
    ds_read_b128 v[60:63], v29 offset:0
    ds_read_b128 v[64:67], v28 offset:24576
    ds_read_b128 v[68:71], v29 offset:24576
    ds_read_b128 v[72:75], v28 offset:32768
    ds_read_b128 v[76:79], v29 offset:32768
    ds_read_b128 v[80:83], v30 offset:0
    ds_read_b128 v[84:87], v31 offset:0
    ds_read_b128 v[88:91], v30 offset:16384
    ds_read_b128 v[92:95], v31 offset:16384
    ds_read_b128 v[96:99], v30 offset:24576
    ds_read_b128 v[100:103], v31 offset:24576
    ds_read_b128 v[104:107], v30 offset:32768
    ds_read_b128 v[108:111], v31 offset:32768
    s_waitcnt lgkmcnt(13)
    v_dot2_f32_bf16 v32, v56, s48, 0
    v_dot2_f32_bf16 v36, v56, v56, 0
    v_dot2_f32_bf16 v33, v57, s48, 0
    v_dot2_f32_bf16 v37, v57, v57, 0
    v_dot2_f32_bf16 v34, v58, s48, 0
    v_dot2_f32_bf16 v38, v58, v58, 0
    v_dot2_f32_bf16 v35, v59, s48, 0
    v_dot2_f32_bf16 v39, v59, v59, 0
    s_waitcnt lgkmcnt(12)
    v_dot2_f32_bf16 v32, v60, s48, v32
    v_dot2_f32_bf16 v36, v60, v60, v36
    v_dot2_f32_bf16 v33, v61, s48, v33
    v_dot2_f32_bf16 v37, v61, v61, v37
    v_dot2_f32_bf16 v34, v62, s48, v34
    v_dot2_f32_bf16 v38, v62, v62, v38
    v_dot2_f32_bf16 v35, v63, s48, v35
    v_dot2_f32_bf16 v39, v63, v63, v39
    s_waitcnt lgkmcnt(11)
    v_dot2_f32_bf16 v32, v64, s48, v32
    v_dot2_f32_bf16 v36, v64, v64, v36
    v_dot2_f32_bf16 v33, v65, s48, v33
    v_dot2_f32_bf16 v37, v65, v65, v37
    v_dot2_f32_bf16 v34, v66, s48, v34
    v_dot2_f32_bf16 v38, v66, v66, v38
    v_dot2_f32_bf16 v35, v67, s48, v35
    v_dot2_f32_bf16 v39, v67, v67, v39
    s_waitcnt lgkmcnt(10)
    v_dot2_f32_bf16 v32, v68, s48, v32
    v_dot2_f32_bf16 v36, v68, v68, v36
    v_dot2_f32_bf16 v33, v69, s48, v33
    v_dot2_f32_bf16 v37, v69, v69, v37
    v_dot2_f32_bf16 v34, v70, s48, v34
    v_dot2_f32_bf16 v38, v70, v70, v38
    v_dot2_f32_bf16 v35, v71, s48, v35
    v_dot2_f32_bf16 v39, v71, v71, v39
    s_waitcnt lgkmcnt(9)
    v_dot2_f32_bf16 v32, v72, s48, v32
    v_dot2_f32_bf16 v36, v72, v72, v36
    v_dot2_f32_bf16 v33, v73, s48, v33
    v_dot2_f32_bf16 v37, v73, v73, v37
    v_dot2_f32_bf16 v34, v74, s48, v34
    v_dot2_f32_bf16 v38, v74, v74, v38
    v_dot2_f32_bf16 v35, v75, s48, v35
    v_dot2_f32_bf16 v39, v75, v75, v39
    s_waitcnt lgkmcnt(8)
    v_dot2_f32_bf16 v32, v76, s48, v32
    v_dot2_f32_bf16 v36, v76, v76, v36
    v_dot2_f32_bf16 v33, v77, s48, v33
    v_dot2_f32_bf16 v37, v77, v77, v37
    v_dot2_f32_bf16 v34, v78, s48, v34
    v_dot2_f32_bf16 v38, v78, v78, v38
    v_dot2_f32_bf16 v35, v79, s48, v35
    v_dot2_f32_bf16 v39, v79, v79, v39
    s_waitcnt lgkmcnt(7)
    v_dot2_f32_bf16 v32, v80, s48, v32
    v_dot2_f32_bf16 v36, v80, v80, v36
    v_dot2_f32_bf16 v33, v81, s48, v33
    v_dot2_f32_bf16 v37, v81, v81, v37
    v_dot2_f32_bf16 v34, v82, s48, v34
    v_dot2_f32_bf16 v38, v82, v82, v38
    v_dot2_f32_bf16 v35, v83, s48, v35
    v_dot2_f32_bf16 v39, v83, v83, v39
    s_waitcnt lgkmcnt(6)
    v_dot2_f32_bf16 v32, v84, s48, v32
    v_dot2_f32_bf16 v36, v84, v84, v36
    v_dot2_f32_bf16 v33, v85, s48, v33
    v_dot2_f32_bf16 v37, v85, v85, v37
    v_dot2_f32_bf16 v34, v86, s48, v34
    v_dot2_f32_bf16 v38, v86, v86, v38
    v_dot2_f32_bf16 v35, v87, s48, v35
    v_dot2_f32_bf16 v39, v87, v87, v39
    s_waitcnt lgkmcnt(5)
    v_dot2_f32_bf16 v32, v88, s48, v32
    v_dot2_f32_bf16 v36, v88, v88, v36
    v_dot2_f32_bf16 v33, v89, s48, v33
    v_dot2_f32_bf16 v37, v89, v89, v37
    v_dot2_f32_bf16 v34, v90, s48, v34
    v_dot2_f32_bf16 v38, v90, v90, v38
    v_dot2_f32_bf16 v35, v91, s48, v35
    v_dot2_f32_bf16 v39, v91, v91, v39
    s_waitcnt lgkmcnt(4)
    v_dot2_f32_bf16 v32, v92, s48, v32
    v_dot2_f32_bf16 v36, v92, v92, v36
    v_dot2_f32_bf16 v33, v93, s48, v33
    v_dot2_f32_bf16 v37, v93, v93, v37
    v_dot2_f32_bf16 v34, v94, s48, v34
    v_dot2_f32_bf16 v38, v94, v94, v38
    v_dot2_f32_bf16 v35, v95, s48, v35
    v_dot2_f32_bf16 v39, v95, v95, v39
    s_waitcnt lgkmcnt(3)
    v_dot2_f32_bf16 v32, v96, s48, v32
    v_dot2_f32_bf16 v36, v96, v96, v36
    v_dot2_f32_bf16 v33, v97, s48, v33
    v_dot2_f32_bf16 v37, v97, v97, v37
    v_dot2_f32_bf16 v34, v98, s48, v34
    v_dot2_f32_bf16 v38, v98, v98, v38
    v_dot2_f32_bf16 v35, v99, s48, v35
    v_dot2_f32_bf16 v39, v99, v99, v39
    s_waitcnt lgkmcnt(2)
    v_dot2_f32_bf16 v32, v100, s48, v32
    v_dot2_f32_bf16 v36, v100, v100, v36
    v_dot2_f32_bf16 v33, v101, s48, v33
    v_dot2_f32_bf16 v37, v101, v101, v37
    v_dot2_f32_bf16 v34, v102, s48, v34
    v_dot2_f32_bf16 v38, v102, v102, v38
    v_dot2_f32_bf16 v35, v103, s48, v35
    v_dot2_f32_bf16 v39, v103, v103, v39
    s_waitcnt lgkmcnt(1)
    v_dot2_f32_bf16 v32, v104, s48, v32
    v_dot2_f32_bf16 v36, v104, v104, v36
    v_dot2_f32_bf16 v33, v105, s48, v33
    v_dot2_f32_bf16 v37, v105, v105, v37
    v_dot2_f32_bf16 v34, v106, s48, v34
    v_dot2_f32_bf16 v38, v106, v106, v38
    v_dot2_f32_bf16 v35, v107, s48, v35
    v_dot2_f32_bf16 v39, v107, v107, v39
    s_waitcnt lgkmcnt(0)
    v_dot2_f32_bf16 v32, v108, s48, v32
    v_dot2_f32_bf16 v36, v108, v108, v36
    v_dot2_f32_bf16 v33, v109, s48, v33
    v_dot2_f32_bf16 v37, v109, v109, v37
    v_dot2_f32_bf16 v34, v110, s48, v34
    v_dot2_f32_bf16 v38, v110, v110, v38
    v_dot2_f32_bf16 v35, v111, s48, v35
    v_dot2_f32_bf16 v39, v111, v111, v39
    ds_read_b128 v[128:131], v10 offset:0
    ds_read_b128 v[132:135], v10 offset:512
    ds_read_b128 v[136:139], v11 offset:0
    ds_read_b128 v[140:143], v11 offset:512
    ds_read_b128 v[144:147], v10 offset:24576
    ds_read_b128 v[148:151], v10 offset:25088
    ds_read_b128 v[152:155], v11 offset:24576
    ds_read_b128 v[156:159], v11 offset:25088
    ds_read_b128 v[160:163], v10 offset:32768
    ds_read_b128 v[164:167], v10 offset:33280
    ds_read_b128 v[168:171], v11 offset:32768
    ds_read_b128 v[172:175], v11 offset:33280
    ds_read_b128 v[176:179], v12 offset:0
    ds_read_b128 v[180:183], v12 offset:512
    v_pk_add_f32 v[32:33], v[32:33], v[34:35] op_sel:[0,0] op_sel_hi:[1,1]
    v_pk_add_f32 v[36:37], v[36:37], v[38:39] op_sel:[0,0] op_sel_hi:[1,1]
    v_add_f32 v32, v32, v33
    v_add_f32 v36, v36, v37
    v_mov_b32 v33, v32
    v_mov_b32 v37, v36
    s_nop 0
    v_permlane32_swap_b32 v32, v33
    v_permlane32_swap_b32 v36, v37
    v_add_f32 v32, v32, v33
    v_add_f32 v36, v36, v37
    v_mov_b32 v33, v32
    v_mov_b32 v37, v36
    s_nop 0
    v_permlane16_swap_b32 v32, v33
    v_permlane16_swap_b32 v36, v37
    v_add_f32 v32, v32, v33
    v_add_f32 v36, v36, v37
    v_mul_f32 v38, 0x3b124925, v32
    v_mul_f32 v253, 0x3b124925, v36
    v_fma_f32 v253, -v38, v38, v253
    v_max_f32 v253, 0, v253
    v_cvt_pk_bf16_f32 v252, 0, v38
    v_cvt_pk_bf16_f32 v253, 0, v253
    v_add_f32 v253, 0x3727c5ac, v253
    v_cvt_pk_bf16_f32 v253, 0, v253
    v_sqrt_f32 v253, v253
    s_nop 0
    v_cvt_pk_bf16_f32 v253, 0, v253
    v_rcp_f32 v34, v253
    v_xor_b32 v252, 0x80000000, v252
    s_mov_b64 exec, 0xffff
    buffer_store_dwordx4 v[252:255], v18, s[24:27], s59 offen sc1
    v_mov_b32 v35, v252
    buffer_store_dwordx2 v[34:35], v55, s[24:27], s61 offen sc1
    s_mov_b64 exec, -1
    ds_read_b64_tr_b16 v[56:57], v48 offset:0
    ds_read_b64_tr_b16 v[58:59], v48 offset:512
    ds_read_b64_tr_b16 v[60:61], v49 offset:0
    ds_read_b64_tr_b16 v[62:63], v49 offset:512
    ds_read_b64_tr_b16 v[64:65], v48 offset:24576
    ds_read_b64_tr_b16 v[66:67], v48 offset:25088
    ds_read_b64_tr_b16 v[68:69], v49 offset:24576
    ds_read_b64_tr_b16 v[70:71], v49 offset:25088
    ds_read_b64_tr_b16 v[72:73], v48 offset:32768
    ds_read_b64_tr_b16 v[74:75], v48 offset:33280
    ds_read_b64_tr_b16 v[76:77], v49 offset:32768
    ds_read_b64_tr_b16 v[78:79], v49 offset:33280
    ds_read_b64_tr_b16 v[80:81], v50 offset:0
    ds_read_b64_tr_b16 v[82:83], v50 offset:512
    ds_read_b64_tr_b16 v[84:85], v51 offset:0
    ds_read_b64_tr_b16 v[86:87], v51 offset:512
    s_add_u32 s56, s56, 128
    s_cmp_eq_u32 s56, 896
    s_cselect_b32 s56, 0, s56
    s_lshl_b32 s49, s56, 11
    s_add_u32 s49, s49, s46
    s_add_u32 s3, s49, 32768
    s_waitcnt lgkmcnt(12)
    buffer_store_dwordx4 v[56:59], v52, s[24:27], s49 offen sc1
    buffer_store_dwordx4 v[60:63], v52, s[24:27], s3 offen sc1
    ds_read_b64_tr_b16 v[88:89], v50 offset:16384
    ds_read_b64_tr_b16 v[90:91], v50 offset:16896
    ds_read_b64_tr_b16 v[92:93], v51 offset:16384
    ds_read_b64_tr_b16 v[94:95], v51 offset:16896
    s_add_u32 s56, s56, 128
    s_cmp_eq_u32 s56, 896
    s_cselect_b32 s56, 0, s56
    s_lshl_b32 s49, s56, 11
    s_add_u32 s49, s49, s46
    s_add_u32 s3, s49, 32768
    s_waitcnt lgkmcnt(12)
    buffer_store_dwordx4 v[64:67], v52, s[24:27], s49 offen sc1
    buffer_store_dwordx4 v[68:71], v52, s[24:27], s3 offen sc1
    ds_read_b64_tr_b16 v[96:97], v50 offset:24576
    ds_read_b64_tr_b16 v[98:99], v50 offset:25088
    ds_read_b64_tr_b16 v[100:101], v51 offset:24576
    ds_read_b64_tr_b16 v[102:103], v51 offset:25088
    s_add_u32 s56, s56, 128
    s_cmp_eq_u32 s56, 896
    s_cselect_b32 s56, 0, s56
    s_lshl_b32 s49, s56, 11
    s_add_u32 s49, s49, s46
    s_add_u32 s3, s49, 32768
    s_waitcnt lgkmcnt(12)
    buffer_store_dwordx4 v[72:75], v52, s[24:27], s49 offen sc1
    buffer_store_dwordx4 v[76:79], v52, s[24:27], s3 offen sc1
    ds_read_b64_tr_b16 v[104:105], v50 offset:32768
    ds_read_b64_tr_b16 v[106:107], v50 offset:33280
    ds_read_b64_tr_b16 v[108:109], v51 offset:32768
    ds_read_b64_tr_b16 v[110:111], v51 offset:33280
    s_add_u32 s56, s56, 128
    s_cmp_eq_u32 s56, 896
    s_cselect_b32 s56, 0, s56
    s_lshl_b32 s49, s56, 11
    s_add_u32 s49, s49, s46
    s_add_u32 s3, s49, 32768
    s_waitcnt lgkmcnt(12)
    buffer_store_dwordx4 v[80:83], v52, s[24:27], s49 offen sc1
    buffer_store_dwordx4 v[84:87], v52, s[24:27], s3 offen sc1
    ds_read_b128 v[184:187], v13 offset:0
    ds_read_b128 v[188:191], v13 offset:512
    ds_read_b128 v[192:195], v12 offset:16384
    ds_read_b128 v[196:199], v12 offset:16896
    s_add_u32 s56, s56, 128
    s_cmp_eq_u32 s56, 896
    s_cselect_b32 s56, 0, s56
    s_lshl_b32 s49, s56, 11
    s_add_u32 s49, s49, s46
    s_add_u32 s3, s49, 32768
    s_waitcnt lgkmcnt(12)
    buffer_store_dwordx4 v[88:91], v52, s[24:27], s49 offen sc1
    buffer_store_dwordx4 v[92:95], v52, s[24:27], s3 offen sc1
    ds_read_b128 v[200:203], v13 offset:16384
    ds_read_b128 v[204:207], v13 offset:16896
    ds_read_b128 v[208:211], v12 offset:24576
    ds_read_b128 v[212:215], v12 offset:25088
    s_add_u32 s56, s56, 128
    s_cmp_eq_u32 s56, 896
    s_cselect_b32 s56, 0, s56
    s_lshl_b32 s49, s56, 11
    s_add_u32 s49, s49, s46
    s_add_u32 s3, s49, 32768
    s_waitcnt lgkmcnt(12)
    buffer_store_dwordx4 v[96:99], v52, s[24:27], s49 offen sc1
    buffer_store_dwordx4 v[100:103], v52, s[24:27], s3 offen sc1
    ds_read_b128 v[216:219], v13 offset:24576
    ds_read_b128 v[220:223], v13 offset:25088
    ds_read_b128 v[224:227], v12 offset:32768
    ds_read_b128 v[228:231], v12 offset:33280
    ds_read_b128 v[232:235], v13 offset:32768
    ds_read_b128 v[236:239], v13 offset:33280
    s_add_u32 s56, s56, 128
    s_cmp_eq_u32 s56, 896
    s_cselect_b32 s56, 0, s56
    s_lshl_b32 s49, s56, 11
    s_add_u32 s49, s49, s46
    s_add_u32 s3, s49, 32768
    s_waitcnt lgkmcnt(14)
    buffer_store_dwordx4 v[104:107], v52, s[24:27], s49 offen sc1
    buffer_store_dwordx4 v[108:111], v52, s[24:27], s3 offen sc1
    s_waitcnt vmcnt(16)
    s_waitcnt lgkmcnt(0)
    s_barrier
    ds_read_b64_tr_b16 v[104:105], v53 offset:8192
    ds_read_b64_tr_b16 v[106:107], v53 offset:10240
    ds_read_b64_tr_b16 v[108:109], v53 offset:12288
    ds_read_b64_tr_b16 v[110:111], v53 offset:14336
    ds_read_b64_tr_b16 v[112:113], v54 offset:8192
    ds_read_b64_tr_b16 v[114:115], v54 offset:10240
    ds_read_b64_tr_b16 v[116:117], v54 offset:12288
    ds_read_b64_tr_b16 v[118:119], v54 offset:14336
    ds_read_b64_tr_b16 v[120:121], v53 offset:16384
    ds_read_b64_tr_b16 v[122:123], v53 offset:18432
    ds_read_b64_tr_b16 v[124:125], v53 offset:20480
    ds_read_b64_tr_b16 v[126:127], v53 offset:22528
    s_add_u32 m0, s50, 56576
    s_nop 0
    buffer_load_dwordx4 v6, s[32:35], s52 offen offset:768 lds
    s_add_u32 m0, s55, 32768
    s_nop 0
    buffer_load_dwordx4 v8, s[20:23], s57 offen lds
    buffer_load_dwordx4 v9, s[20:23], s57 offen offset:1024 lds
    s_add_u32 m0, s55, 73728
    s_add_u32 s57, s57, 114688
    buffer_load_dwordx4 v8, s[20:23], s57 offen lds
    buffer_load_dwordx4 v9, s[20:23], s57 offen offset:1024 lds
    s_add_u32 m0, s55, 0
    s_add_u32 s57, s57, 114688
    s_cmp_eq_u32 s57, 1605632
    s_cselect_b32 s57, 0, s57
    buffer_load_dwordx4 v8, s[20:23], s57 offen lds
    buffer_load_dwordx4 v9, s[20:23], s57 offen offset:1024 lds
    s_add_u32 m0, s55, 40960
    s_add_u32 s57, s57, 114688
    buffer_load_dwordx4 v8, s[20:23], s57 offen lds
    buffer_load_dwordx4 v9, s[20:23], s57 offen offset:1024 lds
    s_waitcnt lgkmcnt(0)
    s_waitcnt vmcnt(8)
    s_barrier
    s_cmp_lg_u32 s38, 0
    s_cbranch_scc1 L_nofu
    s_add_u32 s3, s51, 4096
    s_mov_b64 exec, 1
    buffer_store_dwordx2 v[254:255], v1, s[24:27], s3 offen sc1
    s_mov_b64 exec, -1
L_nofu:
    buffer_store_dwordx4 v[104:107], v1, s[24:27], s47 offen sc1
    s_add_u32 s47, s47, 114688
    buffer_store_dwordx4 v[108:111], v1, s[24:27], s47 offen sc1
    s_add_u32 s47, s47, 114688
    buffer_store_dwordx4 v[112:115], v1, s[24:27], s47 offen sc1
    s_add_u32 s47, s47, 114688
    buffer_store_dwordx4 v[116:119], v1, s[24:27], s47 offen sc1
    s_add_u32 s47, s47, 114688
    buffer_store_dwordx4 v[120:123], v1, s[24:27], s47 offen sc1
    s_add_u32 s47, s47, 114688
    buffer_store_dwordx4 v[124:127], v1, s[24:27], s47 offen sc1
    s_add_u32 s47, s47, 114688
    ds_read_b64_tr_b16 v[104:105], v54 offset:16384
    ds_read_b64_tr_b16 v[106:107], v54 offset:18432
    s_add_u32 m0, s55, 8192
    s_add_u32 s57, s57, 114688
    s_cmp_eq_u32 s57, 1605632
    s_cselect_b32 s57, 0, s57
    buffer_load_dwordx4 v8, s[20:23], s57 offen lds
    buffer_load_dwordx4 v9, s[20:23], s57 offen offset:1024 lds
    s_add_u32 m0, s55, 49152
    s_add_u32 s57, s57, 114688
    buffer_load_dwordx4 v8, s[20:23], s57 offen lds
    buffer_load_dwordx4 v9, s[20:23], s57 offen offset:1024 lds
    s_add_u32 m0, s55, 16384
    s_add_u32 s57, s57, 114688
    s_cmp_eq_u32 s57, 1605632
    s_cselect_b32 s57, 0, s57
    buffer_load_dwordx4 v8, s[20:23], s57 offen lds
    buffer_load_dwordx4 v9, s[20:23], s57 offen offset:1024 lds
    s_waitcnt lgkmcnt(0)
    buffer_store_dwordx4 v[104:107], v1, s[24:27], s47 offen sc1
    s_add_u32 s47, s47, 114688
    s_waitcnt vmcnt(17)
    s_barrier
    s_add_u32 m0, s55, 57344
    s_add_u32 s57, s57, 114688
    buffer_load_dwordx4 v8, s[20:23], s57 offen lds
    buffer_load_dwordx4 v9, s[20:23], s57 offen offset:1024 lds
    s_add_u32 m0, s55, 24576
    s_add_u32 s57, s57, 114688
    s_cmp_eq_u32 s57, 1605632
    s_cselect_b32 s57, 0, s57
    buffer_load_dwordx4 v8, s[20:23], s57 offen lds
    buffer_load_dwordx4 v9, s[20:23], s57 offen offset:1024 lds
    s_add_u32 m0, s55, 65536
    s_add_u32 s57, s57, 114688
    buffer_load_dwordx4 v8, s[20:23], s57 offen lds
    buffer_load_dwordx4 v9, s[20:23], s57 offen offset:1024 lds
    ds_read_b64_tr_b16 v[24:25], v240 offset:32768
    ds_read_b64_tr_b16 v[26:27], v240 offset:33792
    ds_read_b64_tr_b16 v[28:29], v241 offset:32768
    ds_read_b64_tr_b16 v[30:31], v241 offset:33792
    ds_read_b64_tr_b16 v[32:33], v242 offset:32768
    ds_read_b64_tr_b16 v[34:35], v242 offset:33792
    ds_read_b64_tr_b16 v[36:37], v243 offset:32768
    ds_read_b64_tr_b16 v[38:39], v243 offset:33792
    ds_read_b64_tr_b16 v[40:41], v244 offset:32768
    ds_read_b64_tr_b16 v[42:43], v244 offset:33792
    s_waitcnt lgkmcnt(8)
    v_mfma_f32_16x16x32_bf16 v[56:59], v[24:27], v[128:131], 0
    ds_read_b64_tr_b16 v[44:45], v245 offset:32768
    ds_read_b64_tr_b16 v[46:47], v245 offset:33792
    v_mfma_f32_16x16x32_bf16 v[60:63], v[24:27], v[132:135], 0
    ds_read_b64_tr_b16 v[48:49], v246 offset:32768
    ds_read_b64_tr_b16 v[50:51], v246 offset:33792
    v_mfma_f32_16x16x32_bf16 v[88:91], v[24:27], v[20:23], 0
    ds_read_b64_tr_b16 v[52:53], v247 offset:32768
    ds_read_b64_tr_b16 v[54:55], v247 offset:33792
    s_waitcnt lgkmcnt(12)
    v_mfma_f32_16x16x32_bf16 v[64:67], v[28:31], v[128:131], 0
    v_mfma_f32_16x16x32_bf16 v[68:71], v[28:31], v[132:135], 0
    v_mfma_f32_16x16x32_bf16 v[92:95], v[28:31], v[20:23], 0
    s_waitcnt lgkmcnt(10)
    v_mfma_f32_16x16x32_bf16 v[72:75], v[32:35], v[128:131], 0
    v_mfma_f32_16x16x32_bf16 v[76:79], v[32:35], v[132:135], 0
    s_waitcnt lgkmcnt(8)
    v_mfma_f32_16x16x32_bf16 v[80:83], v[36:39], v[128:131], 0
    v_mfma_f32_16x16x32_bf16 v[84:87], v[36:39], v[132:135], 0
    s_waitcnt lgkmcnt(6)
    v_mfma_f32_16x16x32_bf16 v[56:59], v[40:43], v[136:139], v[56:59]
    v_mfma_f32_16x16x32_bf16 v[60:63], v[40:43], v[140:143], v[60:63]
    s_waitcnt vmcnt(19)
    s_waitcnt lgkmcnt(0)
    s_barrier
    ds_read_b64_tr_b16 v[24:25], v240 offset:0
    ds_read_b64_tr_b16 v[26:27], v240 offset:1024
    v_mfma_f32_16x16x32_bf16 v[88:91], v[40:43], v[20:23], v[88:91]
    ds_read_b64_tr_b16 v[28:29], v241 offset:0
    ds_read_b64_tr_b16 v[30:31], v241 offset:1024
    v_mfma_f32_16x16x32_bf16 v[64:67], v[44:47], v[136:139], v[64:67]
    ds_read_b64_tr_b16 v[32:33], v242 offset:0
    ds_read_b64_tr_b16 v[34:35], v242 offset:1024
    v_mfma_f32_16x16x32_bf16 v[68:71], v[44:47], v[140:143], v[68:71]
    ds_read_b64_tr_b16 v[36:37], v243 offset:0
    ds_read_b64_tr_b16 v[38:39], v243 offset:1024
    v_mfma_f32_16x16x32_bf16 v[92:95], v[44:47], v[20:23], v[92:95]
    v_mfma_f32_16x16x32_bf16 v[72:75], v[48:51], v[136:139], v[72:75]
    v_mfma_f32_16x16x32_bf16 v[76:79], v[48:51], v[140:143], v[76:79]
    v_mfma_f32_16x16x32_bf16 v[80:83], v[52:55], v[136:139], v[80:83]
    v_mfma_f32_16x16x32_bf16 v[84:87], v[52:55], v[140:143], v[84:87]
    ds_read_b64_tr_b16 v[40:41], v244 offset:0
    ds_read_b64_tr_b16 v[42:43], v244 offset:1024
    s_waitcnt lgkmcnt(8)
    v_mfma_f32_16x16x32_bf16 v[56:59], v[24:27], v[144:147], v[56:59]
    ds_read_b64_tr_b16 v[44:45], v245 offset:0
    ds_read_b64_tr_b16 v[46:47], v245 offset:1024
    v_mfma_f32_16x16x32_bf16 v[60:63], v[24:27], v[148:151], v[60:63]
    ds_read_b64_tr_b16 v[48:49], v246 offset:0
    ds_read_b64_tr_b16 v[50:51], v246 offset:1024
    v_mfma_f32_16x16x32_bf16 v[88:91], v[24:27], v[20:23], v[88:91]
    ds_read_b64_tr_b16 v[52:53], v247 offset:0
    ds_read_b64_tr_b16 v[54:55], v247 offset:1024
    s_waitcnt lgkmcnt(12)
    v_mfma_f32_16x16x32_bf16 v[64:67], v[28:31], v[144:147], v[64:67]
    v_mfma_f32_16x16x32_bf16 v[68:71], v[28:31], v[148:151], v[68:71]
    v_mfma_f32_16x16x32_bf16 v[92:95], v[28:31], v[20:23], v[92:95]
    s_waitcnt lgkmcnt(10)
    v_mfma_f32_16x16x32_bf16 v[72:75], v[32:35], v[144:147], v[72:75]
    v_mfma_f32_16x16x32_bf16 v[76:79], v[32:35], v[148:151], v[76:79]
    s_waitcnt lgkmcnt(8)
    v_mfma_f32_16x16x32_bf16 v[80:83], v[36:39], v[144:147], v[80:83]
    v_mfma_f32_16x16x32_bf16 v[84:87], v[36:39], v[148:151], v[84:87]
    s_waitcnt lgkmcnt(6)
    v_mfma_f32_16x16x32_bf16 v[56:59], v[40:43], v[152:155], v[56:59]
    v_mfma_f32_16x16x32_bf16 v[60:63], v[40:43], v[156:159], v[60:63]
    s_waitcnt vmcnt(9)
    s_waitcnt lgkmcnt(0)
    s_barrier
    ds_read_b64_tr_b16 v[24:25], v240 offset:8192
    ds_read_b64_tr_b16 v[26:27], v240 offset:9216
    v_mfma_f32_16x16x32_bf16 v[88:91], v[40:43], v[20:23], v[88:91]
    ds_read_b64_tr_b16 v[28:29], v241 offset:8192
    ds_read_b64_tr_b16 v[30:31], v241 offset:9216
    v_mfma_f32_16x16x32_bf16 v[64:67], v[44:47], v[152:155], v[64:67]
    ds_read_b64_tr_b16 v[32:33], v242 offset:8192
    ds_read_b64_tr_b16 v[34:35], v242 offset:9216
    v_mfma_f32_16x16x32_bf16 v[68:71], v[44:47], v[156:159], v[68:71]
    ds_read_b64_tr_b16 v[36:37], v243 offset:8192
    ds_read_b64_tr_b16 v[38:39], v243 offset:9216
    v_mfma_f32_16x16x32_bf16 v[92:95], v[44:47], v[20:23], v[92:95]
    v_mfma_f32_16x16x32_bf16 v[72:75], v[48:51], v[152:155], v[72:75]
    v_mfma_f32_16x16x32_bf16 v[76:79], v[48:51], v[156:159], v[76:79]
    v_mfma_f32_16x16x32_bf16 v[80:83], v[52:55], v[152:155], v[80:83]
    v_mfma_f32_16x16x32_bf16 v[84:87], v[52:55], v[156:159], v[84:87]
    ds_read_b64_tr_b16 v[40:41], v244 offset:8192
    ds_read_b64_tr_b16 v[42:43], v244 offset:9216
    s_waitcnt lgkmcnt(8)
    v_mfma_f32_16x16x32_bf16 v[56:59], v[24:27], v[160:163], v[56:59]
    ds_read_b64_tr_b16 v[44:45], v245 offset:8192
    ds_read_b64_tr_b16 v[46:47], v245 offset:9216
    v_mfma_f32_16x16x32_bf16 v[60:63], v[24:27], v[164:167], v[60:63]
    ds_read_b64_tr_b16 v[48:49], v246 offset:8192
    ds_read_b64_tr_b16 v[50:51], v246 offset:9216
    v_mfma_f32_16x16x32_bf16 v[88:91], v[24:27], v[20:23], v[88:91]
    ds_read_b64_tr_b16 v[52:53], v247 offset:8192
    ds_read_b64_tr_b16 v[54:55], v247 offset:9216
    s_waitcnt lgkmcnt(12)
    v_mfma_f32_16x16x32_bf16 v[64:67], v[28:31], v[160:163], v[64:67]
    v_mfma_f32_16x16x32_bf16 v[68:71], v[28:31], v[164:167], v[68:71]
    v_mfma_f32_16x16x32_bf16 v[92:95], v[28:31], v[20:23], v[92:95]
    s_waitcnt lgkmcnt(10)
    v_mfma_f32_16x16x32_bf16 v[72:75], v[32:35], v[160:163], v[72:75]
    v_mfma_f32_16x16x32_bf16 v[76:79], v[32:35], v[164:167], v[76:79]
    s_waitcnt lgkmcnt(8)
    v_mfma_f32_16x16x32_bf16 v[80:83], v[36:39], v[160:163], v[80:83]
    v_mfma_f32_16x16x32_bf16 v[84:87], v[36:39], v[164:167], v[84:87]
    s_waitcnt lgkmcnt(6)
    v_mfma_f32_16x16x32_bf16 v[56:59], v[40:43], v[168:171], v[56:59]
    v_mfma_f32_16x16x32_bf16 v[60:63], v[40:43], v[172:175], v[60:63]
    s_waitcnt vmcnt(4)
    s_waitcnt lgkmcnt(0)
    s_barrier
    s_cmp_lg_u32 s38, 0
    s_cbranch_scc1 L_nofx
    s_mov_b64 exec, 1
    buffer_store_dwordx2 v[254:255], v1, s[24:27], s51 offen sc1
    s_mov_b64 exec, -1
L_nofx:
    ds_read_b64_tr_b16 v[24:25], v240 offset:16384
    ds_read_b64_tr_b16 v[26:27], v240 offset:17408
    v_mfma_f32_16x16x32_bf16 v[88:91], v[40:43], v[20:23], v[88:91]
    ds_read_b64_tr_b16 v[28:29], v241 offset:16384
    ds_read_b64_tr_b16 v[30:31], v241 offset:17408
    v_mfma_f32_16x16x32_bf16 v[64:67], v[44:47], v[168:171], v[64:67]
    ds_read_b64_tr_b16 v[32:33], v242 offset:16384
    ds_read_b64_tr_b16 v[34:35], v242 offset:17408
    v_mfma_f32_16x16x32_bf16 v[68:71], v[44:47], v[172:175], v[68:71]
    ds_read_b64_tr_b16 v[36:37], v243 offset:16384
    ds_read_b64_tr_b16 v[38:39], v243 offset:17408
    v_mfma_f32_16x16x32_bf16 v[92:95], v[44:47], v[20:23], v[92:95]
    s_add_u32 m0, s55, 32768
    s_add_u32 s57, s57, 114688
    s_cmp_eq_u32 s57, 1605632
    s_cselect_b32 s57, 0, s57
    buffer_load_dwordx4 v8, s[20:23], s57 offen lds
    v_mfma_f32_16x16x32_bf16 v[72:75], v[48:51], v[168:171], v[72:75]
    buffer_load_dwordx4 v9, s[20:23], s57 offen offset:1024 lds
    v_mfma_f32_16x16x32_bf16 v[76:79], v[48:51], v[172:175], v[76:79]
    s_add_u32 m0, s55, 73728
    s_add_u32 s57, s57, 114688
    buffer_load_dwordx4 v8, s[20:23], s57 offen lds
    v_mfma_f32_16x16x32_bf16 v[80:83], v[52:55], v[168:171], v[80:83]
    buffer_load_dwordx4 v9, s[20:23], s57 offen offset:1024 lds
    v_mfma_f32_16x16x32_bf16 v[84:87], v[52:55], v[172:175], v[84:87]
    ds_read_b64_tr_b16 v[40:41], v244 offset:16384
    ds_read_b64_tr_b16 v[42:43], v244 offset:17408
    s_waitcnt lgkmcnt(8)
    v_mfma_f32_16x16x32_bf16 v[56:59], v[24:27], v[176:179], v[56:59]
    ds_read_b64_tr_b16 v[44:45], v245 offset:16384
    ds_read_b64_tr_b16 v[46:47], v245 offset:17408
    v_mfma_f32_16x16x32_bf16 v[60:63], v[24:27], v[180:183], v[60:63]
    ds_read_b64_tr_b16 v[48:49], v246 offset:16384
    ds_read_b64_tr_b16 v[50:51], v246 offset:17408
    v_mfma_f32_16x16x32_bf16 v[88:91], v[24:27], v[20:23], v[88:91]
    ds_read_b64_tr_b16 v[52:53], v247 offset:16384
    ds_read_b64_tr_b16 v[54:55], v247 offset:17408
    s_waitcnt lgkmcnt(12)
    v_mfma_f32_16x16x32_bf16 v[64:67], v[28:31], v[176:179], v[64:67]
    s_add_u32 m0, s55, 0
    s_add_u32 s57, s57, 114688
    s_cmp_eq_u32 s57, 1605632
    s_cselect_b32 s57, 0, s57
    buffer_load_dwordx4 v8, s[20:23], s57 offen lds
    v_mfma_f32_16x16x32_bf16 v[68:71], v[28:31], v[180:183], v[68:71]
    buffer_load_dwordx4 v9, s[20:23], s57 offen offset:1024 lds
    v_mfma_f32_16x16x32_bf16 v[92:95], v[28:31], v[20:23], v[92:95]
    s_add_u32 m0, s55, 40960
    s_add_u32 s57, s57, 114688
    buffer_load_dwordx4 v8, s[20:23], s57 offen lds
    s_waitcnt lgkmcnt(10)
    v_mfma_f32_16x16x32_bf16 v[72:75], v[32:35], v[176:179], v[72:75]
    buffer_load_dwordx4 v9, s[20:23], s57 offen offset:1024 lds
    v_mfma_f32_16x16x32_bf16 v[76:79], v[32:35], v[180:183], v[76:79]
    s_waitcnt lgkmcnt(8)
    v_mfma_f32_16x16x32_bf16 v[80:83], v[36:39], v[176:179], v[80:83]
    v_mfma_f32_16x16x32_bf16 v[84:87], v[36:39], v[180:183], v[84:87]
    s_waitcnt lgkmcnt(6)
    v_mfma_f32_16x16x32_bf16 v[56:59], v[40:43], v[184:187], v[56:59]
    v_mfma_f32_16x16x32_bf16 v[60:63], v[40:43], v[188:191], v[60:63]
    s_waitcnt vmcnt(8)
    s_waitcnt lgkmcnt(0)
    s_barrier
    ds_read_b64_tr_b16 v[24:25], v240 offset:24576
    ds_read_b64_tr_b16 v[26:27], v240 offset:25600
    v_mfma_f32_16x16x32_bf16 v[88:91], v[40:43], v[20:23], v[88:91]
    ds_read_b64_tr_b16 v[28:29], v241 offset:24576
    ds_read_b64_tr_b16 v[30:31], v241 offset:25600
    v_mfma_f32_16x16x32_bf16 v[64:67], v[44:47], v[184:187], v[64:67]
    ds_read_b64_tr_b16 v[32:33], v242 offset:24576
    ds_read_b64_tr_b16 v[34:35], v242 offset:25600
    v_mfma_f32_16x16x32_bf16 v[68:71], v[44:47], v[188:191], v[68:71]
    ds_read_b64_tr_b16 v[36:37], v243 offset:24576
    ds_read_b64_tr_b16 v[38:39], v243 offset:25600
    v_mfma_f32_16x16x32_bf16 v[92:95], v[44:47], v[20:23], v[92:95]
    v_mfma_f32_16x16x32_bf16 v[72:75], v[48:51], v[184:187], v[72:75]
    v_mfma_f32_16x16x32_bf16 v[76:79], v[48:51], v[188:191], v[76:79]
    v_mfma_f32_16x16x32_bf16 v[80:83], v[52:55], v[184:187], v[80:83]
    v_mfma_f32_16x16x32_bf16 v[84:87], v[52:55], v[188:191], v[84:87]
    s_waitcnt vmcnt(0)
    s_mov_b32 s50, 1
L_join:
    v_lshlrev_b32 v18, 4, v14
    s_lshl_b32 s3, s44, 6
    v_lshl_add_u32 v19, v14, 1, s3
    v_and_b32 v12, 7, v2
    v_xor_b32 v12, v12, v3
    v_lshlrev_b32 v12, 4, v12
    v_lshl_add_u32 v12, v14, 7, v12
    ds_read_b64_tr_b16 v[40:41], v244 offset:24576
    ds_read_b64_tr_b16 v[42:43], v244 offset:25600
    s_waitcnt lgkmcnt(8)
    v_mfma_f32_16x16x32_bf16 v[56:59], v[24:27], v[192:195], v[56:59]
    ds_read_b64_tr_b16 v[44:45], v245 offset:24576
    ds_read_b64_tr_b16 v[46:47], v245 offset:25600
    v_mfma_f32_16x16x32_bf16 v[60:63], v[24:27], v[196:199], v[60:63]
    ds_read_b64_tr_b16 v[48:49], v246 offset:24576
    ds_read_b64_tr_b16 v[50:51], v246 offset:25600
    v_mfma_f32_16x16x32_bf16 v[88:91], v[24:27], v[20:23], v[88:91]
    ds_read_b64_tr_b16 v[52:53], v247 offset:24576
    ds_read_b64_tr_b16 v[54:55], v247 offset:25600
    s_waitcnt lgkmcnt(12)
    v_mfma_f32_16x16x32_bf16 v[64:67], v[28:31], v[192:195], v[64:67]
    global_load_short_d16_hi v14, v19, s[10:11] offset:0
    v_mfma_f32_16x16x32_bf16 v[68:71], v[28:31], v[196:199], v[68:71]
    global_load_short_d16_hi v15, v19, s[10:11] offset:8
    v_mfma_f32_16x16x32_bf16 v[92:95], v[28:31], v[20:23], v[92:95]
    buffer_load_dwordx2 v[184:185], v18, s[24:27], s59 offen offset:0 sc1
    s_waitcnt lgkmcnt(10)
    v_mfma_f32_16x16x32_bf16 v[72:75], v[32:35], v[192:195], v[72:75]
    buffer_load_dwordx2 v[188:189], v18, s[24:27], s59 offen offset:64 sc1
    v_mfma_f32_16x16x32_bf16 v[76:79], v[32:35], v[196:199], v[76:79]
    s_add_u32 m0, s55, 8192
    s_add_u32 s49, s60, 0
    s_and_b32 s49, s49, 2047
    s_add_u32 s49, s49, s54
    buffer_load_dwordx4 v16, s[28:31], s49 offen lds
    s_waitcnt lgkmcnt(8)
    v_mfma_f32_16x16x32_bf16 v[80:83], v[36:39], v[192:195], v[80:83]
    s_add_u32 s49, s49, 31744
    buffer_load_dwordx4 v17, s[28:31], s49 offen offset:1024 lds
    v_mfma_f32_16x16x32_bf16 v[84:87], v[36:39], v[196:199], v[84:87]
    s_waitcnt lgkmcnt(6)
    v_mfma_f32_16x16x32_bf16 v[56:59], v[40:43], v[200:203], v[56:59]
    v_mfma_f32_16x16x32_bf16 v[60:63], v[40:43], v[204:207], v[60:63]
    s_waitcnt lgkmcnt(0)
    s_barrier
    ds_read_b64_tr_b16 v[24:25], v240 offset:32768
    ds_read_b64_tr_b16 v[26:27], v240 offset:33792
    v_mfma_f32_16x16x32_bf16 v[88:91], v[40:43], v[20:23], v[88:91]
    ds_read_b64_tr_b16 v[28:29], v241 offset:32768
    ds_read_b64_tr_b16 v[30:31], v241 offset:33792
    v_mfma_f32_16x16x32_bf16 v[64:67], v[44:47], v[200:203], v[64:67]
    ds_read_b64_tr_b16 v[32:33], v242 offset:32768
    ds_read_b64_tr_b16 v[34:35], v242 offset:33792
    v_mfma_f32_16x16x32_bf16 v[68:71], v[44:47], v[204:207], v[68:71]
    ds_read_b64_tr_b16 v[36:37], v243 offset:32768
    ds_read_b64_tr_b16 v[38:39], v243 offset:33792
    v_mfma_f32_16x16x32_bf16 v[92:95], v[44:47], v[20:23], v[92:95]
    s_add_u32 m0, s55, 49152
    s_add_u32 s49, s60, 0
    s_and_b32 s49, s49, 2047
    s_add_u32 s49, s49, s54
    s_add_u32 s49, s49, 2048
    buffer_load_dwordx4 v16, s[28:31], s49 offen lds
    v_mfma_f32_16x16x32_bf16 v[72:75], v[48:51], v[200:203], v[72:75]
    s_add_u32 s49, s49, 31744
    buffer_load_dwordx4 v17, s[28:31], s49 offen offset:1024 lds
    v_mfma_f32_16x16x32_bf16 v[76:79], v[48:51], v[204:207], v[76:79]
    s_add_u32 m0, s55, 16384
    s_add_u32 s49, s60, 128
    s_and_b32 s49, s49, 2047
    s_add_u32 s49, s49, s54
    buffer_load_dwordx4 v16, s[28:31], s49 offen lds
    v_mfma_f32_16x16x32_bf16 v[80:83], v[52:55], v[200:203], v[80:83]
    s_add_u32 s49, s49, 31744
    buffer_load_dwordx4 v17, s[28:31], s49 offen offset:1024 lds
    v_mfma_f32_16x16x32_bf16 v[84:87], v[52:55], v[204:207], v[84:87]
    ds_read_b64_tr_b16 v[40:41], v244 offset:32768
    ds_read_b64_tr_b16 v[42:43], v244 offset:33792
    s_waitcnt lgkmcnt(8)
    v_mfma_f32_16x16x32_bf16 v[56:59], v[24:27], v[208:211], v[56:59]
    ds_read_b64_tr_b16 v[44:45], v245 offset:32768
    ds_read_b64_tr_b16 v[46:47], v245 offset:33792
    v_mfma_f32_16x16x32_bf16 v[60:63], v[24:27], v[212:215], v[60:63]
    ds_read_b64_tr_b16 v[48:49], v246 offset:32768
    ds_read_b64_tr_b16 v[50:51], v246 offset:33792
    v_mfma_f32_16x16x32_bf16 v[88:91], v[24:27], v[20:23], v[88:91]
    ds_read_b64_tr_b16 v[52:53], v247 offset:32768
    ds_read_b64_tr_b16 v[54:55], v247 offset:33792
    s_waitcnt lgkmcnt(12)
    v_mfma_f32_16x16x32_bf16 v[64:67], v[28:31], v[208:211], v[64:67]
    s_add_u32 m0, s55, 57344
    s_add_u32 s49, s60, 128
    s_and_b32 s49, s49, 2047
    s_add_u32 s49, s49, s54
    s_add_u32 s49, s49, 2048
    buffer_load_dwordx4 v16, s[28:31], s49 offen lds
    v_mfma_f32_16x16x32_bf16 v[68:71], v[28:31], v[212:215], v[68:71]
    s_add_u32 s49, s49, 31744
    buffer_load_dwordx4 v17, s[28:31], s49 offen offset:1024 lds
    v_mfma_f32_16x16x32_bf16 v[92:95], v[28:31], v[20:23], v[92:95]
    s_add_u32 m0, s55, 24576
    s_add_u32 s49, s60, 256
    s_and_b32 s49, s49, 2047
    s_add_u32 s49, s49, s54
    buffer_load_dwordx4 v16, s[28:31], s49 offen lds
    s_waitcnt lgkmcnt(10)
    v_mfma_f32_16x16x32_bf16 v[72:75], v[32:35], v[208:211], v[72:75]
    s_add_u32 s49, s49, 31744
    buffer_load_dwordx4 v17, s[28:31], s49 offen offset:1024 lds
    v_mfma_f32_16x16x32_bf16 v[76:79], v[32:35], v[212:215], v[76:79]
    s_add_u32 m0, s55, 65536
    s_add_u32 s49, s60, 256
    s_and_b32 s49, s49, 2047
    s_add_u32 s49, s49, s54
    s_add_u32 s49, s49, 2048
    buffer_load_dwordx4 v16, s[28:31], s49 offen lds
    s_waitcnt lgkmcnt(8)
    v_mfma_f32_16x16x32_bf16 v[80:83], v[36:39], v[208:211], v[80:83]
    s_add_u32 s49, s49, 31744
    buffer_load_dwordx4 v17, s[28:31], s49 offen offset:1024 lds
    v_mfma_f32_16x16x32_bf16 v[84:87], v[36:39], v[212:215], v[84:87]
    s_mul_i32 s48, s41, 40960
    s_mul_i32 s47, s41, 45056
    v_add_u32 v10, s47, v12
    v_xor_b32 v11, 0x1000, v10
    v_xor_b32 v12, 64, v10
    v_xor_b32 v13, 64, v11
    s_lshl_b32 s52, s42, 12
    s_add_u32 s52, s52, s48
    v_add_u32 v8, s52, v1
    s_waitcnt lgkmcnt(6)
    v_mfma_f32_16x16x32_bf16 v[56:59], v[40:43], v[216:219], v[56:59]
    v_mfma_f32_16x16x32_bf16 v[60:63], v[40:43], v[220:223], v[60:63]
    s_waitcnt vmcnt(20)
    s_waitcnt vmcnt(16)
    s_waitcnt lgkmcnt(0)
    s_barrier
    s_cmp_lg_u32 s50, 0
    s_cbranch_scc1 L_nofz
    s_mov_b64 exec, 1
    buffer_store_dwordx2 v[254:255], v1, s[24:27], s51 offen sc1
    s_mov_b64 exec, -1
L_nofz:
    s_mul_i32 s4, s44, 57344
    s_and_b32 s6, s40, 3
    s_mul_i32 s6, s6, 7168
    s_add_u32 s4, s4, 0xd00000
    s_add_u32 s4, s4, s6
    s_lshr_b32 s6, s40, 2
    s_xor_b32 s7, s6, s40
    s_and_b32 s7, s7, 1
    s_mul_i32 s7, s7, 28672
    s_add_u32 s7, s7, s4
    s_add_u32 s7, s7, 6144
    s_mul_i32 s6, s6, 3072
    s_add_u32 s4, s4, s6
    s_lshl_b32 s6, s42, 11
    s_add_u32 s4, s4, s6
    s_add_u32 s5, s4, 28672
    s_add_u32 s6, s4, 1024
    s_add_u32 s20, s5, 1024
    s_cmp_eq_u32 s42, 0
    s_cselect_b32 s6, s6, s7
    s_cselect_b32 s7, s20, s7
    v_mov_b32 v128, -1
    v_mov_b32 v129, -1
    v_mov_b32 v130, -1
    v_mov_b32 v131, -1
    buffer_store_dwordx4 v[128:131], v1, s[24:27], s4 offen sc1
    buffer_store_dwordx4 v[128:131], v1, s[24:27], s5 offen sc1
    buffer_store_dwordx4 v[128:131], v1, s[24:27], s6 offen sc1
    buffer_store_dwordx4 v[128:131], v1, s[24:27], s7 offen sc1
    ds_read_b64_tr_b16 v[24:25], v240 offset:0
    ds_read_b64_tr_b16 v[26:27], v240 offset:1024
    v_mfma_f32_16x16x32_bf16 v[88:91], v[40:43], v[20:23], v[88:91]
    ds_read_b64_tr_b16 v[28:29], v241 offset:0
    ds_read_b64_tr_b16 v[30:31], v241 offset:1024
    v_mfma_f32_16x16x32_bf16 v[64:67], v[44:47], v[216:219], v[64:67]
    ds_read_b64_tr_b16 v[32:33], v242 offset:0
    ds_read_b64_tr_b16 v[34:35], v242 offset:1024
    v_mfma_f32_16x16x32_bf16 v[68:71], v[44:47], v[220:223], v[68:71]
    ds_read_b64_tr_b16 v[36:37], v243 offset:0
    ds_read_b64_tr_b16 v[38:39], v243 offset:1024
    v_mfma_f32_16x16x32_bf16 v[92:95], v[44:47], v[20:23], v[92:95]
    s_add_u32 m0, s55, 32768
    s_add_u32 s49, s60, 384
    s_and_b32 s49, s49, 2047
    s_add_u32 s49, s49, s54
    buffer_load_dwordx4 v16, s[28:31], s49 offen lds
    v_mfma_f32_16x16x32_bf16 v[72:75], v[48:51], v[216:219], v[72:75]
    s_add_u32 s49, s49, 31744
    buffer_load_dwordx4 v17, s[28:31], s49 offen offset:1024 lds
    v_mfma_f32_16x16x32_bf16 v[76:79], v[48:51], v[220:223], v[76:79]
    s_add_u32 m0, s55, 73728
    s_add_u32 s49, s60, 384
    s_and_b32 s49, s49, 2047
    s_add_u32 s49, s49, s54
    s_add_u32 s49, s49, 2048
    buffer_load_dwordx4 v16, s[28:31], s49 offen lds
    v_mfma_f32_16x16x32_bf16 v[80:83], v[52:55], v[216:219], v[80:83]
    s_add_u32 s49, s49, 31744
    buffer_load_dwordx4 v17, s[28:31], s49 offen offset:1024 lds
    v_mfma_f32_16x16x32_bf16 v[84:87], v[52:55], v[220:223], v[84:87]
    ds_read_b64_tr_b16 v[40:41], v244 offset:0
    ds_read_b64_tr_b16 v[42:43], v244 offset:1024
    s_waitcnt lgkmcnt(8)
    v_mfma_f32_16x16x32_bf16 v[56:59], v[24:27], v[224:227], v[56:59]
    ds_read_b64_tr_b16 v[44:45], v245 offset:0
    ds_read_b64_tr_b16 v[46:47], v245 offset:1024
    v_mfma_f32_16x16x32_bf16 v[60:63], v[24:27], v[228:231], v[60:63]
    ds_read_b64_tr_b16 v[48:49], v246 offset:0
    ds_read_b64_tr_b16 v[50:51], v246 offset:1024
    v_mfma_f32_16x16x32_bf16 v[88:91], v[24:27], v[20:23], v[88:91]
    ds_read_b64_tr_b16 v[52:53], v247 offset:0
    ds_read_b64_tr_b16 v[54:55], v247 offset:1024
    s_waitcnt lgkmcnt(12)
    v_mfma_f32_16x16x32_bf16 v[64:67], v[28:31], v[224:227], v[64:67]
    s_mul_i32 s46, s40, 7
    s_add_u32 s47, s46, 6
    v_mfma_f32_16x16x32_bf16 v[68:71], v[28:31], v[228:231], v[68:71]
    s_lshr_b32 s47, s47, 3
    s_lshr_b32 s3, s46, 3
    v_mfma_f32_16x16x32_bf16 v[92:95], v[28:31], v[20:23], v[92:95]
    s_cmp_eq_u32 s38, 1
    s_cselect_b32 s3, 8, s3
    s_cselect_b32 s47, 8, s47
    v_lshrrev_b32 v9, 1, v3
    s_waitcnt lgkmcnt(10)
    v_mfma_f32_16x16x32_bf16 v[72:75], v[32:35], v[224:227], v[72:75]
    v_add_u32 v9, s3, v9
    v_min_u32 v9, s47, v9
    v_mfma_f32_16x16x32_bf16 v[76:79], v[32:35], v[228:231], v[76:79]
    v_lshlrev_b32 v9, 12, v9
    v_and_b32 v7, 31, v0
    s_waitcnt lgkmcnt(8)
    v_mfma_f32_16x16x32_bf16 v[80:83], v[36:39], v[224:227], v[80:83]
    v_lshl_add_u32 v9, v7, 7, v9
    s_cmp_lt_u32 s38, 2
    s_cselect_b32 s3, -1, 0
    v_mfma_f32_16x16x32_bf16 v[84:87], v[36:39], v[228:231], v[84:87]
    v_and_b32 v9, s3, v9
    s_mul_i32 s53, s41, 1792
    s_add_u32 s53, s53, s46
    s_mul_i32 s47, s42, 3
    s_add_u32 s53, s53, s47
    s_lshl_b32 s53, s53, 10
    s_add_u32 s53, s53, 0x500000
    s_add_u32 s57, s53, 1835008
    s_mul_i32 s56, s60, 896
    s_add_u32 s56, s56, s53
    s_mov_b32 s46, 0xa0000
    s_waitcnt vmcnt(20)
    s_waitcnt lgkmcnt(6)
    v_mfma_f32_16x16x32_bf16 v[56:59], v[40:43], v[232:235], v[56:59]
    v_mfma_f32_16x16x32_bf16 v[60:63], v[40:43], v[236:239], v[60:63]
    s_waitcnt lgkmcnt(0)
    s_barrier
    s_add_u32 m0, s55, 0
    s_add_u32 s49, s60, 512
    s_and_b32 s49, s49, 2047
    s_add_u32 s49, s49, s54
    buffer_load_dwordx4 v16, s[28:31], s49 offen lds
    v_mfma_f32_16x16x32_bf16 v[88:91], v[40:43], v[20:23], v[88:91]
    s_add_u32 s49, s49, 31744
    buffer_load_dwordx4 v17, s[28:31], s49 offen offset:1024 lds
    v_mfma_f32_16x16x32_bf16 v[64:67], v[44:47], v[232:235], v[64:67]
    v_rcp_f32 v186, v185
    v_rcp_f32 v190, v189
    v_mfma_f32_16x16x32_bf16 v[68:71], v[44:47], v[236:239], v[68:71]
    v_mov_b32 v24, v185
    v_mov_b32 v26, v189
    v_mfma_f32_16x16x32_bf16 v[92:95], v[44:47], v[20:23], v[92:95]
    v_mov_b32 v104, v184
    v_mov_b32 v108, v188
    v_mfma_f32_16x16x32_bf16 v[72:75], v[48:51], v[232:235], v[72:75]
    v_mul_f32 v106, 0xc0135761, v186
    v_mul_f32 v110, 0xc0135761, v190
    v_mfma_f32_16x16x32_bf16 v[76:79], v[48:51], v[236:239], v[76:79]
    v_mul_f32 v187, v186, v186
    v_mul_f32 v191, v190, v190
    v_mfma_f32_16x16x32_bf16 v[80:83], v[52:55], v[232:235], v[80:83]
    v_mul_f32 v187, v187, v106
    v_mul_f32 v191, v191, v110
    v_mfma_f32_16x16x32_bf16 v[84:87], v[52:55], v[236:239], v[84:87]
    v_mul_f32 v28, 0x3d372713, v187
    v_mul_f32 v30, 0x3d372713, v191
    s_add_u32 s3, s55, 40960
    v_add_u32 v32, s3, v1
    ds_write_b128 v32, v[88:91] offset:0
    ds_write_b128 v32, v[92:95] offset:1024
    v_xor_b32 v33, 0x800, v32
    v_fma_f32 v56, v104, v88, v56
    v_fma_f32 v57, v104, v89, v57
    v_fma_f32 v58, v104, v90, v58
    v_fma_f32 v59, v104, v91, v59
    v_fma_f32 v60, v108, v88, v60
    v_fma_f32 v61, v108, v89, v61
    v_fma_f32 v62, v108, v90, v62
    v_fma_f32 v63, v108, v91, v63
    s_add_u32 s49, s60, 768
    s_and_b32 s49, s49, 2047
    s_add_u32 s49, s49, s58
    buffer_load_dwordx4 v[128:131], v16, s[28:31], s49 offen
    v_mul_f32 v112, v56, v56
    v_mul_f32 v113, v57, v57
    v_mul_f32 v114, v58, v58
    v_mul_f32 v115, v59, v59
    v_mul_f32 v116, v60, v60
    v_mul_f32 v117, v61, v61
    v_mul_f32 v118, v62, v62
    v_mul_f32 v119, v63, v63
    s_add_u32 s49, s49, 32768
    buffer_load_dwordx4 v[132:135], v17, s[28:31], s49 offen
    v_fma_f32 v112, v112, v28, v106
    v_fma_f32 v113, v113, v28, v106
    v_fma_f32 v114, v114, v28, v106
    v_fma_f32 v115, v115, v28, v106
    v_fma_f32 v116, v116, v30, v110
    v_fma_f32 v117, v117, v30, v110
    v_fma_f32 v118, v118, v30, v110
    v_fma_f32 v119, v119, v30, v110
    s_add_u32 s49, s49, 32768
    buffer_load_dwordx4 v[136:139], v16, s[28:31], s49 offen
    v_mul_f32 v112, v112, v56
    v_mul_f32 v113, v113, v57
    v_mul_f32 v114, v114, v58
    v_mul_f32 v115, v115, v59
    v_mul_f32 v116, v116, v60
    v_mul_f32 v117, v117, v61
    v_mul_f32 v118, v118, v62
    v_mul_f32 v119, v119, v63
    s_add_u32 s49, s49, 32768
    buffer_load_dwordx4 v[140:143], v17, s[28:31], s49 offen
    v_exp_f32 v112, v112
    v_exp_f32 v113, v113
    v_exp_f32 v114, v114
    v_exp_f32 v115, v115
    v_exp_f32 v116, v116
    v_exp_f32 v117, v117
    v_exp_f32 v118, v118
    v_exp_f32 v119, v119
    s_add_u32 s49, s60, 1024
    s_and_b32 s49, s49, 2047
    s_add_u32 s49, s49, s58
    buffer_load_dwordx4 v[144:147], v16, s[28:31], s49 offen
    s_add_u32 s49, s49, 32768
    buffer_load_dwordx4 v[148:151], v17, s[28:31], s49 offen
    v_fma_f32 v112, v112, v24, v24
    v_fma_f32 v113, v113, v24, v24
    v_fma_f32 v114, v114, v24, v24
    v_fma_f32 v115, v115, v24, v24
    v_fma_f32 v116, v116, v26, v26
    v_fma_f32 v117, v117, v26, v26
    v_fma_f32 v118, v118, v26, v26
    v_fma_f32 v119, v119, v26, v26
    s_add_u32 s49, s49, 32768
    buffer_load_dwordx4 v[152:155], v16, s[28:31], s49 offen
    v_rcp_f32 v112, v112
    v_rcp_f32 v113, v113
    v_rcp_f32 v114, v114
    v_rcp_f32 v115, v115
    v_rcp_f32 v116, v116
    v_rcp_f32 v117, v117
    v_rcp_f32 v118, v118
    v_rcp_f32 v119, v119
    s_add_u32 s49, s49, 32768
    buffer_load_dwordx4 v[156:159], v17, s[28:31], s49 offen
    s_add_u32 s49, s60, 1280
    s_and_b32 s49, s49, 2047
    s_add_u32 s49, s49, s58
    buffer_load_dwordx4 v[160:163], v16, s[28:31], s49 offen
    v_mul_f32 v56, v56, v112
    v_mul_f32 v57, v57, v113
    v_mul_f32 v58, v58, v114
    v_mul_f32 v59, v59, v115
    v_mul_f32 v60, v60, v116
    v_mul_f32 v61, v61, v117
    v_mul_f32 v62, v62, v118
    v_mul_f32 v63, v63, v119
    s_add_u32 s49, s49, 32768
    buffer_load_dwordx4 v[164:167], v17, s[28:31], s49 offen
    v_cvt_pk_bf16_f32 v240, v56, v57
    v_cvt_pk_bf16_f32 v241, v58, v59
    v_cvt_pk_bf16_f32 v242, v60, v61
    v_cvt_pk_bf16_f32 v243, v62, v63
    s_waitcnt lgkmcnt(0)
    s_barrier
    ds_read_b128 v[96:99], v33 offset:0
    ds_read_b128 v[100:103], v33 offset:1024
    v_fma_f32 v64, v104, v92, v64
    v_fma_f32 v65, v104, v93, v65
    v_fma_f32 v66, v104, v94, v66
    v_fma_f32 v67, v104, v95, v67
    v_fma_f32 v68, v108, v92, v68
    v_fma_f32 v69, v108, v93, v69
    v_fma_f32 v70, v108, v94, v70
    v_fma_f32 v71, v108, v95, v71
    s_add_u32 s49, s49, 32768
    buffer_load_dwordx4 v[168:171], v16, s[28:31], s49 offen
    v_mul_f32 v112, v64, v64
    v_mul_f32 v113, v65, v65
    v_mul_f32 v114, v66, v66
    v_mul_f32 v115, v67, v67
    v_mul_f32 v116, v68, v68
    v_mul_f32 v117, v69, v69
    v_mul_f32 v118, v70, v70
    v_mul_f32 v119, v71, v71
    s_add_u32 s49, s49, 32768
    buffer_load_dwordx4 v[172:175], v17, s[28:31], s49 offen
    v_fma_f32 v112, v112, v28, v106
    v_fma_f32 v113, v113, v28, v106
    v_fma_f32 v114, v114, v28, v106
    v_fma_f32 v115, v115, v28, v106
    v_fma_f32 v116, v116, v30, v110
    v_fma_f32 v117, v117, v30, v110
    v_fma_f32 v118, v118, v30, v110
    v_fma_f32 v119, v119, v30, v110
    s_add_u32 s49, s60, 1536
    s_and_b32 s49, s49, 2047
    s_add_u32 s49, s49, s58
    buffer_load_dwordx4 v[176:179], v16, s[28:31], s49 offen
    v_mul_f32 v112, v112, v64
    v_mul_f32 v113, v113, v65
    v_mul_f32 v114, v114, v66
    v_mul_f32 v115, v115, v67
    v_mul_f32 v116, v116, v68
    v_mul_f32 v117, v117, v69
    v_mul_f32 v118, v118, v70
    v_mul_f32 v119, v119, v71
    s_add_u32 s49, s49, 32768
    buffer_load_dwordx4 v[180:183], v17, s[28:31], s49 offen
    v_exp_f32 v112, v112
    v_exp_f32 v113, v113
    v_exp_f32 v114, v114
    v_exp_f32 v115, v115
    v_exp_f32 v116, v116
    v_exp_f32 v117, v117
    v_exp_f32 v118, v118
    v_exp_f32 v119, v119
    s_add_u32 s49, s49, 32768
    buffer_load_dwordx4 v[184:187], v16, s[28:31], s49 offen
    s_add_u32 s49, s49, 32768
    buffer_load_dwordx4 v[188:191], v17, s[28:31], s49 offen
    v_fma_f32 v112, v112, v24, v24
    v_fma_f32 v113, v113, v24, v24
    v_fma_f32 v114, v114, v24, v24
    v_fma_f32 v115, v115, v24, v24
    v_fma_f32 v116, v116, v26, v26
    v_fma_f32 v117, v117, v26, v26
    v_fma_f32 v118, v118, v26, v26
    v_fma_f32 v119, v119, v26, v26
    s_add_u32 s49, s60, 1792
    s_and_b32 s49, s49, 2047
    s_add_u32 s49, s49, s58
    buffer_load_dwordx4 v[192:195], v16, s[28:31], s49 offen
    v_rcp_f32 v112, v112
    v_rcp_f32 v113, v113
    v_rcp_f32 v114, v114
    v_rcp_f32 v115, v115
    v_rcp_f32 v116, v116
    v_rcp_f32 v117, v117
    v_rcp_f32 v118, v118
    v_rcp_f32 v119, v119
    s_add_u32 s49, s49, 32768
    buffer_load_dwordx4 v[196:199], v17, s[28:31], s49 offen
    s_add_u32 s49, s49, 32768
    buffer_load_dwordx4 v[200:203], v16, s[28:31], s49 offen
    v_mul_f32 v64, v64, v112
    v_mul_f32 v65, v65, v113
    v_mul_f32 v66, v66, v114
    v_mul_f32 v67, v67, v115
    v_mul_f32 v68, v68, v116
    v_mul_f32 v69, v69, v117
    v_mul_f32 v70, v70, v118
    v_mul_f32 v71, v71, v119
    s_add_u32 s49, s49, 32768
    buffer_load_dwordx4 v[204:207], v17, s[28:31], s49 offen
    v_cvt_pk_bf16_f32 v244, v64, v65
    v_cvt_pk_bf16_f32 v245, v66, v67
    v_cvt_pk_bf16_f32 v246, v68, v69
    v_cvt_pk_bf16_f32 v247, v70, v71
    s_waitcnt lgkmcnt(0)
    v_fma_f32 v72, v104, v96, v72
    v_fma_f32 v73, v104, v97, v73
    v_fma_f32 v74, v104, v98, v74
    v_fma_f32 v75, v104, v99, v75
    v_fma_f32 v76, v108, v96, v76
    v_fma_f32 v77, v108, v97, v77
    v_fma_f32 v78, v108, v98, v78
    v_fma_f32 v79, v108, v99, v79
    v_mul_f32 v112, v72, v72
    v_mul_f32 v113, v73, v73
    v_mul_f32 v114, v74, v74
    v_mul_f32 v115, v75, v75
    v_mul_f32 v116, v76, v76
    v_mul_f32 v117, v77, v77
    v_mul_f32 v118, v78, v78
    v_mul_f32 v119, v79, v79
    v_fma_f32 v112, v112, v28, v106
    v_fma_f32 v113, v113, v28, v106
    v_fma_f32 v114, v114, v28, v106
    v_fma_f32 v115, v115, v28, v106
    v_fma_f32 v116, v116, v30, v110
    v_fma_f32 v117, v117, v30, v110
    v_fma_f32 v118, v118, v30, v110
    v_fma_f32 v119, v119, v30, v110
    v_mul_f32 v112, v112, v72
    v_mul_f32 v113, v113, v73
    v_mul_f32 v114, v114, v74
    v_mul_f32 v115, v115, v75
    v_mul_f32 v116, v116, v76
    v_mul_f32 v117, v117, v77
    v_mul_f32 v118, v118, v78
    v_mul_f32 v119, v119, v79
    v_exp_f32 v112, v112
    v_exp_f32 v113, v113
    v_exp_f32 v114, v114
    v_exp_f32 v115, v115
    v_exp_f32 v116, v116
    v_exp_f32 v117, v117
    v_exp_f32 v118, v118
    v_exp_f32 v119, v119
    buffer_load_dwordx2 v[252:253], v9, s[24:27], s46 offen sc1
    v_fma_f32 v112, v112, v24, v24
    v_fma_f32 v113, v113, v24, v24
    v_fma_f32 v114, v114, v24, v24
    v_fma_f32 v115, v115, v24, v24
    v_fma_f32 v116, v116, v26, v26
    v_fma_f32 v117, v117, v26, v26
    v_fma_f32 v118, v118, v26, v26
    v_fma_f32 v119, v119, v26, v26
    v_rcp_f32 v112, v112
    v_rcp_f32 v113, v113
    v_rcp_f32 v114, v114
    v_rcp_f32 v115, v115
    v_rcp_f32 v116, v116
    v_rcp_f32 v117, v117
    v_rcp_f32 v118, v118
    v_rcp_f32 v119, v119
    v_mul_f32 v72, v72, v112
    v_mul_f32 v73, v73, v113
    v_mul_f32 v74, v74, v114
    v_mul_f32 v75, v75, v115
    v_mul_f32 v76, v76, v116
    v_mul_f32 v77, v77, v117
    v_mul_f32 v78, v78, v118
    v_mul_f32 v79, v79, v119
    v_cvt_pk_bf16_f32 v248, v72, v73
    v_cvt_pk_bf16_f32 v249, v74, v75
    v_cvt_pk_bf16_f32 v250, v76, v77
    v_cvt_pk_bf16_f32 v251, v78, v79
    s_cmp_ge_u32 s38, 2
    s_cbranch_scc1 L_fz_ok
    s_waitcnt vmcnt(0)
    v_cmp_ne_u64 s[62:63], v[252:253], s[36:37]
    s_nop 0
    s_cmp_eq_u64 s[62:63], 0
    s_cbranch_scc1 L_fz_ok
    s_mov_b32 s61, 16384
L_fz:
    buffer_load_dwordx2 v[252:253], v9, s[24:27], s46 offen sc1
    s_waitcnt vmcnt(0)
    v_cmp_ne_u64 s[62:63], v[252:253], s[36:37]
    s_nop 0
    s_cmp_eq_u64 s[62:63], 0
    s_cbranch_scc1 L_fz_ok
    s_sleep 2
    s_sub_u32 s61, s61, 1
    s_cbranch_scc0 L_fz
L_fz_ok:
    s_barrier
    s_cmp_eq_u32 s42, 1
    s_cbranch_scc1 L_g2b
    buffer_load_dwordx4 v[120:123], v1, s[24:27], s56 offen offset:0 sc1
    buffer_load_dwordx4 v[124:127], v1, s[24:27], s56 offen offset:1024 sc1
    buffer_load_dwordx4 v[208:211], v1, s[24:27], s56 offen offset:2048 sc1
    buffer_load_dwordx4 v[212:215], v1, s[24:27], s56 offen offset:3072 sc1
    v_fma_f32 v80, v104, v100, v80
    v_fma_f32 v81, v104, v101, v81
    v_fma_f32 v82, v104, v102, v82
    v_fma_f32 v83, v104, v103, v83
    v_fma_f32 v84, v108, v100, v84
    v_fma_f32 v85, v108, v101, v85
    v_fma_f32 v86, v108, v102, v86
    v_fma_f32 v87, v108, v103, v87
    s_add_u32 s56, s56, 57344
    buffer_load_dwordx4 v[216:219], v1, s[24:27], s56 offen offset:0 sc1
    v_mul_f32 v112, v80, v80
    v_mul_f32 v113, v81, v81
    v_mul_f32 v114, v82, v82
    v_mul_f32 v115, v83, v83
    v_mul_f32 v116, v84, v84
    v_mul_f32 v117, v85, v85
    v_mul_f32 v118, v86, v86
    v_mul_f32 v119, v87, v87
    buffer_load_dwordx4 v[220:223], v1, s[24:27], s56 offen offset:1024 sc1
    v_fma_f32 v112, v112, v28, v106
    v_fma_f32 v113, v113, v28, v106
    v_fma_f32 v114, v114, v28, v106
    v_fma_f32 v115, v115, v28, v106
    v_fma_f32 v116, v116, v30, v110
    v_fma_f32 v117, v117, v30, v110
    v_fma_f32 v118, v118, v30, v110
    v_fma_f32 v119, v119, v30, v110
    buffer_load_dwordx4 v[224:227], v1, s[24:27], s56 offen offset:2048 sc1
    v_mul_f32 v112, v112, v80
    v_mul_f32 v113, v113, v81
    v_mul_f32 v114, v114, v82
    v_mul_f32 v115, v115, v83
    v_mul_f32 v116, v116, v84
    v_mul_f32 v117, v117, v85
    v_mul_f32 v118, v118, v86
    v_mul_f32 v119, v119, v87
    s_add_u32 s56, s56, 57344
    buffer_load_dwordx4 v[228:231], v1, s[24:27], s56 offen offset:0 sc1
    v_exp_f32 v112, v112
    v_exp_f32 v113, v113
    v_exp_f32 v114, v114
    v_exp_f32 v115, v115
    v_exp_f32 v116, v116
    v_exp_f32 v117, v117
    v_exp_f32 v118, v118
    v_exp_f32 v119, v119
    buffer_load_dwordx4 v[232:235], v1, s[24:27], s56 offen offset:1024 sc1
    buffer_load_dwordx4 v[236:239], v1, s[24:27], s56 offen offset:2048 sc1
    v_fma_f32 v112, v112, v24, v24
    v_fma_f32 v113, v113, v24, v24
    v_fma_f32 v114, v114, v24, v24
    v_fma_f32 v115, v115, v24, v24
    v_fma_f32 v116, v116, v26, v26
    v_fma_f32 v117, v117, v26, v26
    v_fma_f32 v118, v118, v26, v26
    v_fma_f32 v119, v119, v26, v26
    buffer_load_dwordx4 v[20:23], v1, s[24:27], s56 offen offset:3072 sc1
    v_rcp_f32 v112, v112
    v_rcp_f32 v113, v113
    v_rcp_f32 v114, v114
    v_rcp_f32 v115, v115
    v_rcp_f32 v116, v116
    v_rcp_f32 v117, v117
    v_rcp_f32 v118, v118
    v_rcp_f32 v119, v119
    s_add_u32 m0, s55, 40960
    s_add_u32 s49, s60, 512
    s_and_b32 s49, s49, 2047
    s_add_u32 s49, s49, s54
    s_add_u32 s49, s49, 2048
    buffer_load_dwordx4 v16, s[28:31], s49 offen lds
    s_add_u32 s49, s49, 31744
    buffer_load_dwordx4 v17, s[28:31], s49 offen offset:1024 lds
    v_mul_f32 v80, v80, v112
    v_mul_f32 v81, v81, v113
    v_mul_f32 v82, v82, v114
    v_mul_f32 v83, v83, v115
    v_mul_f32 v84, v84, v116
    v_mul_f32 v85, v85, v117
    v_mul_f32 v86, v86, v118
    v_mul_f32 v87, v87, v119
    v_cvt_pk_bf16_f32 v4, v80, v81
    v_cvt_pk_bf16_f32 v5, v82, v83
    v_cvt_pk_bf16_f32 v6, v84, v85
    v_cvt_pk_bf16_f32 v7, v86, v87
    s_cmp_eq_u32 s41, 0
    s_cbranch_scc1 L_csw0
    v_swap_b32 v240, v248
    v_swap_b32 v241, v249
    v_swap_b32 v242, v250
    v_swap_b32 v243, v251
    v_swap_b32 v244, v4
    v_swap_b32 v245, v5
    v_swap_b32 v246, v6
    v_swap_b32 v247, v7
L_csw0:
    v_and_b32 v112, 0xffff0000, v14
    v_and_b32 v113, 0xffff0000, v14
    v_and_b32 v114, 0xffff0000, v14
    v_and_b32 v115, 0xffff0000, v14
    v_and_b32 v116, 0xffff0000, v15
    v_and_b32 v117, 0xffff0000, v15
    v_and_b32 v118, 0xffff0000, v15
    v_and_b32 v119, 0xffff0000, v15
    s_waitcnt vmcnt(48)
    s_barrier
    ds_read_b128 v[24:27], v10 offset:8192
    ds_read_b128 v[28:31], v10 offset:8704
    ds_read_b128 v[32:35], v11 offset:8192
    ds_read_b128 v[36:39], v11 offset:8704
    s_waitcnt vmcnt(12) lgkmcnt(0)
    v_mfma_f32_16x16x32_bf16 v[56:59], v[120:123], v[24:27], v[112:115]
    s_add_u32 s56, s56, 57344
    ds_read_b128 v[40:43], v12 offset:8192
    v_mfma_f32_16x16x32_bf16 v[60:63], v[120:123], v[28:31], v[116:119]
    ds_read_b128 v[44:47], v12 offset:8704
    ds_read_b128 v[48:51], v13 offset:8192
    v_mfma_f32_16x16x32_bf16 v[64:67], v[120:123], v[32:35], 0
    ds_read_b128 v[52:55], v13 offset:8704
    v_mfma_f32_16x16x32_bf16 v[68:71], v[120:123], v[36:39], 0
    s_waitcnt vmcnt(11)
    v_mfma_f32_16x16x32_bf16 v[72:75], v[124:127], v[24:27], v[112:115]
    buffer_load_dwordx4 v[120:123], v1, s[24:27], s56 offen offset:0 sc1
    v_mfma_f32_16x16x32_bf16 v[76:79], v[124:127], v[28:31], v[116:119]
    v_mfma_f32_16x16x32_bf16 v[80:83], v[124:127], v[32:35], 0
    v_mfma_f32_16x16x32_bf16 v[84:87], v[124:127], v[36:39], 0
    s_waitcnt vmcnt(11)
    v_mfma_f32_16x16x32_bf16 v[88:91], v[208:211], v[24:27], v[112:115]
    buffer_load_dwordx4 v[124:127], v1, s[24:27], s56 offen offset:1024 sc1
    v_mfma_f32_16x16x32_bf16 v[92:95], v[208:211], v[28:31], v[116:119]
    v_mfma_f32_16x16x32_bf16 v[96:99], v[208:211], v[32:35], 0
    v_mfma_f32_16x16x32_bf16 v[100:103], v[208:211], v[36:39], 0
    s_waitcnt vmcnt(11)
    v_mfma_f32_16x16x32_bf16 v[104:107], v[212:215], v[24:27], v[112:115]
    buffer_load_dwordx4 v[208:211], v1, s[24:27], s56 offen offset:2048 sc1
    v_mfma_f32_16x16x32_bf16 v[108:111], v[212:215], v[28:31], v[116:119]
    s_add_u32 s56, s56, 57344
    v_mfma_f32_16x16x32_bf16 v[112:115], v[212:215], v[32:35], 0
    s_cmp_eq_u32 s56, s57
    s_cselect_b32 s56, s53, s56
    v_mfma_f32_16x16x32_bf16 v[116:119], v[212:215], v[36:39], 0
    s_waitcnt vmcnt(11) lgkmcnt(0)
    v_mfma_f32_16x16x32_bf16 v[56:59], v[216:219], v[40:43], v[56:59]
    buffer_load_dwordx4 v[212:215], v1, s[24:27], s56 offen offset:0 sc1
    v_mfma_f32_16x16x32_bf16 v[60:63], v[216:219], v[44:47], v[60:63]
    ds_read_b128 v[24:27], v10 offset:16384
    ds_read_b128 v[28:31], v10 offset:16896
    v_mfma_f32_16x16x32_bf16 v[64:67], v[216:219], v[48:51], v[64:67]
    ds_read_b128 v[32:35], v11 offset:16384
    ds_read_b128 v[36:39], v11 offset:16896
    v_mfma_f32_16x16x32_bf16 v[68:71], v[216:219], v[52:55], v[68:71]
    s_waitcnt vmcnt(11)
    v_mfma_f32_16x16x32_bf16 v[72:75], v[220:223], v[40:43], v[72:75]
    buffer_load_dwordx4 v[216:219], v1, s[24:27], s56 offen offset:1024 sc1
    v_mfma_f32_16x16x32_bf16 v[76:79], v[220:223], v[44:47], v[76:79]
    s_barrier
    v_mfma_f32_16x16x32_bf16 v[80:83], v[220:223], v[48:51], v[80:83]
    s_add_u32 m0, s52, 8192
    s_add_u32 s49, s60, 640
    v_mfma_f32_16x16x32_bf16 v[84:87], v[220:223], v[52:55], v[84:87]
    s_and_b32 s49, s49, 2047
    s_waitcnt vmcnt(11)
    v_mfma_f32_16x16x32_bf16 v[88:91], v[224:227], v[40:43], v[88:91]
    buffer_load_dwordx4 v[220:223], v1, s[24:27], s56 offen offset:2048 sc1
    v_mfma_f32_16x16x32_bf16 v[92:95], v[224:227], v[44:47], v[92:95]
    s_add_u32 s49, s49, s58
    v_mfma_f32_16x16x32_bf16 v[96:99], v[224:227], v[48:51], v[96:99]
    buffer_load_dwordx4 v16, s[28:31], s49 offen offset:0 lds
    v_mfma_f32_16x16x32_bf16 v[100:103], v[224:227], v[52:55], v[100:103]
    s_add_u32 s49, s49, 31744
    s_waitcnt vmcnt(12) lgkmcnt(0)
    v_mfma_f32_16x16x32_bf16 v[56:59], v[228:231], v[24:27], v[56:59]
    buffer_load_dwordx4 v[224:227], v1, s[24:27], s56 offen offset:3072 sc1
    v_mfma_f32_16x16x32_bf16 v[60:63], v[228:231], v[28:31], v[60:63]
    s_add_u32 s56, s56, 57344
    ds_read_b128 v[40:43], v12 offset:16384
    v_mfma_f32_16x16x32_bf16 v[64:67], v[228:231], v[32:35], v[64:67]
    ds_read_b128 v[44:47], v12 offset:16896
    ds_read_b128 v[48:51], v13 offset:16384
    v_mfma_f32_16x16x32_bf16 v[68:71], v[228:231], v[36:39], v[68:71]
    ds_read_b128 v[52:55], v13 offset:16896
    s_waitcnt vmcnt(12)
    v_mfma_f32_16x16x32_bf16 v[72:75], v[232:235], v[24:27], v[72:75]
    buffer_load_dwordx4 v[228:231], v1, s[24:27], s56 offen offset:0 sc1
    v_mfma_f32_16x16x32_bf16 v[76:79], v[232:235], v[28:31], v[76:79]
    buffer_load_dwordx4 v17, s[28:31], s49 offen offset:1024 lds
    v_mfma_f32_16x16x32_bf16 v[80:83], v[232:235], v[32:35], v[80:83]
    s_add_u32 s49, s49, 31744
    v_and_b32 v18, 31, v0
    v_mfma_f32_16x16x32_bf16 v[84:87], v[232:235], v[36:39], v[84:87]
    v_lshlrev_b32 v18, 7, v18
    s_waitcnt vmcnt(13)
    v_mfma_f32_16x16x32_bf16 v[88:91], v[236:239], v[24:27], v[88:91]
    buffer_load_dwordx4 v[232:235], v1, s[24:27], s56 offen offset:1024 sc1
    v_mfma_f32_16x16x32_bf16 v[92:95], v[236:239], v[28:31], v[92:95]
    buffer_load_dwordx4 v16, s[28:31], s49 offen offset:2048 lds
    v_mfma_f32_16x16x32_bf16 v[96:99], v[236:239], v[32:35], v[96:99]
    s_add_u32 s49, s49, 31744
    s_mul_i32 s45, s43, 114688
    v_mfma_f32_16x16x32_bf16 v[100:103], v[236:239], v[36:39], v[100:103]
    s_mul_i32 s46, s38, 7168
    s_waitcnt vmcnt(14)
    v_mfma_f32_16x16x32_bf16 v[104:107], v[20:23], v[24:27], v[104:107]
    buffer_load_dwordx4 v[236:239], v1, s[24:27], s56 offen offset:2048 sc1
    v_mfma_f32_16x16x32_bf16 v[108:111], v[20:23], v[28:31], v[108:111]
    s_add_u32 s56, s56, 57344
    s_add_u32 s45, s45, s46
    v_mfma_f32_16x16x32_bf16 v[112:115], v[20:23], v[32:35], v[112:115]
    buffer_load_dwordx4 v17, s[28:31], s49 offen offset:3072 lds
    v_mfma_f32_16x16x32_bf16 v[116:119], v[20:23], v[36:39], v[116:119]
    s_add_u32 s45, s45, 0x1100000
    s_waitcnt vmcnt(13) lgkmcnt(0)
    v_mfma_f32_16x16x32_bf16 v[56:59], v[120:123], v[40:43], v[56:59]
    buffer_load_dwordx4 v[20:23], v1, s[24:27], s56 offen offset:0 sc1
    v_mfma_f32_16x16x32_bf16 v[60:63], v[120:123], v[44:47], v[60:63]
    ds_read_b128 v[24:27], v10 offset:24576
    ds_read_b128 v[28:31], v10 offset:25088
    v_mfma_f32_16x16x32_bf16 v[64:67], v[120:123], v[48:51], v[64:67]
    ds_read_b128 v[32:35], v11 offset:24576
    ds_read_b128 v[36:39], v11 offset:25088
    v_mfma_f32_16x16x32_bf16 v[68:71], v[120:123], v[52:55], v[68:71]
    s_add_u32 s46, s45, 28672
    s_waitcnt vmcnt(13)
    v_mfma_f32_16x16x32_bf16 v[72:75], v[124:127], v[40:43], v[72:75]
    buffer_load_dwordx4 v[120:123], v1, s[24:27], s56 offen offset:1024 sc1
    v_mfma_f32_16x16x32_bf16 v[76:79], v[124:127], v[44:47], v[76:79]
    s_barrier
    v_mfma_f32_16x16x32_bf16 v[80:83], v[124:127], v[48:51], v[80:83]
    ds_write_b128 v8, v[128:131] offset:16384
    v_mfma_f32_16x16x32_bf16 v[84:87], v[124:127], v[52:55], v[84:87]
    s_add_u32 s47, s46, 28672
    s_waitcnt vmcnt(13)
    v_mfma_f32_16x16x32_bf16 v[88:91], v[208:211], v[40:43], v[88:91]
    buffer_load_dwordx4 v[124:127], v1, s[24:27], s56 offen offset:2048 sc1
    v_mfma_f32_16x16x32_bf16 v[92:95], v[208:211], v[44:47], v[92:95]
    ds_write_b128 v8, v[132:135] offset:17408
    v_mfma_f32_16x16x32_bf16 v[96:99], v[208:211], v[48:51], v[96:99]
    ds_write_b128 v8, v[136:139] offset:18432
    v_mfma_f32_16x16x32_bf16 v[100:103], v[208:211], v[52:55], v[100:103]
    s_add_u32 s50, s47, 28672
    s_waitcnt vmcnt(13) lgkmcnt(3)
    v_mfma_f32_16x16x32_bf16 v[56:59], v[212:215], v[24:27], v[56:59]
    buffer_load_dwordx4 v[208:211], v1, s[24:27], s56 offen offset:3072 sc1
    v_mfma_f32_16x16x32_bf16 v[60:63], v[212:215], v[28:31], v[60:63]
    s_add_u32 s56, s56, 57344
    ds_read_b128 v[40:43], v12 offset:24576
    v_mfma_f32_16x16x32_bf16 v[64:67], v[212:215], v[32:35], v[64:67]
    ds_read_b128 v[44:47], v12 offset:25088
    ds_read_b128 v[48:51], v13 offset:24576
    v_mfma_f32_16x16x32_bf16 v[68:71], v[212:215], v[36:39], v[68:71]
    ds_read_b128 v[52:55], v13 offset:25088
    s_waitcnt vmcnt(13)
    v_mfma_f32_16x16x32_bf16 v[72:75], v[216:219], v[24:27], v[72:75]
    buffer_load_dwordx4 v[212:215], v1, s[24:27], s56 offen offset:0 sc1
    v_mfma_f32_16x16x32_bf16 v[76:79], v[216:219], v[28:31], v[76:79]
    ds_write_b128 v8, v[140:143] offset:19456
    v_mfma_f32_16x16x32_bf16 v[80:83], v[216:219], v[32:35], v[80:83]
    s_add_u32 s98, s40, s39
    s_and_b32 s98, s98, 3
    v_mfma_f32_16x16x32_bf16 v[84:87], v[216:219], v[36:39], v[84:87]
    s_waitcnt vmcnt(13)
    v_mfma_f32_16x16x32_bf16 v[88:91], v[220:223], v[24:27], v[88:91]
    buffer_load_dwordx4 v[216:219], v1, s[24:27], s56 offen offset:1024 sc1
    v_mfma_f32_16x16x32_bf16 v[92:95], v[220:223], v[28:31], v[92:95]
    s_cmp_eq_u32 s98, 3
    s_cselect_b32 s98, 0, s98
    v_mfma_f32_16x16x32_bf16 v[96:99], v[220:223], v[32:35], v[96:99]
    s_lshl_b32 s98, s98, 10
    s_add_u32 s99, s98, 1024
    v_mfma_f32_16x16x32_bf16 v[100:103], v[220:223], v[36:39], v[100:103]
    s_waitcnt vmcnt(12)
    v_mfma_f32_16x16x32_bf16 v[104:107], v[224:227], v[24:27], v[104:107]
    buffer_load_dwordx4 v[220:223], v1, s[24:27], s56 offen offset:2048 sc1
    v_mfma_f32_16x16x32_bf16 v[108:111], v[224:227], v[28:31], v[108:111]
    s_add_u32 s56, s56, 57344
    v_mfma_f32_16x16x32_bf16 v[112:115], v[224:227], v[32:35], v[112:115]
    s_cmp_eq_u32 s56, s57
    s_cselect_b32 s56, s53, s56
    v_mfma_f32_16x16x32_bf16 v[116:119], v[224:227], v[36:39], v[116:119]
    s_waitcnt vmcnt(12) lgkmcnt(1)
    v_mfma_f32_16x16x32_bf16 v[56:59], v[228:231], v[40:43], v[56:59]
    buffer_load_dwordx4 v[224:227], v1, s[24:27], s56 offen offset:0 sc1
    v_mfma_f32_16x16x32_bf16 v[60:63], v[228:231], v[44:47], v[60:63]
    ds_read_b128 v[24:27], v10 offset:32768
    ds_read_b128 v[28:31], v10 offset:33280
    v_mfma_f32_16x16x32_bf16 v[64:67], v[228:231], v[48:51], v[64:67]
    ds_read_b128 v[32:35], v11 offset:32768
    ds_read_b128 v[36:39], v11 offset:33280
    v_mfma_f32_16x16x32_bf16 v[68:71], v[228:231], v[52:55], v[68:71]
    s_waitcnt vmcnt(11)
    v_mfma_f32_16x16x32_bf16 v[72:75], v[232:235], v[40:43], v[72:75]
    buffer_load_dwordx4 v[228:231], v1, s[24:27], s56 offen offset:1024 sc1
    v_mfma_f32_16x16x32_bf16 v[76:79], v[232:235], v[44:47], v[76:79]
    s_barrier
    v_mfma_f32_16x16x32_bf16 v[80:83], v[232:235], v[48:51], v[80:83]
    s_add_u32 m0, s52, 24576
    s_add_u32 s49, s60, 896
    v_mfma_f32_16x16x32_bf16 v[84:87], v[232:235], v[52:55], v[84:87]
    s_and_b32 s49, s49, 2047
    s_waitcnt vmcnt(10)
    v_mfma_f32_16x16x32_bf16 v[88:91], v[236:239], v[40:43], v[88:91]
    buffer_load_dwordx4 v[232:235], v1, s[24:27], s56 offen offset:2048 sc1
    v_mfma_f32_16x16x32_bf16 v[92:95], v[236:239], v[44:47], v[92:95]
    s_add_u32 s49, s49, s58
    v_mfma_f32_16x16x32_bf16 v[96:99], v[236:239], v[48:51], v[96:99]
    buffer_load_dwordx4 v16, s[28:31], s49 offen offset:0 lds
    v_mfma_f32_16x16x32_bf16 v[100:103], v[236:239], v[52:55], v[100:103]
    s_add_u32 s49, s49, 31744
    s_waitcnt vmcnt(10) lgkmcnt(0)
    v_mfma_f32_16x16x32_bf16 v[56:59], v[20:23], v[24:27], v[56:59]
    buffer_load_dwordx4 v[236:239], v1, s[24:27], s56 offen offset:3072 sc1
    v_mfma_f32_16x16x32_bf16 v[60:63], v[20:23], v[28:31], v[60:63]
    s_add_u32 s56, s56, 57344
    ds_read_b128 v[40:43], v12 offset:32768
    v_mfma_f32_16x16x32_bf16 v[64:67], v[20:23], v[32:35], v[64:67]
    ds_read_b128 v[44:47], v12 offset:33280
    ds_read_b128 v[48:51], v13 offset:32768
    v_mfma_f32_16x16x32_bf16 v[68:71], v[20:23], v[36:39], v[68:71]
    ds_read_b128 v[52:55], v13 offset:33280
    s_waitcnt vmcnt(10)
    v_mfma_f32_16x16x32_bf16 v[72:75], v[120:123], v[24:27], v[72:75]
    buffer_load_dwordx4 v[20:23], v1, s[24:27], s56 offen offset:0 sc1
    v_mfma_f32_16x16x32_bf16 v[76:79], v[120:123], v[28:31], v[76:79]
    buffer_load_dwordx4 v17, s[28:31], s49 offen offset:1024 lds
    v_mfma_f32_16x16x32_bf16 v[80:83], v[120:123], v[32:35], v[80:83]
    s_add_u32 s49, s49, 31744
    v_mfma_f32_16x16x32_bf16 v[84:87], v[120:123], v[36:39], v[84:87]
    s_waitcnt vmcnt(11)
    v_mfma_f32_16x16x32_bf16 v[88:91], v[124:127], v[24:27], v[88:91]
    buffer_load_dwordx4 v[120:123], v1, s[24:27], s56 offen offset:1024 sc1
    v_mfma_f32_16x16x32_bf16 v[92:95], v[124:127], v[28:31], v[92:95]
    buffer_load_dwordx4 v16, s[28:31], s49 offen offset:2048 lds
    v_mfma_f32_16x16x32_bf16 v[96:99], v[124:127], v[32:35], v[96:99]
    s_add_u32 s49, s49, 31744
    v_mfma_f32_16x16x32_bf16 v[100:103], v[124:127], v[36:39], v[100:103]
    s_waitcnt vmcnt(12)
    v_mfma_f32_16x16x32_bf16 v[104:107], v[208:211], v[24:27], v[104:107]
    buffer_load_dwordx4 v[124:127], v1, s[24:27], s56 offen offset:2048 sc1
    v_mfma_f32_16x16x32_bf16 v[108:111], v[208:211], v[28:31], v[108:111]
    s_add_u32 s56, s56, 57344
    v_mfma_f32_16x16x32_bf16 v[112:115], v[208:211], v[32:35], v[112:115]
    buffer_load_dwordx4 v17, s[28:31], s49 offen offset:3072 lds
    v_mfma_f32_16x16x32_bf16 v[116:119], v[208:211], v[36:39], v[116:119]
    s_waitcnt vmcnt(13) lgkmcnt(0)
    v_mfma_f32_16x16x32_bf16 v[56:59], v[212:215], v[40:43], v[56:59]
    buffer_load_dwordx4 v[208:211], v1, s[24:27], s56 offen offset:0 sc1
    v_mfma_f32_16x16x32_bf16 v[60:63], v[212:215], v[44:47], v[60:63]
    ds_read_b128 v[24:27], v10 offset:0
    ds_read_b128 v[28:31], v10 offset:512
    v_mfma_f32_16x16x32_bf16 v[64:67], v[212:215], v[48:51], v[64:67]
    ds_read_b128 v[32:35], v11 offset:0
    ds_read_b128 v[36:39], v11 offset:512
    v_mfma_f32_16x16x32_bf16 v[68:71], v[212:215], v[52:55], v[68:71]
    s_waitcnt vmcnt(13)
    v_mfma_f32_16x16x32_bf16 v[72:75], v[216:219], v[40:43], v[72:75]
    buffer_load_dwordx4 v[212:215], v1, s[24:27], s56 offen offset:1024 sc1
    v_mfma_f32_16x16x32_bf16 v[76:79], v[216:219], v[44:47], v[76:79]
    s_barrier
    v_mfma_f32_16x16x32_bf16 v[80:83], v[216:219], v[48:51], v[80:83]
    ds_write_b128 v8, v[144:147] offset:32768
    v_mfma_f32_16x16x32_bf16 v[84:87], v[216:219], v[52:55], v[84:87]
    s_waitcnt vmcnt(13)
    v_mfma_f32_16x16x32_bf16 v[88:91], v[220:223], v[40:43], v[88:91]
    buffer_load_dwordx4 v[216:219], v1, s[24:27], s56 offen offset:2048 sc1
    v_mfma_f32_16x16x32_bf16 v[92:95], v[220:223], v[44:47], v[92:95]
    ds_write_b128 v8, v[148:151] offset:33792
    v_mfma_f32_16x16x32_bf16 v[96:99], v[220:223], v[48:51], v[96:99]
    ds_write_b128 v8, v[152:155] offset:34816
    v_mfma_f32_16x16x32_bf16 v[100:103], v[220:223], v[52:55], v[100:103]
    s_waitcnt vmcnt(13) lgkmcnt(3)
    v_mfma_f32_16x16x32_bf16 v[56:59], v[224:227], v[24:27], v[56:59]
    buffer_load_dwordx4 v[220:223], v1, s[24:27], s56 offen offset:3072 sc1
    v_mfma_f32_16x16x32_bf16 v[60:63], v[224:227], v[28:31], v[60:63]
    s_add_u32 s56, s56, 57344
    ds_read_b128 v[40:43], v12 offset:0
    v_mfma_f32_16x16x32_bf16 v[64:67], v[224:227], v[32:35], v[64:67]
    ds_read_b128 v[44:47], v12 offset:512
    ds_read_b128 v[48:51], v13 offset:0
    v_mfma_f32_16x16x32_bf16 v[68:71], v[224:227], v[36:39], v[68:71]
    ds_read_b128 v[52:55], v13 offset:512
    s_waitcnt vmcnt(13)
    v_mfma_f32_16x16x32_bf16 v[72:75], v[228:231], v[24:27], v[72:75]
    buffer_load_dwordx4 v[224:227], v1, s[24:27], s56 offen offset:0 sc1
    v_mfma_f32_16x16x32_bf16 v[76:79], v[228:231], v[28:31], v[76:79]
    ds_write_b128 v8, v[156:159] offset:35840
    v_mfma_f32_16x16x32_bf16 v[80:83], v[228:231], v[32:35], v[80:83]
    s_cmp_eq_u32 s99, 3072
    s_cselect_b32 s99, 0, s99
    v_mfma_f32_16x16x32_bf16 v[84:87], v[228:231], v[36:39], v[84:87]
    s_add_u32 s100, s99, 1024
    s_waitcnt vmcnt(13)
    v_mfma_f32_16x16x32_bf16 v[88:91], v[232:235], v[24:27], v[88:91]
    buffer_load_dwordx4 v[228:231], v1, s[24:27], s56 offen offset:1024 sc1
    v_mfma_f32_16x16x32_bf16 v[92:95], v[232:235], v[28:31], v[92:95]
    s_cmp_eq_u32 s100, 3072
    s_cselect_b32 s100, 0, s100
    v_mfma_f32_16x16x32_bf16 v[96:99], v[232:235], v[32:35], v[96:99]
    s_mov_b32 s32, s12
    s_and_b32 s33, s13, 0xffff
    v_mfma_f32_16x16x32_bf16 v[100:103], v[232:235], v[36:39], v[100:103]
    s_mov_b32 s34, 0x1c0000
    s_waitcnt vmcnt(12)
    v_mfma_f32_16x16x32_bf16 v[104:107], v[236:239], v[24:27], v[104:107]
    buffer_load_dwordx4 v[232:235], v1, s[24:27], s56 offen offset:2048 sc1
    v_mfma_f32_16x16x32_bf16 v[108:111], v[236:239], v[28:31], v[108:111]
    s_add_u32 s56, s56, 57344
    s_mov_b32 s35, 0x20000
    v_mfma_f32_16x16x32_bf16 v[112:115], v[236:239], v[32:35], v[112:115]
    s_cmp_eq_u32 s56, s57
    s_cselect_b32 s56, s53, s56
    v_mfma_f32_16x16x32_bf16 v[116:119], v[236:239], v[36:39], v[116:119]
    s_add_u32 s55, s48, 36864
    s_waitcnt vmcnt(12) lgkmcnt(1)
    v_mfma_f32_16x16x32_bf16 v[56:59], v[20:23], v[40:43], v[56:59]
    buffer_load_dwordx4 v[236:239], v1, s[24:27], s56 offen offset:0 sc1
    v_mfma_f32_16x16x32_bf16 v[60:63], v[20:23], v[44:47], v[60:63]
    ds_read_b128 v[24:27], v10 offset:8192
    ds_read_b128 v[28:31], v10 offset:8704
    v_mfma_f32_16x16x32_bf16 v[64:67], v[20:23], v[48:51], v[64:67]
    ds_read_b128 v[32:35], v11 offset:8192
    ds_read_b128 v[36:39], v11 offset:8704
    v_mfma_f32_16x16x32_bf16 v[68:71], v[20:23], v[52:55], v[68:71]
    s_add_u32 s3, s48, 16384
    s_waitcnt vmcnt(11)
    v_mfma_f32_16x16x32_bf16 v[72:75], v[120:123], v[40:43], v[72:75]
    buffer_load_dwordx4 v[20:23], v1, s[24:27], s56 offen offset:1024 sc1
    v_mfma_f32_16x16x32_bf16 v[76:79], v[120:123], v[44:47], v[76:79]
    s_barrier
    v_mfma_f32_16x16x32_bf16 v[80:83], v[120:123], v[48:51], v[80:83]
    s_add_u32 m0, s52, 0
    s_add_u32 s49, s60, 1152
    v_mfma_f32_16x16x32_bf16 v[84:87], v[120:123], v[52:55], v[84:87]
    s_and_b32 s49, s49, 2047
    s_waitcnt vmcnt(10)
    v_mfma_f32_16x16x32_bf16 v[88:91], v[124:127], v[40:43], v[88:91]
    buffer_load_dwordx4 v[120:123], v1, s[24:27], s56 offen offset:2048 sc1
    v_mfma_f32_16x16x32_bf16 v[92:95], v[124:127], v[44:47], v[92:95]
    s_add_u32 s49, s49, s58
    v_add_u32 v14, s3, v1
    v_mfma_f32_16x16x32_bf16 v[96:99], v[124:127], v[48:51], v[96:99]
    buffer_load_dwordx4 v16, s[28:31], s49 offen offset:0 lds
    v_mfma_f32_16x16x32_bf16 v[100:103], v[124:127], v[52:55], v[100:103]
    s_add_u32 s49, s49, 31744
    s_waitcnt vmcnt(10) lgkmcnt(0)
    v_mfma_f32_16x16x32_bf16 v[56:59], v[208:211], v[24:27], v[56:59]
    buffer_load_dwordx4 v[124:127], v1, s[24:27], s56 offen offset:3072 sc1
    v_mfma_f32_16x16x32_bf16 v[60:63], v[208:211], v[28:31], v[60:63]
    s_add_u32 s56, s56, 57344
    ds_read_b128 v[40:43], v12 offset:8192
    v_mfma_f32_16x16x32_bf16 v[64:67], v[208:211], v[32:35], v[64:67]
    ds_read_b128 v[44:47], v12 offset:8704
    ds_read_b128 v[48:51], v13 offset:8192
    v_mfma_f32_16x16x32_bf16 v[68:71], v[208:211], v[36:39], v[68:71]
    ds_read_b128 v[52:55], v13 offset:8704
    s_waitcnt vmcnt(10)
    v_mfma_f32_16x16x32_bf16 v[72:75], v[212:215], v[24:27], v[72:75]
    buffer_load_dwordx4 v[208:211], v1, s[24:27], s56 offen offset:0 sc1
    v_mfma_f32_16x16x32_bf16 v[76:79], v[212:215], v[28:31], v[76:79]
    buffer_load_dwordx4 v17, s[28:31], s49 offen offset:1024 lds
    v_mfma_f32_16x16x32_bf16 v[80:83], v[212:215], v[32:35], v[80:83]
    s_add_u32 s49, s49, 31744
    s_sub_u32 s3, 57344, s48
    v_mfma_f32_16x16x32_bf16 v[84:87], v[212:215], v[36:39], v[84:87]
    v_add_u32 v15, s3, v1
    s_waitcnt vmcnt(11)
    v_mfma_f32_16x16x32_bf16 v[88:91], v[216:219], v[24:27], v[88:91]
    buffer_load_dwordx4 v[212:215], v1, s[24:27], s56 offen offset:1024 sc1
    v_mfma_f32_16x16x32_bf16 v[92:95], v[216:219], v[28:31], v[92:95]
    buffer_load_dwordx4 v16, s[28:31], s49 offen offset:2048 lds
    v_mfma_f32_16x16x32_bf16 v[96:99], v[216:219], v[32:35], v[96:99]
    s_add_u32 s49, s49, 31744
    s_xor_b32 s3, s40, s38
    v_mfma_f32_16x16x32_bf16 v[100:103], v[216:219], v[36:39], v[100:103]
    s_waitcnt vmcnt(12)
    v_mfma_f32_16x16x32_bf16 v[104:107], v[220:223], v[24:27], v[104:107]
    buffer_load_dwordx4 v[216:219], v1, s[24:27], s56 offen offset:2048 sc1
    v_mfma_f32_16x16x32_bf16 v[108:111], v[220:223], v[28:31], v[108:111]
    s_add_u32 s56, s56, 57344
    v_mfma_f32_16x16x32_bf16 v[112:115], v[220:223], v[32:35], v[112:115]
    buffer_load_dwordx4 v17, s[28:31], s49 offen offset:3072 lds
    v_mfma_f32_16x16x32_bf16 v[116:119], v[220:223], v[36:39], v[116:119]
    s_waitcnt vmcnt(13) lgkmcnt(0)
    v_mfma_f32_16x16x32_bf16 v[56:59], v[224:227], v[40:43], v[56:59]
    buffer_load_dwordx4 v[220:223], v1, s[24:27], s56 offen offset:0 sc1
    v_mfma_f32_16x16x32_bf16 v[60:63], v[224:227], v[44:47], v[60:63]
    ds_read_b128 v[24:27], v10 offset:16384
    ds_read_b128 v[28:31], v10 offset:16896
    v_mfma_f32_16x16x32_bf16 v[64:67], v[224:227], v[48:51], v[64:67]
    ds_read_b128 v[32:35], v11 offset:16384
    ds_read_b128 v[36:39], v11 offset:16896
    v_mfma_f32_16x16x32_bf16 v[68:71], v[224:227], v[52:55], v[68:71]
    s_waitcnt vmcnt(13)
    v_mfma_f32_16x16x32_bf16 v[72:75], v[228:231], v[40:43], v[72:75]
    buffer_load_dwordx4 v[224:227], v1, s[24:27], s56 offen offset:1024 sc1
    v_mfma_f32_16x16x32_bf16 v[76:79], v[228:231], v[44:47], v[76:79]
    s_barrier
    v_mfma_f32_16x16x32_bf16 v[80:83], v[228:231], v[48:51], v[80:83]
    ds_write_b128 v8, v[160:163] offset:8192
    v_mfma_f32_16x16x32_bf16 v[84:87], v[228:231], v[52:55], v[84:87]
    s_waitcnt vmcnt(13)
    v_mfma_f32_16x16x32_bf16 v[88:91], v[232:235], v[40:43], v[88:91]
    buffer_load_dwordx4 v[228:231], v1, s[24:27], s56 offen offset:2048 sc1
    v_mfma_f32_16x16x32_bf16 v[92:95], v[232:235], v[44:47], v[92:95]
    ds_write_b128 v8, v[164:167] offset:9216
    v_mfma_f32_16x16x32_bf16 v[96:99], v[232:235], v[48:51], v[96:99]
    ds_write_b128 v8, v[168:171] offset:10240
    v_mfma_f32_16x16x32_bf16 v[100:103], v[232:235], v[52:55], v[100:103]
    s_waitcnt vmcnt(13) lgkmcnt(3)
    s_setprio 0
    v_mfma_f32_16x16x32_bf16 v[56:59], v[236:239], v[24:27], v[56:59]
    buffer_load_dwordx4 v[232:235], v1, s[24:27], s56 offen offset:3072 sc1
    v_mfma_f32_16x16x32_bf16 v[60:63], v[236:239], v[28:31], v[60:63]
    s_add_u32 s56, s56, 57344
    ds_read_b128 v[40:43], v12 offset:16384
    v_mfma_f32_16x16x32_bf16 v[64:67], v[236:239], v[32:35], v[64:67]
    ds_read_b128 v[44:47], v12 offset:16896
    ds_read_b128 v[48:51], v13 offset:16384
    v_mfma_f32_16x16x32_bf16 v[68:71], v[236:239], v[36:39], v[68:71]
    ds_read_b128 v[52:55], v13 offset:16896
    s_waitcnt vmcnt(13)
    v_mfma_f32_16x16x32_bf16 v[72:75], v[20:23], v[24:27], v[72:75]
    buffer_load_dwordx4 v[236:239], v1, s[24:27], s56 offen offset:0 sc1
    v_mfma_f32_16x16x32_bf16 v[76:79], v[20:23], v[28:31], v[76:79]
    ds_write_b128 v8, v[172:175] offset:11264
    v_mfma_f32_16x16x32_bf16 v[80:83], v[20:23], v[32:35], v[80:83]
    s_cmp_eq_u32 s3, 0
    s_cselect_b32 s51, 2, 3
    v_mfma_f32_16x16x32_bf16 v[84:87], v[20:23], v[36:39], v[84:87]
    s_waitcnt vmcnt(13)
    v_mfma_f32_16x16x32_bf16 v[88:91], v[120:123], v[24:27], v[88:91]
    buffer_load_dwordx4 v[20:23], v1, s[24:27], s56 offen offset:1024 sc1
    v_mfma_f32_16x16x32_bf16 v[92:95], v[120:123], v[28:31], v[92:95]
    s_cmp_eq_u32 s3, 4
    s_cselect_b32 s51, 1, s51
    v_mfma_f32_16x16x32_bf16 v[96:99], v[120:123], v[32:35], v[96:99]
    s_mul_i32 s21, s44, 57344
    s_add_u32 s21, s21, 0xd00000
    v_mfma_f32_16x16x32_bf16 v[100:103], v[120:123], v[36:39], v[100:103]
    s_and_b32 s3, s40, 3
    s_waitcnt vmcnt(12)
    v_mfma_f32_16x16x32_bf16 v[104:107], v[124:127], v[24:27], v[104:107]
    buffer_load_dwordx4 v[120:123], v1, s[24:27], s56 offen offset:2048 sc1
    v_mfma_f32_16x16x32_bf16 v[108:111], v[124:127], v[28:31], v[108:111]
    s_add_u32 s56, s56, 57344
    s_mul_i32 s22, s3, 7168
    v_mfma_f32_16x16x32_bf16 v[112:115], v[124:127], v[32:35], v[112:115]
    s_cmp_eq_u32 s56, s57
    s_cselect_b32 s56, s53, s56
    v_mfma_f32_16x16x32_bf16 v[116:119], v[124:127], v[36:39], v[116:119]
    s_add_u32 s21, s21, s22
    s_waitcnt vmcnt(12) lgkmcnt(1)
    v_mfma_f32_16x16x32_bf16 v[56:59], v[208:211], v[40:43], v[56:59]
    buffer_load_dwordx4 v[124:127], v1, s[24:27], s56 offen offset:0 sc1
    v_mfma_f32_16x16x32_bf16 v[60:63], v[208:211], v[44:47], v[60:63]
    ds_read_b128 v[24:27], v10 offset:24576
    ds_read_b128 v[28:31], v10 offset:25088
    v_mfma_f32_16x16x32_bf16 v[64:67], v[208:211], v[48:51], v[64:67]
    ds_read_b128 v[32:35], v11 offset:24576
    ds_read_b128 v[36:39], v11 offset:25088
    v_mfma_f32_16x16x32_bf16 v[68:71], v[208:211], v[52:55], v[68:71]
    s_lshr_b32 s3, s40, 2
    s_waitcnt vmcnt(11)
    v_mfma_f32_16x16x32_bf16 v[72:75], v[212:215], v[40:43], v[72:75]
    buffer_load_dwordx4 v[208:211], v1, s[24:27], s56 offen offset:1024 sc1
    v_mfma_f32_16x16x32_bf16 v[76:79], v[212:215], v[44:47], v[76:79]
    s_barrier
    v_mfma_f32_16x16x32_bf16 v[80:83], v[212:215], v[48:51], v[80:83]
    s_add_u32 m0, s52, 16384
    s_add_u32 s49, s60, 1408
    v_mfma_f32_16x16x32_bf16 v[84:87], v[212:215], v[52:55], v[84:87]
    s_and_b32 s49, s49, 2047
    s_waitcnt vmcnt(10)
    v_mfma_f32_16x16x32_bf16 v[88:91], v[216:219], v[40:43], v[88:91]
    buffer_load_dwordx4 v[212:215], v1, s[24:27], s56 offen offset:2048 sc1
    v_mfma_f32_16x16x32_bf16 v[92:95], v[216:219], v[44:47], v[92:95]
    s_add_u32 s49, s49, s58
    s_mul_i32 s3, s3, 3072
    v_mfma_f32_16x16x32_bf16 v[96:99], v[216:219], v[48:51], v[96:99]
    buffer_load_dwordx4 v16, s[28:31], s49 offen offset:0 lds
    v_mfma_f32_16x16x32_bf16 v[100:103], v[216:219], v[52:55], v[100:103]
    s_add_u32 s49, s49, 31744
    s_waitcnt vmcnt(10) lgkmcnt(0)
    v_mfma_f32_16x16x32_bf16 v[56:59], v[220:223], v[24:27], v[56:59]
    buffer_load_dwordx4 v[216:219], v1, s[24:27], s56 offen offset:3072 sc1
    v_mfma_f32_16x16x32_bf16 v[60:63], v[220:223], v[28:31], v[60:63]
    s_add_u32 s56, s56, 57344
    ds_read_b128 v[40:43], v12 offset:24576
    v_mfma_f32_16x16x32_bf16 v[64:67], v[220:223], v[32:35], v[64:67]
    ds_read_b128 v[44:47], v12 offset:25088
    ds_read_b128 v[48:51], v13 offset:24576
    v_mfma_f32_16x16x32_bf16 v[68:71], v[220:223], v[36:39], v[68:71]
    ds_read_b128 v[52:55], v13 offset:25088
    s_waitcnt vmcnt(10)
    v_mfma_f32_16x16x32_bf16 v[72:75], v[224:227], v[24:27], v[72:75]
    buffer_load_dwordx4 v[220:223], v1, s[24:27], s56 offen offset:0 sc1
    v_mfma_f32_16x16x32_bf16 v[76:79], v[224:227], v[28:31], v[76:79]
    buffer_load_dwordx4 v17, s[28:31], s49 offen offset:1024 lds
    v_mfma_f32_16x16x32_bf16 v[80:83], v[224:227], v[32:35], v[80:83]
    s_add_u32 s49, s49, 31744
    s_add_u32 s21, s21, s3
    v_mfma_f32_16x16x32_bf16 v[84:87], v[224:227], v[36:39], v[84:87]
    s_add_u32 s22, s21, 28672
    s_waitcnt vmcnt(11)
    v_mfma_f32_16x16x32_bf16 v[88:91], v[228:231], v[24:27], v[88:91]
    buffer_load_dwordx4 v[224:227], v1, s[24:27], s56 offen offset:1024 sc1
    v_mfma_f32_16x16x32_bf16 v[92:95], v[228:231], v[28:31], v[92:95]
    buffer_load_dwordx4 v16, s[28:31], s49 offen offset:2048 lds
    v_mfma_f32_16x16x32_bf16 v[96:99], v[228:231], v[32:35], v[96:99]
    s_add_u32 s49, s49, 31744
    v_mfma_f32_16x16x32_bf16 v[100:103], v[228:231], v[36:39], v[100:103]
    s_waitcnt vmcnt(12)
    v_mfma_f32_16x16x32_bf16 v[104:107], v[232:235], v[24:27], v[104:107]
    buffer_load_dwordx4 v[228:231], v1, s[24:27], s56 offen offset:2048 sc1
    v_mfma_f32_16x16x32_bf16 v[108:111], v[232:235], v[28:31], v[108:111]
    s_add_u32 s56, s56, 57344
    v_mfma_f32_16x16x32_bf16 v[112:115], v[232:235], v[32:35], v[112:115]
    buffer_load_dwordx4 v17, s[28:31], s49 offen offset:3072 lds
    v_mfma_f32_16x16x32_bf16 v[116:119], v[232:235], v[36:39], v[116:119]
    s_waitcnt vmcnt(13) lgkmcnt(0)
    v_mfma_f32_16x16x32_bf16 v[56:59], v[236:239], v[40:43], v[56:59]
    buffer_load_dwordx4 v[232:235], v1, s[24:27], s56 offen offset:0 sc1
    v_mfma_f32_16x16x32_bf16 v[60:63], v[236:239], v[44:47], v[60:63]
    ds_read_b128 v[24:27], v10 offset:32768
    ds_read_b128 v[28:31], v10 offset:33280
    v_mfma_f32_16x16x32_bf16 v[64:67], v[236:239], v[48:51], v[64:67]
    ds_read_b128 v[32:35], v11 offset:32768
    ds_read_b128 v[36:39], v11 offset:33280
    v_mfma_f32_16x16x32_bf16 v[68:71], v[236:239], v[52:55], v[68:71]
    s_waitcnt vmcnt(13)
    v_mfma_f32_16x16x32_bf16 v[72:75], v[20:23], v[40:43], v[72:75]
    buffer_load_dwordx4 v[236:239], v1, s[24:27], s56 offen offset:1024 sc1
    v_mfma_f32_16x16x32_bf16 v[76:79], v[20:23], v[44:47], v[76:79]
    s_barrier
    v_mfma_f32_16x16x32_bf16 v[80:83], v[20:23], v[48:51], v[80:83]
    ds_write_b128 v8, v[176:179] offset:24576
    v_mfma_f32_16x16x32_bf16 v[84:87], v[20:23], v[52:55], v[84:87]
    s_waitcnt vmcnt(13)
    v_mfma_f32_16x16x32_bf16 v[88:91], v[120:123], v[40:43], v[88:91]
    buffer_load_dwordx4 v[20:23], v1, s[24:27], s56 offen offset:2048 sc1
    v_mfma_f32_16x16x32_bf16 v[92:95], v[120:123], v[44:47], v[92:95]
    ds_write_b128 v8, v[180:183] offset:25600
    v_mfma_f32_16x16x32_bf16 v[96:99], v[120:123], v[48:51], v[96:99]
    ds_write_b128 v8, v[184:187] offset:26624
    v_mfma_f32_16x16x32_bf16 v[100:103], v[120:123], v[52:55], v[100:103]
    s_waitcnt vmcnt(13) lgkmcnt(3)
    v_mfma_f32_16x16x32_bf16 v[56:59], v[124:127], v[24:27], v[56:59]
    buffer_load_dwordx4 v[120:123], v1, s[24:27], s56 offen offset:3072 sc1
    v_mfma_f32_16x16x32_bf16 v[60:63], v[124:127], v[28:31], v[60:63]
    s_add_u32 s56, s56, 57344
    ds_read_b128 v[40:43], v12 offset:32768
    v_mfma_f32_16x16x32_bf16 v[64:67], v[124:127], v[32:35], v[64:67]
    ds_read_b128 v[44:47], v12 offset:33280
    ds_read_b128 v[48:51], v13 offset:32768
    v_mfma_f32_16x16x32_bf16 v[68:71], v[124:127], v[36:39], v[68:71]
    ds_read_b128 v[52:55], v13 offset:33280
    s_waitcnt vmcnt(13)
    v_mfma_f32_16x16x32_bf16 v[72:75], v[208:211], v[24:27], v[72:75]
    buffer_load_dwordx4 v[124:127], v1, s[24:27], s56 offen offset:0 sc1
    v_mfma_f32_16x16x32_bf16 v[76:79], v[208:211], v[28:31], v[76:79]
    ds_write_b128 v8, v[188:191] offset:27648
    v_mfma_f32_16x16x32_bf16 v[80:83], v[208:211], v[32:35], v[80:83]
    v_mfma_f32_16x16x32_bf16 v[84:87], v[208:211], v[36:39], v[84:87]
    s_waitcnt vmcnt(13)
    v_mfma_f32_16x16x32_bf16 v[88:91], v[212:215], v[24:27], v[88:91]
    buffer_load_dwordx4 v[208:211], v1, s[24:27], s56 offen offset:1024 sc1
    v_mfma_f32_16x16x32_bf16 v[92:95], v[212:215], v[28:31], v[92:95]
    v_mfma_f32_16x16x32_bf16 v[96:99], v[212:215], v[32:35], v[96:99]
    v_mfma_f32_16x16x32_bf16 v[100:103], v[212:215], v[36:39], v[100:103]
    s_waitcnt vmcnt(12)
    v_mfma_f32_16x16x32_bf16 v[104:107], v[216:219], v[24:27], v[104:107]
    buffer_load_dwordx4 v[212:215], v1, s[24:27], s56 offen offset:2048 sc1
    v_mfma_f32_16x16x32_bf16 v[108:111], v[216:219], v[28:31], v[108:111]
    s_add_u32 s56, s56, 57344
    v_mfma_f32_16x16x32_bf16 v[112:115], v[216:219], v[32:35], v[112:115]
    s_cmp_eq_u32 s56, s57
    s_cselect_b32 s56, s53, s56
    v_mfma_f32_16x16x32_bf16 v[116:119], v[216:219], v[36:39], v[116:119]
    s_waitcnt vmcnt(12) lgkmcnt(1)
    v_mfma_f32_16x16x32_bf16 v[56:59], v[220:223], v[40:43], v[56:59]
    buffer_load_dwordx4 v[216:219], v1, s[24:27], s56 offen offset:0 sc1
    v_mfma_f32_16x16x32_bf16 v[60:63], v[220:223], v[44:47], v[60:63]
    ds_read_b128 v[24:27], v10 offset:0
    ds_read_b128 v[28:31], v10 offset:512
    v_mfma_f32_16x16x32_bf16 v[64:67], v[220:223], v[48:51], v[64:67]
    ds_read_b128 v[32:35], v11 offset:0
    ds_read_b128 v[36:39], v11 offset:512
    v_mfma_f32_16x16x32_bf16 v[68:71], v[220:223], v[52:55], v[68:71]
    s_waitcnt vmcnt(11)
    v_mfma_f32_16x16x32_bf16 v[72:75], v[224:227], v[40:43], v[72:75]
    buffer_load_dwordx4 v[220:223], v1, s[24:27], s56 offen offset:1024 sc1
    v_mfma_f32_16x16x32_bf16 v[76:79], v[224:227], v[44:47], v[76:79]
    s_barrier
    v_mfma_f32_16x16x32_bf16 v[80:83], v[224:227], v[48:51], v[80:83]
    s_add_u32 m0, s52, 32768
    s_add_u32 s49, s60, 1664
    v_mfma_f32_16x16x32_bf16 v[84:87], v[224:227], v[52:55], v[84:87]
    s_and_b32 s49, s49, 2047
    s_waitcnt vmcnt(10)
    v_mfma_f32_16x16x32_bf16 v[88:91], v[228:231], v[40:43], v[88:91]
    buffer_load_dwordx4 v[224:227], v1, s[24:27], s56 offen offset:2048 sc1
    v_mfma_f32_16x16x32_bf16 v[92:95], v[228:231], v[44:47], v[92:95]
    s_add_u32 s49, s49, s58
    v_mfma_f32_16x16x32_bf16 v[96:99], v[228:231], v[48:51], v[96:99]
    buffer_load_dwordx4 v16, s[28:31], s49 offen offset:0 lds
    v_mfma_f32_16x16x32_bf16 v[100:103], v[228:231], v[52:55], v[100:103]
    s_add_u32 s49, s49, 31744
    s_waitcnt vmcnt(10) lgkmcnt(0)
    v_mfma_f32_16x16x32_bf16 v[56:59], v[232:235], v[24:27], v[56:59]
    buffer_load_dwordx4 v[228:231], v1, s[24:27], s56 offen offset:3072 sc1
    v_mfma_f32_16x16x32_bf16 v[60:63], v[232:235], v[28:31], v[60:63]
    s_add_u32 s56, s56, 57344
    ds_read_b128 v[40:43], v12 offset:0
    v_mfma_f32_16x16x32_bf16 v[64:67], v[232:235], v[32:35], v[64:67]
    ds_read_b128 v[44:47], v12 offset:512
    ds_read_b128 v[48:51], v13 offset:0
    v_mfma_f32_16x16x32_bf16 v[68:71], v[232:235], v[36:39], v[68:71]
    ds_read_b128 v[52:55], v13 offset:512
    s_waitcnt vmcnt(10)
    v_mfma_f32_16x16x32_bf16 v[72:75], v[236:239], v[24:27], v[72:75]
    buffer_load_dwordx4 v[232:235], v1, s[24:27], s56 offen offset:0 sc1
    v_mfma_f32_16x16x32_bf16 v[76:79], v[236:239], v[28:31], v[76:79]
    buffer_load_dwordx4 v17, s[28:31], s49 offen offset:1024 lds
    v_mfma_f32_16x16x32_bf16 v[80:83], v[236:239], v[32:35], v[80:83]
    s_add_u32 s49, s49, 31744
    v_mfma_f32_16x16x32_bf16 v[84:87], v[236:239], v[36:39], v[84:87]
    s_waitcnt vmcnt(11)
    v_mfma_f32_16x16x32_bf16 v[88:91], v[20:23], v[24:27], v[88:91]
    buffer_load_dwordx4 v[236:239], v1, s[24:27], s56 offen offset:1024 sc1
    v_mfma_f32_16x16x32_bf16 v[92:95], v[20:23], v[28:31], v[92:95]
    buffer_load_dwordx4 v16, s[28:31], s49 offen offset:2048 lds
    v_mfma_f32_16x16x32_bf16 v[96:99], v[20:23], v[32:35], v[96:99]
    s_add_u32 s49, s49, 31744
    v_mfma_f32_16x16x32_bf16 v[100:103], v[20:23], v[36:39], v[100:103]
    s_waitcnt vmcnt(12)
    v_mfma_f32_16x16x32_bf16 v[104:107], v[120:123], v[24:27], v[104:107]
    buffer_load_dwordx4 v[20:23], v1, s[24:27], s56 offen offset:2048 sc1
    v_mfma_f32_16x16x32_bf16 v[108:111], v[120:123], v[28:31], v[108:111]
    s_add_u32 s56, s56, 57344
    v_mfma_f32_16x16x32_bf16 v[112:115], v[120:123], v[32:35], v[112:115]
    buffer_load_dwordx4 v17, s[28:31], s49 offen offset:3072 lds
    v_mfma_f32_16x16x32_bf16 v[116:119], v[120:123], v[36:39], v[116:119]
    s_waitcnt vmcnt(13) lgkmcnt(0)
    v_mfma_f32_16x16x32_bf16 v[56:59], v[124:127], v[40:43], v[56:59]
    buffer_load_dwordx4 v[120:123], v1, s[24:27], s56 offen offset:0 sc1
    v_mfma_f32_16x16x32_bf16 v[60:63], v[124:127], v[44:47], v[60:63]
    ds_read_b128 v[24:27], v10 offset:8192
    ds_read_b128 v[28:31], v10 offset:8704
    v_mfma_f32_16x16x32_bf16 v[64:67], v[124:127], v[48:51], v[64:67]
    ds_read_b128 v[32:35], v11 offset:8192
    ds_read_b128 v[36:39], v11 offset:8704
    v_mfma_f32_16x16x32_bf16 v[68:71], v[124:127], v[52:55], v[68:71]
    s_waitcnt vmcnt(13)
    v_mfma_f32_16x16x32_bf16 v[72:75], v[208:211], v[40:43], v[72:75]
    buffer_load_dwordx4 v[124:127], v1, s[24:27], s56 offen offset:1024 sc1
    v_mfma_f32_16x16x32_bf16 v[76:79], v[208:211], v[44:47], v[76:79]
    s_barrier
    v_mfma_f32_16x16x32_bf16 v[80:83], v[208:211], v[48:51], v[80:83]
    ds_write_b128 v8, v[192:195] offset:0
    v_mfma_f32_16x16x32_bf16 v[84:87], v[208:211], v[52:55], v[84:87]
    s_waitcnt vmcnt(13)
    v_mfma_f32_16x16x32_bf16 v[88:91], v[212:215], v[40:43], v[88:91]
    buffer_load_dwordx4 v[208:211], v1, s[24:27], s56 offen offset:2048 sc1
    v_mfma_f32_16x16x32_bf16 v[92:95], v[212:215], v[44:47], v[92:95]
    ds_write_b128 v8, v[196:199] offset:1024
    v_mfma_f32_16x16x32_bf16 v[96:99], v[212:215], v[48:51], v[96:99]
    ds_write_b128 v8, v[200:203] offset:2048
    v_mfma_f32_16x16x32_bf16 v[100:103], v[212:215], v[52:55], v[100:103]
    s_waitcnt vmcnt(13) lgkmcnt(3)
    v_mfma_f32_16x16x32_bf16 v[56:59], v[216:219], v[24:27], v[56:59]
    buffer_load_dwordx4 v[212:215], v1, s[24:27], s56 offen offset:3072 sc1
    v_mfma_f32_16x16x32_bf16 v[60:63], v[216:219], v[28:31], v[60:63]
    s_add_u32 s56, s56, 57344
    ds_read_b128 v[40:43], v12 offset:8192
    v_mfma_f32_16x16x32_bf16 v[64:67], v[216:219], v[32:35], v[64:67]
    ds_read_b128 v[44:47], v12 offset:8704
    ds_read_b128 v[48:51], v13 offset:8192
    v_mfma_f32_16x16x32_bf16 v[68:71], v[216:219], v[36:39], v[68:71]
    ds_read_b128 v[52:55], v13 offset:8704
    s_waitcnt vmcnt(13)
    v_mfma_f32_16x16x32_bf16 v[72:75], v[220:223], v[24:27], v[72:75]
    buffer_load_dwordx4 v[216:219], v1, s[24:27], s56 offen offset:0 sc1
    v_mfma_f32_16x16x32_bf16 v[76:79], v[220:223], v[28:31], v[76:79]
    ds_write_b128 v8, v[204:207] offset:3072
    v_mfma_f32_16x16x32_bf16 v[80:83], v[220:223], v[32:35], v[80:83]
    v_mfma_f32_16x16x32_bf16 v[84:87], v[220:223], v[36:39], v[84:87]
    s_waitcnt vmcnt(13)
    v_mfma_f32_16x16x32_bf16 v[88:91], v[224:227], v[24:27], v[88:91]
    buffer_load_dwordx4 v[220:223], v1, s[24:27], s56 offen offset:1024 sc1
    v_mfma_f32_16x16x32_bf16 v[92:95], v[224:227], v[28:31], v[92:95]
    v_mfma_f32_16x16x32_bf16 v[96:99], v[224:227], v[32:35], v[96:99]
    v_mfma_f32_16x16x32_bf16 v[100:103], v[224:227], v[36:39], v[100:103]
    s_waitcnt vmcnt(12)
    v_mfma_f32_16x16x32_bf16 v[104:107], v[228:231], v[24:27], v[104:107]
    buffer_load_dwordx4 v[224:227], v1, s[24:27], s56 offen offset:2048 sc1
    v_mfma_f32_16x16x32_bf16 v[108:111], v[228:231], v[28:31], v[108:111]
    s_add_u32 s56, s56, 57344
    v_mfma_f32_16x16x32_bf16 v[112:115], v[228:231], v[32:35], v[112:115]
    s_cmp_eq_u32 s56, s57
    s_cselect_b32 s56, s53, s56
    v_mfma_f32_16x16x32_bf16 v[116:119], v[228:231], v[36:39], v[116:119]
    s_waitcnt vmcnt(12) lgkmcnt(1)
    v_mfma_f32_16x16x32_bf16 v[56:59], v[232:235], v[40:43], v[56:59]
    buffer_load_dwordx4 v[228:231], v1, s[24:27], s56 offen offset:0 sc1
    v_mfma_f32_16x16x32_bf16 v[60:63], v[232:235], v[44:47], v[60:63]
    ds_read_b128 v[24:27], v10 offset:16384
    ds_read_b128 v[28:31], v10 offset:16896
    v_mfma_f32_16x16x32_bf16 v[64:67], v[232:235], v[48:51], v[64:67]
    ds_read_b128 v[32:35], v11 offset:16384
    ds_read_b128 v[36:39], v11 offset:16896
    v_mfma_f32_16x16x32_bf16 v[68:71], v[232:235], v[52:55], v[68:71]
    s_waitcnt vmcnt(11)
    v_mfma_f32_16x16x32_bf16 v[72:75], v[236:239], v[40:43], v[72:75]
    buffer_load_dwordx4 v[232:235], v1, s[24:27], s56 offen offset:1024 sc1
    v_mfma_f32_16x16x32_bf16 v[76:79], v[236:239], v[44:47], v[76:79]
    s_barrier
    v_mfma_f32_16x16x32_bf16 v[80:83], v[236:239], v[48:51], v[80:83]
    s_add_u32 m0, s52, 8192
    s_add_u32 s49, s60, 1920
    v_mfma_f32_16x16x32_bf16 v[84:87], v[236:239], v[52:55], v[84:87]
    s_and_b32 s49, s49, 2047
    s_waitcnt vmcnt(10)
    v_mfma_f32_16x16x32_bf16 v[88:91], v[20:23], v[40:43], v[88:91]
    buffer_load_dwordx4 v[236:239], v1, s[24:27], s56 offen offset:2048 sc1
    v_mfma_f32_16x16x32_bf16 v[92:95], v[20:23], v[44:47], v[92:95]
    s_add_u32 s49, s49, s58
    v_mfma_f32_16x16x32_bf16 v[96:99], v[20:23], v[48:51], v[96:99]
    buffer_load_dwordx4 v16, s[28:31], s49 offen offset:0 lds
    v_mfma_f32_16x16x32_bf16 v[100:103], v[20:23], v[52:55], v[100:103]
    s_add_u32 s49, s49, 31744
    s_waitcnt vmcnt(10) lgkmcnt(0)
    v_mfma_f32_16x16x32_bf16 v[56:59], v[120:123], v[24:27], v[56:59]
    buffer_load_dwordx4 v[20:23], v1, s[24:27], s56 offen offset:3072 sc1
    v_mfma_f32_16x16x32_bf16 v[60:63], v[120:123], v[28:31], v[60:63]
    s_add_u32 s56, s56, 57344
    ds_read_b128 v[40:43], v12 offset:16384
    v_mfma_f32_16x16x32_bf16 v[64:67], v[120:123], v[32:35], v[64:67]
    ds_read_b128 v[44:47], v12 offset:16896
    ds_read_b128 v[48:51], v13 offset:16384
    v_mfma_f32_16x16x32_bf16 v[68:71], v[120:123], v[36:39], v[68:71]
    ds_read_b128 v[52:55], v13 offset:16896
    s_waitcnt vmcnt(10)
    v_mfma_f32_16x16x32_bf16 v[72:75], v[124:127], v[24:27], v[72:75]
    buffer_load_dwordx4 v[120:123], v1, s[24:27], s56 offen offset:0 sc1
    v_mfma_f32_16x16x32_bf16 v[76:79], v[124:127], v[28:31], v[76:79]
    buffer_load_dwordx4 v17, s[28:31], s49 offen offset:1024 lds
    v_mfma_f32_16x16x32_bf16 v[80:83], v[124:127], v[32:35], v[80:83]
    s_add_u32 s49, s49, 31744
    v_mfma_f32_16x16x32_bf16 v[84:87], v[124:127], v[36:39], v[84:87]
    s_waitcnt vmcnt(11)
    v_mfma_f32_16x16x32_bf16 v[88:91], v[208:211], v[24:27], v[88:91]
    buffer_load_dwordx4 v[124:127], v1, s[24:27], s56 offen offset:1024 sc1
    v_mfma_f32_16x16x32_bf16 v[92:95], v[208:211], v[28:31], v[92:95]
    buffer_load_dwordx4 v16, s[28:31], s49 offen offset:2048 lds
    v_mfma_f32_16x16x32_bf16 v[96:99], v[208:211], v[32:35], v[96:99]
    s_add_u32 s49, s49, 31744
    v_mfma_f32_16x16x32_bf16 v[100:103], v[208:211], v[36:39], v[100:103]
    s_waitcnt vmcnt(12)
    v_mfma_f32_16x16x32_bf16 v[104:107], v[212:215], v[24:27], v[104:107]
    buffer_load_dwordx4 v[208:211], v1, s[24:27], s56 offen offset:2048 sc1
    v_mfma_f32_16x16x32_bf16 v[108:111], v[212:215], v[28:31], v[108:111]
    s_add_u32 s56, s56, 57344
    v_mfma_f32_16x16x32_bf16 v[112:115], v[212:215], v[32:35], v[112:115]
    buffer_load_dwordx4 v17, s[28:31], s49 offen offset:3072 lds
    v_mfma_f32_16x16x32_bf16 v[116:119], v[212:215], v[36:39], v[116:119]
    s_lshl_b32 s60, s43, 12
    s_waitcnt vmcnt(13) lgkmcnt(0)
    v_mfma_f32_16x16x32_bf16 v[56:59], v[216:219], v[40:43], v[56:59]
    buffer_load_dwordx4 v[212:215], v1, s[24:27], s56 offen offset:0 sc1
    v_mfma_f32_16x16x32_bf16 v[60:63], v[216:219], v[44:47], v[60:63]
    ds_read_b128 v[24:27], v10 offset:24576
    ds_read_b128 v[28:31], v10 offset:25088
    v_mfma_f32_16x16x32_bf16 v[64:67], v[216:219], v[48:51], v[64:67]
    ds_read_b128 v[32:35], v11 offset:24576
    ds_read_b128 v[36:39], v11 offset:25088
    v_mfma_f32_16x16x32_bf16 v[68:71], v[216:219], v[52:55], v[68:71]
    s_add_u32 s60, s60, 0xb8000
    s_waitcnt vmcnt(13)
    v_mfma_f32_16x16x32_bf16 v[72:75], v[220:223], v[40:43], v[72:75]
    buffer_load_dwordx4 v[216:219], v1, s[24:27], s56 offen offset:1024 sc1
    v_mfma_f32_16x16x32_bf16 v[76:79], v[220:223], v[44:47], v[76:79]
    s_barrier
    v_mfma_f32_16x16x32_bf16 v[80:83], v[220:223], v[48:51], v[80:83]
    s_lshl_b32 s49, s39, 10
    s_add_u32 s49, s49, 0xb0000
    v_mfma_f32_16x16x32_bf16 v[84:87], v[220:223], v[52:55], v[84:87]
    s_lshl_b32 s54, s40, 7
    s_waitcnt vmcnt(13)
    v_mfma_f32_16x16x32_bf16 v[88:91], v[224:227], v[40:43], v[88:91]
    buffer_load_dwordx4 v[220:223], v1, s[24:27], s56 offen offset:2048 sc1
    v_mfma_f32_16x16x32_bf16 v[92:95], v[224:227], v[44:47], v[92:95]
    s_add_u32 s54, s54, s49
    v_and_b32 v16, 1, v0
    v_mfma_f32_16x16x32_bf16 v[96:99], v[224:227], v[48:51], v[96:99]
    v_lshl_add_u32 v16, v16, 2, s38
    v_lshlrev_b32 v16, 7, v16
    v_mfma_f32_16x16x32_bf16 v[100:103], v[224:227], v[52:55], v[100:103]
    v_lshrrev_b32 v17, 5, v1
    s_waitcnt vmcnt(13) lgkmcnt(0)
    v_mfma_f32_16x16x32_bf16 v[56:59], v[228:231], v[24:27], v[56:59]
    buffer_load_dwordx4 v[224:227], v1, s[24:27], s56 offen offset:3072 sc1
    v_mfma_f32_16x16x32_bf16 v[60:63], v[228:231], v[28:31], v[60:63]
    s_add_u32 s56, s56, 57344
    ds_read_b128 v[40:43], v12 offset:24576
    v_mfma_f32_16x16x32_bf16 v[64:67], v[228:231], v[32:35], v[64:67]
    ds_read_b128 v[44:47], v12 offset:25088
    ds_read_b128 v[48:51], v13 offset:24576
    v_mfma_f32_16x16x32_bf16 v[68:71], v[228:231], v[36:39], v[68:71]
    ds_read_b128 v[52:55], v13 offset:25088
    s_waitcnt vmcnt(13)
    v_mfma_f32_16x16x32_bf16 v[72:75], v[232:235], v[24:27], v[72:75]
    buffer_load_dwordx4 v[228:231], v1, s[24:27], s56 offen offset:0 sc1
    v_mfma_f32_16x16x32_bf16 v[76:79], v[232:235], v[28:31], v[76:79]
    v_mul_u32_u24 v17, 4096, v17
    v_and_or_b32 v17, v1, 16, v17
    v_mfma_f32_16x16x32_bf16 v[80:83], v[232:235], v[32:35], v[80:83]
    s_lshl_b32 s52, s39, 2
    s_add_u32 s52, s52, s38
    v_mfma_f32_16x16x32_bf16 v[84:87], v[232:235], v[36:39], v[84:87]
    s_lshl_b32 s52, s52, 5
    s_waitcnt vmcnt(13)
    v_mfma_f32_16x16x32_bf16 v[88:91], v[236:239], v[24:27], v[88:91]
    buffer_load_dwordx4 v[232:235], v1, s[24:27], s56 offen offset:1024 sc1
    v_mfma_f32_16x16x32_bf16 v[92:95], v[236:239], v[28:31], v[92:95]
    s_mul_i32 s3, s43, 262144
    s_add_u32 s52, s52, s3
    v_mfma_f32_16x16x32_bf16 v[96:99], v[236:239], v[32:35], v[96:99]
    s_add_u32 s52, s52, 0xb00000
    s_mov_b32 m0, s55
    v_mfma_f32_16x16x32_bf16 v[100:103], v[236:239], v[36:39], v[100:103]
    s_waitcnt vmcnt(12)
    v_mfma_f32_16x16x32_bf16 v[104:107], v[20:23], v[24:27], v[104:107]
    buffer_load_dwordx4 v[236:239], v1, s[24:27], s56 offen offset:2048 sc1
    v_mfma_f32_16x16x32_bf16 v[108:111], v[20:23], v[28:31], v[108:111]
    s_add_u32 s56, s56, 57344
    v_mfma_f32_16x16x32_bf16 v[112:115], v[20:23], v[32:35], v[112:115]
    s_cmp_eq_u32 s56, s57
    s_cselect_b32 s56, s53, s56
    v_mfma_f32_16x16x32_bf16 v[116:119], v[20:23], v[36:39], v[116:119]
    s_waitcnt vmcnt(12) lgkmcnt(0)
    v_mfma_f32_16x16x32_bf16 v[56:59], v[120:123], v[40:43], v[56:59]
    buffer_load_dwordx4 v[20:23], v1, s[24:27], s56 offen offset:0 sc1
    v_mfma_f32_16x16x32_bf16 v[60:63], v[120:123], v[44:47], v[60:63]
    ds_read_b128 v[24:27], v10 offset:32768
    ds_read_b128 v[28:31], v10 offset:33280
    v_mfma_f32_16x16x32_bf16 v[64:67], v[120:123], v[48:51], v[64:67]
    ds_read_b128 v[32:35], v11 offset:32768
    ds_read_b128 v[36:39], v11 offset:33280
    v_mfma_f32_16x16x32_bf16 v[68:71], v[120:123], v[52:55], v[68:71]
    s_waitcnt vmcnt(11)
    v_mfma_f32_16x16x32_bf16 v[72:75], v[124:127], v[40:43], v[72:75]
    buffer_load_dwordx4 v[120:123], v1, s[24:27], s56 offen offset:1024 sc1
    v_mfma_f32_16x16x32_bf16 v[76:79], v[124:127], v[44:47], v[76:79]
    s_barrier
    v_mfma_f32_16x16x32_bf16 v[80:83], v[124:127], v[48:51], v[80:83]
    v_mfma_f32_16x16x32_bf16 v[84:87], v[124:127], v[52:55], v[84:87]
    s_waitcnt vmcnt(10)
    v_mfma_f32_16x16x32_bf16 v[88:91], v[208:211], v[40:43], v[88:91]
    buffer_load_dwordx4 v[124:127], v1, s[24:27], s56 offen offset:2048 sc1
    v_mfma_f32_16x16x32_bf16 v[92:95], v[208:211], v[44:47], v[92:95]
    v_mfma_f32_16x16x32_bf16 v[96:99], v[208:211], v[48:51], v[96:99]
    v_mfma_f32_16x16x32_bf16 v[100:103], v[208:211], v[52:55], v[100:103]
    s_waitcnt vmcnt(9) lgkmcnt(0)
    v_mfma_f32_16x16x32_bf16 v[56:59], v[212:215], v[24:27], v[56:59]
    buffer_load_dwordx4 v[208:211], v1, s[24:27], s56 offen offset:3072 sc1
    v_mfma_f32_16x16x32_bf16 v[60:63], v[212:215], v[28:31], v[60:63]
    s_add_u32 s56, s56, 57344
    ds_read_b128 v[40:43], v12 offset:32768
    v_mfma_f32_16x16x32_bf16 v[64:67], v[212:215], v[32:35], v[64:67]
    ds_read_b128 v[44:47], v12 offset:33280
    ds_read_b128 v[48:51], v13 offset:32768
    v_mfma_f32_16x16x32_bf16 v[68:71], v[212:215], v[36:39], v[68:71]
    ds_read_b128 v[52:55], v13 offset:33280
    s_waitcnt vmcnt(9)
    v_mfma_f32_16x16x32_bf16 v[72:75], v[216:219], v[24:27], v[72:75]
    buffer_load_dwordx4 v[212:215], v1, s[24:27], s56 offen offset:0 sc1
    v_mfma_f32_16x16x32_bf16 v[76:79], v[216:219], v[28:31], v[76:79]
    v_mfma_f32_16x16x32_bf16 v[80:83], v[216:219], v[32:35], v[80:83]
    v_mfma_f32_16x16x32_bf16 v[84:87], v[216:219], v[36:39], v[84:87]
    s_waitcnt vmcnt(9)
    v_mfma_f32_16x16x32_bf16 v[88:91], v[220:223], v[24:27], v[88:91]
    buffer_load_dwordx4 v[216:219], v1, s[24:27], s56 offen offset:1024 sc1
    v_mfma_f32_16x16x32_bf16 v[92:95], v[220:223], v[28:31], v[92:95]
    v_mfma_f32_16x16x32_bf16 v[96:99], v[220:223], v[32:35], v[96:99]
    v_mfma_f32_16x16x32_bf16 v[100:103], v[220:223], v[36:39], v[100:103]
    s_waitcnt vmcnt(9)
    v_mfma_f32_16x16x32_bf16 v[104:107], v[224:227], v[24:27], v[104:107]
    buffer_load_dwordx4 v[220:223], v1, s[24:27], s56 offen offset:2048 sc1
    v_mfma_f32_16x16x32_bf16 v[108:111], v[224:227], v[28:31], v[108:111]
    s_add_u32 s56, s56, 57344
    v_mfma_f32_16x16x32_bf16 v[112:115], v[224:227], v[32:35], v[112:115]
    v_mfma_f32_16x16x32_bf16 v[116:119], v[224:227], v[36:39], v[116:119]
    s_waitcnt vmcnt(9) lgkmcnt(0)
    v_mfma_f32_16x16x32_bf16 v[56:59], v[228:231], v[40:43], v[56:59]
    buffer_load_dwordx4 v[224:227], v1, s[24:27], s56 offen offset:0 sc1
    v_mfma_f32_16x16x32_bf16 v[60:63], v[228:231], v[44:47], v[60:63]
    ds_read_b128 v[24:27], v10 offset:0
    ds_read_b128 v[28:31], v10 offset:512
    v_mfma_f32_16x16x32_bf16 v[64:67], v[228:231], v[48:51], v[64:67]
    ds_read_b128 v[32:35], v11 offset:0
    ds_read_b128 v[36:39], v11 offset:512
    v_mfma_f32_16x16x32_bf16 v[68:71], v[228:231], v[52:55], v[68:71]
    s_waitcnt vmcnt(9)
    v_mfma_f32_16x16x32_bf16 v[72:75], v[232:235], v[40:43], v[72:75]
    buffer_load_dwordx4 v[228:231], v1, s[24:27], s56 offen offset:1024 sc1
    v_mfma_f32_16x16x32_bf16 v[76:79], v[232:235], v[44:47], v[76:79]
    s_barrier
    v_mfma_f32_16x16x32_bf16 v[80:83], v[232:235], v[48:51], v[80:83]
    v_mfma_f32_16x16x32_bf16 v[84:87], v[232:235], v[52:55], v[84:87]
    s_waitcnt vmcnt(9)
    v_mfma_f32_16x16x32_bf16 v[88:91], v[236:239], v[40:43], v[88:91]
    buffer_load_dwordx4 v[232:235], v1, s[24:27], s56 offen offset:2048 sc1
    v_mfma_f32_16x16x32_bf16 v[92:95], v[236:239], v[44:47], v[92:95]
    v_mfma_f32_16x16x32_bf16 v[96:99], v[236:239], v[48:51], v[96:99]
    v_mfma_f32_16x16x32_bf16 v[100:103], v[236:239], v[52:55], v[100:103]
    s_waitcnt vmcnt(9) lgkmcnt(0)
    v_mfma_f32_16x16x32_bf16 v[56:59], v[20:23], v[24:27], v[56:59]
    buffer_load_dwordx4 v[236:239], v1, s[24:27], s56 offen offset:3072 sc1
    v_mfma_f32_16x16x32_bf16 v[60:63], v[20:23], v[28:31], v[60:63]
    s_add_u32 s56, s56, 57344
    ds_read_b128 v[40:43], v12 offset:0
    v_mfma_f32_16x16x32_bf16 v[64:67], v[20:23], v[32:35], v[64:67]
    ds_read_b128 v[44:47], v12 offset:512
    ds_read_b128 v[48:51], v13 offset:0
    v_mfma_f32_16x16x32_bf16 v[68:71], v[20:23], v[36:39], v[68:71]
    ds_read_b128 v[52:55], v13 offset:512
    s_waitcnt vmcnt(9)
    v_mfma_f32_16x16x32_bf16 v[72:75], v[120:123], v[24:27], v[72:75]
    buffer_load_dwordx4 v[20:23], v1, s[24:27], s56 offen offset:0 sc1
    v_mfma_f32_16x16x32_bf16 v[76:79], v[120:123], v[28:31], v[76:79]
    v_mfma_f32_16x16x32_bf16 v[80:83], v[120:123], v[32:35], v[80:83]
    v_mfma_f32_16x16x32_bf16 v[84:87], v[120:123], v[36:39], v[84:87]
    s_waitcnt vmcnt(9)
    v_mfma_f32_16x16x32_bf16 v[88:91], v[124:127], v[24:27], v[88:91]
    buffer_load_dwordx4 v[120:123], v1, s[24:27], s56 offen offset:1024 sc1
    v_mfma_f32_16x16x32_bf16 v[92:95], v[124:127], v[28:31], v[92:95]
    v_mfma_f32_16x16x32_bf16 v[96:99], v[124:127], v[32:35], v[96:99]
    v_mfma_f32_16x16x32_bf16 v[100:103], v[124:127], v[36:39], v[100:103]
    s_waitcnt vmcnt(9)
    v_mfma_f32_16x16x32_bf16 v[104:107], v[208:211], v[24:27], v[104:107]
    buffer_load_dwordx4 v[124:127], v1, s[24:27], s56 offen offset:2048 sc1
    v_mfma_f32_16x16x32_bf16 v[108:111], v[208:211], v[28:31], v[108:111]
    v_add_u32 v19, s98, v1
    buffer_load_dwordx4 v[128:131], v19, s[24:27], s45 offen offset:0 sc1
    v_mfma_f32_16x16x32_bf16 v[112:115], v[208:211], v[32:35], v[112:115]
    buffer_load_dwordx4 v[132:135], v19, s[24:27], s46 offen offset:0 sc1
    v_mfma_f32_16x16x32_bf16 v[116:119], v[208:211], v[36:39], v[116:119]
    s_waitcnt vmcnt(11) lgkmcnt(0)
    v_mfma_f32_16x16x32_bf16 v[56:59], v[212:215], v[40:43], v[56:59]
    ds_read_b128 v[24:27], v10 offset:8192
    ds_read_b128 v[28:31], v10 offset:8704
    v_mfma_f32_16x16x32_bf16 v[60:63], v[212:215], v[44:47], v[60:63]
    ds_read_b128 v[32:35], v11 offset:8192
    ds_read_b128 v[36:39], v11 offset:8704
    v_mfma_f32_16x16x32_bf16 v[64:67], v[212:215], v[48:51], v[64:67]
    buffer_load_dwordx4 v[136:139], v19, s[24:27], s47 offen offset:0 sc1
    v_mfma_f32_16x16x32_bf16 v[68:71], v[212:215], v[52:55], v[68:71]
    s_waitcnt vmcnt(11)
    v_mfma_f32_16x16x32_bf16 v[72:75], v[216:219], v[40:43], v[72:75]
    buffer_load_dwordx4 v[140:143], v19, s[24:27], s50 offen offset:0 sc1
    v_mfma_f32_16x16x32_bf16 v[76:79], v[216:219], v[44:47], v[76:79]
    s_barrier
    v_mfma_f32_16x16x32_bf16 v[80:83], v[216:219], v[48:51], v[80:83]
    v_add_u32 v19, s99, v1
    buffer_load_dwordx4 v[144:147], v19, s[24:27], s45 offen offset:0 sc1
    v_mfma_f32_16x16x32_bf16 v[84:87], v[216:219], v[52:55], v[84:87]
    s_waitcnt vmcnt(12)
    v_mfma_f32_16x16x32_bf16 v[88:91], v[220:223], v[40:43], v[88:91]
    buffer_load_dwordx4 v[148:151], v19, s[24:27], s46 offen offset:0 sc1
    v_mfma_f32_16x16x32_bf16 v[92:95], v[220:223], v[44:47], v[92:95]
    buffer_load_dwordx4 v[152:155], v19, s[24:27], s47 offen offset:0 sc1
    v_mfma_f32_16x16x32_bf16 v[96:99], v[220:223], v[48:51], v[96:99]
    buffer_load_dwordx4 v[156:159], v19, s[24:27], s50 offen offset:0 sc1
    v_mfma_f32_16x16x32_bf16 v[100:103], v[220:223], v[52:55], v[100:103]
    s_waitcnt vmcnt(14) lgkmcnt(0)
    v_mfma_f32_16x16x32_bf16 v[56:59], v[224:227], v[24:27], v[56:59]
    ds_read_b128 v[40:43], v12 offset:8192
    ds_read_b128 v[44:47], v12 offset:8704
    v_mfma_f32_16x16x32_bf16 v[60:63], v[224:227], v[28:31], v[60:63]
    ds_read_b128 v[48:51], v13 offset:8192
    ds_read_b128 v[52:55], v13 offset:8704
    v_mfma_f32_16x16x32_bf16 v[64:67], v[224:227], v[32:35], v[64:67]
    v_add_u32 v19, s100, v1
    buffer_load_dwordx4 v[160:163], v19, s[24:27], s45 offen offset:0 sc1
    v_mfma_f32_16x16x32_bf16 v[68:71], v[224:227], v[36:39], v[68:71]
    s_waitcnt vmcnt(14)
    v_mfma_f32_16x16x32_bf16 v[72:75], v[228:231], v[24:27], v[72:75]
    buffer_load_dwordx4 v[164:167], v19, s[24:27], s46 offen offset:0 sc1
    v_mfma_f32_16x16x32_bf16 v[76:79], v[228:231], v[28:31], v[76:79]
    v_mfma_f32_16x16x32_bf16 v[80:83], v[228:231], v[32:35], v[80:83]
    v_mfma_f32_16x16x32_bf16 v[84:87], v[228:231], v[36:39], v[84:87]
    s_waitcnt vmcnt(14)
    v_mfma_f32_16x16x32_bf16 v[88:91], v[232:235], v[24:27], v[88:91]
    v_mfma_f32_16x16x32_bf16 v[92:95], v[232:235], v[28:31], v[92:95]
    v_mfma_f32_16x16x32_bf16 v[96:99], v[232:235], v[32:35], v[96:99]
    v_mfma_f32_16x16x32_bf16 v[100:103], v[232:235], v[36:39], v[100:103]
    s_waitcnt vmcnt(13)
    v_mfma_f32_16x16x32_bf16 v[104:107], v[236:239], v[24:27], v[104:107]
    v_mfma_f32_16x16x32_bf16 v[108:111], v[236:239], v[28:31], v[108:111]
    v_mfma_f32_16x16x32_bf16 v[112:115], v[236:239], v[32:35], v[112:115]
    v_mfma_f32_16x16x32_bf16 v[116:119], v[236:239], v[36:39], v[116:119]
    s_waitcnt vmcnt(12) lgkmcnt(0)
    v_mfma_f32_16x16x32_bf16 v[64:67], v[20:23], v[48:51], v[64:67]
    buffer_load_dwordx2 v[252:253], v18, s[24:27], s60 offen sc1
    v_mfma_f32_16x16x32_bf16 v[68:71], v[20:23], v[52:55], v[68:71]
    s_waitcnt vmcnt(12)
    v_mfma_f32_16x16x32_bf16 v[80:83], v[120:123], v[48:51], v[80:83]
    v_mfma_f32_16x16x32_bf16 v[84:87], v[120:123], v[52:55], v[84:87]
    s_waitcnt vmcnt(11)
    v_mfma_f32_16x16x32_bf16 v[96:99], v[124:127], v[48:51], v[96:99]
    v_mfma_f32_16x16x32_bf16 v[100:103], v[124:127], v[52:55], v[100:103]
    v_mfma_f32_16x16x32_bf16 v[88:91], v[124:127], v[40:43], v[88:91]
    v_mfma_f32_16x16x32_bf16 v[92:95], v[124:127], v[44:47], v[92:95]
    v_mfma_f32_16x16x32_bf16 v[72:75], v[120:123], v[40:43], v[72:75]
    v_mfma_f32_16x16x32_bf16 v[76:79], v[120:123], v[44:47], v[76:79]
    v_mfma_f32_16x16x32_bf16 v[56:59], v[20:23], v[40:43], v[56:59]
    v_mfma_f32_16x16x32_bf16 v[60:63], v[20:23], v[44:47], v[60:63]
    ds_write_b128 v14, v[64:67] offset:0
    buffer_load_dwordx4 v[168:171], v19, s[24:27], s47 offen offset:0 sc1
    ds_write_b128 v14, v[68:71] offset:1024
    buffer_load_dwordx4 v[172:175], v19, s[24:27], s50 offen offset:0 sc1
    ds_write_b128 v14, v[80:83] offset:2048
    v_add_u32 v19, s98, v1
    buffer_load_dwordx4 v[176:179], v19, s[24:27], s45 offen offset:3072 sc1
    ds_write_b128 v14, v[84:87] offset:3072
    buffer_load_dwordx4 v[180:183], v19, s[24:27], s46 offen offset:3072 sc1
    ds_write_b128 v14, v[96:99] offset:4096
    buffer_load_dwordx4 v[184:187], v19, s[24:27], s47 offen offset:3072 sc1
    ds_write_b128 v14, v[100:103] offset:5120
    buffer_load_dwordx4 v[188:191], v19, s[24:27], s50 offen offset:3072 sc1
    ds_write_b128 v14, v[112:115] offset:6144
    v_add_u32 v19, s99, v1
    buffer_load_dwordx4 v[192:195], v19, s[24:27], s45 offen offset:3072 sc1
    ds_write_b128 v14, v[116:119] offset:7168
    buffer_load_dwordx4 v[196:199], v19, s[24:27], s46 offen offset:3072 sc1
    s_waitcnt lgkmcnt(0)
    s_barrier
    ds_read_b128 v[64:67], v15 offset:0
    ds_read_b128 v[80:83], v15 offset:2048
    ds_read_b128 v[96:99], v15 offset:4096
    ds_read_b128 v[112:115], v15 offset:6144
    ds_read_b128 v[40:43], v14 offset:16384
    ds_read_b128 v[44:47], v15 offset:14336
    ds_read_b128 v[68:71], v15 offset:1024
    ds_read_b128 v[84:87], v15 offset:3072
    ds_read_b128 v[100:103], v15 offset:5120
    ds_read_b128 v[116:119], v15 offset:7168
    ds_read_b128 v[48:51], v14 offset:17408
    ds_read_b128 v[52:55], v15 offset:15360
    s_waitcnt lgkmcnt(10)
    v_pk_add_f32 v[56:57], v[56:57], v[64:65] op_sel:[0,0] op_sel_hi:[1,1]
    v_pk_add_f32 v[58:59], v[58:59], v[66:67] op_sel:[0,0] op_sel_hi:[1,1]
    v_pk_add_f32 v[72:73], v[72:73], v[80:81] op_sel:[0,0] op_sel_hi:[1,1]
    v_pk_add_f32 v[74:75], v[74:75], v[82:83] op_sel:[0,0] op_sel_hi:[1,1]
    v_lshlrev_b32 v64, 16, v240
    v_and_b32 v65, 0xffff0000, v240
    v_lshlrev_b32 v66, 16, v241
    v_and_b32 v67, 0xffff0000, v241
    v_lshlrev_b32 v80, 16, v244
    v_and_b32 v81, 0xffff0000, v244
    v_lshlrev_b32 v82, 16, v245
    v_and_b32 v83, 0xffff0000, v245
    v_pk_mul_f32 v[56:57], v[56:57], v[64:65] op_sel:[0,0] op_sel_hi:[1,1]
    v_pk_mul_f32 v[58:59], v[58:59], v[66:67] op_sel:[0,0] op_sel_hi:[1,1]
    v_pk_mul_f32 v[72:73], v[72:73], v[80:81] op_sel:[0,0] op_sel_hi:[1,1]
    v_pk_mul_f32 v[74:75], v[74:75], v[82:83] op_sel:[0,0] op_sel_hi:[1,1]
    v_cvt_pk_bf16_f32 v24, v56, v57
    v_cvt_pk_bf16_f32 v25, v58, v59
    v_cvt_pk_bf16_f32 v26, v72, v73
    v_cvt_pk_bf16_f32 v27, v74, v75
    v_min_u32 v24, -2, v24
    v_min_u32 v25, -2, v25
    v_min_u32 v26, -2, v26
    v_min_u32 v27, -2, v27
    buffer_store_dwordx4 v[24:27], v1, s[24:27], s21 offen offset:0 sc1
    s_waitcnt lgkmcnt(6)
    v_pk_add_f32 v[40:41], v[40:41], v[44:45] op_sel:[0,0] op_sel_hi:[1,1]
    v_pk_add_f32 v[42:43], v[42:43], v[46:47] op_sel:[0,0] op_sel_hi:[1,1]
    v_pk_add_f32 v[88:89], v[88:89], v[96:97] op_sel:[0,0] op_sel_hi:[1,1]
    v_pk_add_f32 v[90:91], v[90:91], v[98:99] op_sel:[0,0] op_sel_hi:[1,1]
    v_pk_add_f32 v[104:105], v[104:105], v[112:113] op_sel:[0,0] op_sel_hi:[1,1]
    v_pk_add_f32 v[106:107], v[106:107], v[114:115] op_sel:[0,0] op_sel_hi:[1,1]
    v_pk_add_f32 v[104:105], v[104:105], v[40:41] op_sel:[0,0] op_sel_hi:[1,1]
    v_pk_add_f32 v[106:107], v[106:107], v[42:43] op_sel:[0,0] op_sel_hi:[1,1]
    v_lshlrev_b32 v96, 16, v248
    v_and_b32 v97, 0xffff0000, v248
    v_lshlrev_b32 v98, 16, v249
    v_and_b32 v99, 0xffff0000, v249
    v_lshlrev_b32 v112, 16, v4
    v_and_b32 v113, 0xffff0000, v4
    v_lshlrev_b32 v114, 16, v5
    v_and_b32 v115, 0xffff0000, v5
    v_pk_mul_f32 v[88:89], v[88:89], v[96:97] op_sel:[0,0] op_sel_hi:[1,1]
    v_pk_mul_f32 v[90:91], v[90:91], v[98:99] op_sel:[0,0] op_sel_hi:[1,1]
    v_pk_mul_f32 v[104:105], v[104:105], v[112:113] op_sel:[0,0] op_sel_hi:[1,1]
    v_pk_mul_f32 v[106:107], v[106:107], v[114:115] op_sel:[0,0] op_sel_hi:[1,1]
    v_cvt_pk_bf16_f32 v28, v88, v89
    v_cvt_pk_bf16_f32 v29, v90, v91
    v_cvt_pk_bf16_f32 v30, v104, v105
    v_cvt_pk_bf16_f32 v31, v106, v107
    v_min_u32 v28, -2, v28
    v_min_u32 v29, -2, v29
    v_min_u32 v30, -2, v30
    v_min_u32 v31, -2, v31
    buffer_store_dwordx4 v[28:31], v1, s[24:27], s21 offen offset:1024 sc1
    s_waitcnt lgkmcnt(4)
    v_pk_add_f32 v[60:61], v[60:61], v[68:69] op_sel:[0,0] op_sel_hi:[1,1]
    v_pk_add_f32 v[62:63], v[62:63], v[70:71] op_sel:[0,0] op_sel_hi:[1,1]
    v_pk_add_f32 v[76:77], v[76:77], v[84:85] op_sel:[0,0] op_sel_hi:[1,1]
    v_pk_add_f32 v[78:79], v[78:79], v[86:87] op_sel:[0,0] op_sel_hi:[1,1]
    v_lshlrev_b32 v68, 16, v242
    v_and_b32 v69, 0xffff0000, v242
    v_lshlrev_b32 v70, 16, v243
    v_and_b32 v71, 0xffff0000, v243
    v_lshlrev_b32 v84, 16, v246
    v_and_b32 v85, 0xffff0000, v246
    v_lshlrev_b32 v86, 16, v247
    v_and_b32 v87, 0xffff0000, v247
    v_pk_mul_f32 v[60:61], v[60:61], v[68:69] op_sel:[0,0] op_sel_hi:[1,1]
    v_pk_mul_f32 v[62:63], v[62:63], v[70:71] op_sel:[0,0] op_sel_hi:[1,1]
    v_pk_mul_f32 v[76:77], v[76:77], v[84:85] op_sel:[0,0] op_sel_hi:[1,1]
    v_pk_mul_f32 v[78:79], v[78:79], v[86:87] op_sel:[0,0] op_sel_hi:[1,1]
    v_cvt_pk_bf16_f32 v32, v60, v61
    v_cvt_pk_bf16_f32 v33, v62, v63
    v_cvt_pk_bf16_f32 v34, v76, v77
    v_cvt_pk_bf16_f32 v35, v78, v79
    v_min_u32 v32, -2, v32
    v_min_u32 v33, -2, v33
    v_min_u32 v34, -2, v34
    v_min_u32 v35, -2, v35
    buffer_store_dwordx4 v[32:35], v1, s[24:27], s22 offen offset:0 sc1
    s_waitcnt lgkmcnt(0)
    v_pk_add_f32 v[48:49], v[48:49], v[52:53] op_sel:[0,0] op_sel_hi:[1,1]
    v_pk_add_f32 v[50:51], v[50:51], v[54:55] op_sel:[0,0] op_sel_hi:[1,1]
    v_pk_add_f32 v[92:93], v[92:93], v[100:101] op_sel:[0,0] op_sel_hi:[1,1]
    v_pk_add_f32 v[94:95], v[94:95], v[102:103] op_sel:[0,0] op_sel_hi:[1,1]
    v_pk_add_f32 v[108:109], v[108:109], v[116:117] op_sel:[0,0] op_sel_hi:[1,1]
    v_pk_add_f32 v[110:111], v[110:111], v[118:119] op_sel:[0,0] op_sel_hi:[1,1]
    v_pk_add_f32 v[108:109], v[108:109], v[48:49] op_sel:[0,0] op_sel_hi:[1,1]
    v_pk_add_f32 v[110:111], v[110:111], v[50:51] op_sel:[0,0] op_sel_hi:[1,1]
    v_lshlrev_b32 v100, 16, v250
    v_and_b32 v101, 0xffff0000, v250
    v_lshlrev_b32 v102, 16, v251
    v_and_b32 v103, 0xffff0000, v251
    v_lshlrev_b32 v116, 16, v6
    v_and_b32 v117, 0xffff0000, v6
    v_lshlrev_b32 v118, 16, v7
    v_and_b32 v119, 0xffff0000, v7
    v_pk_mul_f32 v[92:93], v[92:93], v[100:101] op_sel:[0,0] op_sel_hi:[1,1]
    v_pk_mul_f32 v[94:95], v[94:95], v[102:103] op_sel:[0,0] op_sel_hi:[1,1]
    v_pk_mul_f32 v[108:109], v[108:109], v[116:117] op_sel:[0,0] op_sel_hi:[1,1]
    v_pk_mul_f32 v[110:111], v[110:111], v[118:119] op_sel:[0,0] op_sel_hi:[1,1]
    v_cvt_pk_bf16_f32 v36, v92, v93
    v_cvt_pk_bf16_f32 v37, v94, v95
    v_cvt_pk_bf16_f32 v38, v108, v109
    v_cvt_pk_bf16_f32 v39, v110, v111
    v_min_u32 v36, -2, v36
    v_min_u32 v37, -2, v37
    v_min_u32 v38, -2, v38
    v_min_u32 v39, -2, v39
    buffer_store_dwordx4 v[36:39], v1, s[24:27], s22 offen offset:1024 sc1
    s_waitcnt vmcnt(12)
    s_barrier
    s_cmp_lg_u32 s38, 0
    s_cbranch_scc1 L_nofh
    s_mov_b64 exec, 1
    buffer_store_dwordx2 v[254:255], v1, s[24:27], s54 offen sc1
    s_mov_b64 exec, -1
L_nofh:
    s_cmp_eq_u32 s40, 7
    s_cbranch_scc1 L_m_tail
    v_cmp_ne_u64 s[62:63], v[252:253], s[36:37]
    s_nop 0
    s_cmp_eq_u64 s[62:63], 0
    s_cbranch_scc1 L_fs_0_ok
    s_mov_b32 s61, 16384
L_fs_0:
    buffer_load_dwordx2 v[252:253], v18, s[24:27], s60 offen sc1
    s_waitcnt vmcnt(0)
    v_cmp_ne_u64 s[62:63], v[252:253], s[36:37]
    s_nop 0
    s_cmp_eq_u64 s[62:63], 0
    s_cbranch_scc1 L_fs_0_ok
    s_sleep 2
    s_sub_u32 s61, s61, 1
    s_cbranch_scc0 L_fs_0
L_fs_0_ok:
    s_add_u32 s3, s52, 130048
    buffer_load_dwordx4 v17, s[24:27], s52 offen sc1 lds
    buffer_load_dwordx4 v17, s[24:27], s3 offen offset:1024 sc1 lds
    s_lshl_b32 s52, s43, 7
    buffer_load_dwordx4 v[200:203], v19, s[24:27], s47 offen offset:3072 sc1
    buffer_load_dwordx4 v[204:207], v19, s[24:27], s50 offen offset:3072 sc1
    v_add_u32 v19, s100, v1
    buffer_load_dwordx4 v[208:211], v19, s[24:27], s45 offen offset:3072 sc1
    buffer_load_dwordx4 v[212:215], v19, s[24:27], s46 offen offset:3072 sc1
    buffer_load_dwordx4 v[216:219], v19, s[24:27], s47 offen offset:3072 sc1
    buffer_load_dwordx4 v[220:223], v19, s[24:27], s50 offen offset:3072 sc1
    v_add_u32 v19, 3072, v1
    buffer_load_dwordx4 v[224:227], v19, s[24:27], s45 offen offset:3072 sc1
    buffer_load_dwordx4 v[228:231], v19, s[24:27], s46 offen offset:3072 sc1
    buffer_load_dwordx4 v[232:235], v19, s[24:27], s47 offen offset:3072 sc1
    buffer_load_dwordx4 v[236:239], v19, s[24:27], s50 offen offset:3072 sc1
    buffer_load_dwordx2 v[8:9], v16, s[24:27], s49 offen sc1
    s_mul_i32 s44, s39, 114688
    s_mul_i32 s53, s38, 7168
    s_add_u32 s44, s44, s53
    s_add_u32 s44, s44, 0xd00000
    s_xor_b32 s56, s38, 0
    s_mul_i32 s56, s56, 28672
    s_add_u32 s56, s56, s44
    s_xor_b32 s57, s38, 1
    s_mul_i32 s57, s57, 28672
    s_add_u32 s57, s57, s44
    s_xor_b32 s58, s38, 2
    s_mul_i32 s58, s58, 28672
    s_add_u32 s58, s58, s44
    s_xor_b32 s59, s38, 3
    s_mul_i32 s59, s59, 28672
    s_add_u32 s59, s59, s44
    s_lshl_b32 s61, s39, 6
    s_lshl_b32 s3, s41, 2
    s_add_u32 s61, s61, s3
    v_and_b32 v11, 12, v2
    v_add3_u32 v11, s61, v2, v11
    v_mul_u32_u24 v11, 896, v11
    v_lshl_add_u32 v11, v3, 4, v11
    v_lshlrev_b32 v12, 8, v3
    v_lshl_add_u32 v12, v2, 3, v12
    v_add_u32 v12, s55, v12
    s_add_u32 s3, s48, 0
    v_add_u32 v10, s3, v1
    s_waitcnt vmcnt(0)
    s_branch L_k3
L_g2b:
    buffer_load_dwordx4 v[120:123], v1, s[24:27], s56 offen offset:1024 sc1
    buffer_load_dwordx4 v[124:127], v1, s[24:27], s56 offen offset:2048 sc1
    buffer_load_dwordx4 v[208:211], v1, s[24:27], s56 offen offset:3072 sc1
    s_add_u32 s56, s56, 57344
    buffer_load_dwordx4 v[212:215], v1, s[24:27], s56 offen offset:1024 sc1
    v_fma_f32 v80, v104, v100, v80
    v_fma_f32 v81, v104, v101, v81
    v_fma_f32 v82, v104, v102, v82
    v_fma_f32 v83, v104, v103, v83
    v_fma_f32 v84, v108, v100, v84
    v_fma_f32 v85, v108, v101, v85
    v_fma_f32 v86, v108, v102, v86
    v_fma_f32 v87, v108, v103, v87
    buffer_load_dwordx4 v[216:219], v1, s[24:27], s56 offen offset:2048 sc1
    v_mul_f32 v112, v80, v80
    v_mul_f32 v113, v81, v81
    v_mul_f32 v114, v82, v82
    v_mul_f32 v115, v83, v83
    v_mul_f32 v116, v84, v84
    v_mul_f32 v117, v85, v85
    v_mul_f32 v118, v86, v86
    v_mul_f32 v119, v87, v87
    buffer_load_dwordx4 v[220:223], v1, s[24:27], s56 offen offset:3072 sc1
    v_fma_f32 v112, v112, v28, v106
    v_fma_f32 v113, v113, v28, v106
    v_fma_f32 v114, v114, v28, v106
    v_fma_f32 v115, v115, v28, v106
    v_fma_f32 v116, v116, v30, v110
    v_fma_f32 v117, v117, v30, v110
    v_fma_f32 v118, v118, v30, v110
    v_fma_f32 v119, v119, v30, v110
    buffer_load_dwordx4 v[224:227], v1, s[24:27], s56 offen offset:0 sc1
    v_mul_f32 v112, v112, v80
    v_mul_f32 v113, v113, v81
    v_mul_f32 v114, v114, v82
    v_mul_f32 v115, v115, v83
    v_mul_f32 v116, v116, v84
    v_mul_f32 v117, v117, v85
    v_mul_f32 v118, v118, v86
    v_mul_f32 v119, v119, v87
    s_add_u32 s56, s56, 57344
    buffer_load_dwordx4 v[228:231], v1, s[24:27], s56 offen offset:1024 sc1
    v_exp_f32 v112, v112
    v_exp_f32 v113, v113
    v_exp_f32 v114, v114
    v_exp_f32 v115, v115
    v_exp_f32 v116, v116
    v_exp_f32 v117, v117
    v_exp_f32 v118, v118
    v_exp_f32 v119, v119
    buffer_load_dwordx4 v[232:235], v1, s[24:27], s56 offen offset:2048 sc1
    buffer_load_dwordx4 v[236:239], v1, s[24:27], s56 offen offset:3072 sc1
    v_fma_f32 v112, v112, v24, v24
    v_fma_f32 v113, v113, v24, v24
    v_fma_f32 v114, v114, v24, v24
    v_fma_f32 v115, v115, v24, v24
    v_fma_f32 v116, v116, v26, v26
    v_fma_f32 v117, v117, v26, v26
    v_fma_f32 v118, v118, v26, v26
    v_fma_f32 v119, v119, v26, v26
    s_add_u32 s56, s56, 57344
    buffer_load_dwordx4 v[20:23], v1, s[24:27], s56 offen offset:1024 sc1
    v_rcp_f32 v112, v112
    v_rcp_f32 v113, v113
    v_rcp_f32 v114, v114
    v_rcp_f32 v115, v115
    v_rcp_f32 v116, v116
    v_rcp_f32 v117, v117
    v_rcp_f32 v118, v118
    v_rcp_f32 v119, v119
    s_add_u32 m0, s55, 40960
    s_add_u32 s49, s60, 512
    s_and_b32 s49, s49, 2047
    s_add_u32 s49, s49, s54
    s_add_u32 s49, s49, 2048
    buffer_load_dwordx4 v16, s[28:31], s49 offen lds
    s_add_u32 s49, s49, 31744
    buffer_load_dwordx4 v17, s[28:31], s49 offen offset:1024 lds
    v_mul_f32 v80, v80, v112
    v_mul_f32 v81, v81, v113
    v_mul_f32 v82, v82, v114
    v_mul_f32 v83, v83, v115
    v_mul_f32 v84, v84, v116
    v_mul_f32 v85, v85, v117
    v_mul_f32 v86, v86, v118
    v_mul_f32 v87, v87, v119
    v_cvt_pk_bf16_f32 v4, v80, v81
    v_cvt_pk_bf16_f32 v5, v82, v83
    v_cvt_pk_bf16_f32 v6, v84, v85
    v_cvt_pk_bf16_f32 v7, v86, v87
    s_cmp_eq_u32 s41, 0
    s_cbranch_scc1 L_csw1
    v_swap_b32 v240, v248
    v_swap_b32 v241, v249
    v_swap_b32 v242, v250
    v_swap_b32 v243, v251
    v_swap_b32 v244, v4
    v_swap_b32 v245, v5
    v_swap_b32 v246, v6
    v_swap_b32 v247, v7
L_csw1:
    v_and_b32 v112, 0xffff0000, v14
    v_and_b32 v113, 0xffff0000, v14
    v_and_b32 v114, 0xffff0000, v14
    v_and_b32 v115, 0xffff0000, v14
    v_and_b32 v116, 0xffff0000, v15
    v_and_b32 v117, 0xffff0000, v15
    v_and_b32 v118, 0xffff0000, v15
    v_and_b32 v119, 0xffff0000, v15
    s_waitcnt vmcnt(48)
    s_barrier
    ds_read_b128 v[24:27], v10 offset:8192
    ds_read_b128 v[28:31], v10 offset:8704
    ds_read_b128 v[32:35], v11 offset:8192
    ds_read_b128 v[36:39], v11 offset:8704
    s_waitcnt vmcnt(12) lgkmcnt(0)
    v_mfma_f32_16x16x32_bf16 v[56:59], v[120:123], v[24:27], v[112:115]
    ds_read_b128 v[40:43], v12 offset:8192
    ds_read_b128 v[44:47], v12 offset:8704
    v_mfma_f32_16x16x32_bf16 v[60:63], v[120:123], v[28:31], v[116:119]
    ds_read_b128 v[48:51], v13 offset:8192
    ds_read_b128 v[52:55], v13 offset:8704
    v_mfma_f32_16x16x32_bf16 v[64:67], v[120:123], v[32:35], 0
    v_mfma_f32_16x16x32_bf16 v[68:71], v[120:123], v[36:39], 0
    s_waitcnt vmcnt(11)
    v_mfma_f32_16x16x32_bf16 v[72:75], v[124:127], v[24:27], v[112:115]
    buffer_load_dwordx4 v[120:123], v1, s[24:27], s56 offen offset:2048 sc1
    v_mfma_f32_16x16x32_bf16 v[76:79], v[124:127], v[28:31], v[116:119]
    v_mfma_f32_16x16x32_bf16 v[80:83], v[124:127], v[32:35], 0
    v_mfma_f32_16x16x32_bf16 v[84:87], v[124:127], v[36:39], 0
    s_waitcnt vmcnt(11)
    v_mfma_f32_16x16x32_bf16 v[88:91], v[208:211], v[24:27], v[112:115]
    buffer_load_dwordx4 v[124:127], v1, s[24:27], s56 offen offset:3072 sc1
    v_mfma_f32_16x16x32_bf16 v[92:95], v[208:211], v[28:31], v[116:119]
    v_mfma_f32_16x16x32_bf16 v[96:99], v[208:211], v[32:35], 0
    v_mfma_f32_16x16x32_bf16 v[100:103], v[208:211], v[36:39], 0
    s_waitcnt vmcnt(11) lgkmcnt(0)
    v_mfma_f32_16x16x32_bf16 v[56:59], v[212:215], v[40:43], v[56:59]
    buffer_load_dwordx4 v[208:211], v1, s[24:27], s56 offen offset:0 sc1
    v_mfma_f32_16x16x32_bf16 v[60:63], v[212:215], v[44:47], v[60:63]
    s_add_u32 s56, s56, 57344
    ds_read_b128 v[24:27], v10 offset:16384
    v_mfma_f32_16x16x32_bf16 v[64:67], v[212:215], v[48:51], v[64:67]
    s_cmp_eq_u32 s56, s57
    s_cselect_b32 s56, s53, s56
    v_mfma_f32_16x16x32_bf16 v[68:71], v[212:215], v[52:55], v[68:71]
    ds_read_b128 v[28:31], v10 offset:16896
    s_waitcnt vmcnt(11)
    v_mfma_f32_16x16x32_bf16 v[72:75], v[216:219], v[40:43], v[72:75]
    buffer_load_dwordx4 v[212:215], v1, s[24:27], s56 offen offset:1024 sc1
    v_mfma_f32_16x16x32_bf16 v[76:79], v[216:219], v[44:47], v[76:79]
    s_barrier
    v_mfma_f32_16x16x32_bf16 v[80:83], v[216:219], v[48:51], v[80:83]
    ds_read_b128 v[32:35], v11 offset:16384
    ds_read_b128 v[36:39], v11 offset:16896
    v_mfma_f32_16x16x32_bf16 v[84:87], v[216:219], v[52:55], v[84:87]
    s_add_u32 m0, s52, 8192
    s_waitcnt vmcnt(11)
    v_mfma_f32_16x16x32_bf16 v[88:91], v[220:223], v[40:43], v[88:91]
    buffer_load_dwordx4 v[216:219], v1, s[24:27], s56 offen offset:2048 sc1
    v_mfma_f32_16x16x32_bf16 v[92:95], v[220:223], v[44:47], v[92:95]
    s_add_u32 s49, s60, 640
    s_and_b32 s49, s49, 2047
    v_mfma_f32_16x16x32_bf16 v[96:99], v[220:223], v[48:51], v[96:99]
    s_add_u32 s49, s49, s58
    v_mfma_f32_16x16x32_bf16 v[100:103], v[220:223], v[52:55], v[100:103]
    s_waitcnt vmcnt(11)
    v_mfma_f32_16x16x32_bf16 v[104:107], v[224:227], v[40:43], 0
    buffer_load_dwordx4 v[220:223], v1, s[24:27], s56 offen offset:3072 sc1
    v_mfma_f32_16x16x32_bf16 v[108:111], v[224:227], v[44:47], 0
    s_add_u32 s56, s56, 57344
    v_mfma_f32_16x16x32_bf16 v[112:115], v[224:227], v[48:51], 0
    buffer_load_dwordx4 v16, s[28:31], s49 offen offset:0 lds
    v_mfma_f32_16x16x32_bf16 v[116:119], v[224:227], v[52:55], 0
    s_add_u32 s49, s49, 31744
    s_waitcnt vmcnt(12) lgkmcnt(0)
    v_mfma_f32_16x16x32_bf16 v[56:59], v[228:231], v[24:27], v[56:59]
    buffer_load_dwordx4 v[224:227], v1, s[24:27], s56 offen offset:1024 sc1
    v_mfma_f32_16x16x32_bf16 v[60:63], v[228:231], v[28:31], v[60:63]
    ds_read_b128 v[40:43], v12 offset:16384
    ds_read_b128 v[44:47], v12 offset:16896
    v_mfma_f32_16x16x32_bf16 v[64:67], v[228:231], v[32:35], v[64:67]
    ds_read_b128 v[48:51], v13 offset:16384
    ds_read_b128 v[52:55], v13 offset:16896
    v_mfma_f32_16x16x32_bf16 v[68:71], v[228:231], v[36:39], v[68:71]
    v_and_b32 v18, 31, v0
    s_waitcnt vmcnt(12)
    v_mfma_f32_16x16x32_bf16 v[72:75], v[232:235], v[24:27], v[72:75]
    buffer_load_dwordx4 v[228:231], v1, s[24:27], s56 offen offset:2048 sc1
    v_mfma_f32_16x16x32_bf16 v[76:79], v[232:235], v[28:31], v[76:79]
    buffer_load_dwordx4 v17, s[28:31], s49 offen offset:1024 lds
    v_mfma_f32_16x16x32_bf16 v[80:83], v[232:235], v[32:35], v[80:83]
    s_add_u32 s49, s49, 31744
    v_lshlrev_b32 v18, 7, v18
    v_mfma_f32_16x16x32_bf16 v[84:87], v[232:235], v[36:39], v[84:87]
    s_mul_i32 s45, s43, 114688
    s_waitcnt vmcnt(13)
    v_mfma_f32_16x16x32_bf16 v[88:91], v[236:239], v[24:27], v[88:91]
    buffer_load_dwordx4 v[232:235], v1, s[24:27], s56 offen offset:3072 sc1
    v_mfma_f32_16x16x32_bf16 v[92:95], v[236:239], v[28:31], v[92:95]
    buffer_load_dwordx4 v16, s[28:31], s49 offen offset:2048 lds
    v_mfma_f32_16x16x32_bf16 v[96:99], v[236:239], v[32:35], v[96:99]
    s_add_u32 s49, s49, 31744
    s_mul_i32 s46, s38, 7168
    v_mfma_f32_16x16x32_bf16 v[100:103], v[236:239], v[36:39], v[100:103]
    s_add_u32 s45, s45, s46
    s_waitcnt vmcnt(14) lgkmcnt(0)
    v_mfma_f32_16x16x32_bf16 v[56:59], v[20:23], v[40:43], v[56:59]
    buffer_load_dwordx4 v[236:239], v1, s[24:27], s56 offen offset:0 sc1
    v_mfma_f32_16x16x32_bf16 v[60:63], v[20:23], v[44:47], v[60:63]
    s_add_u32 s56, s56, 57344
    ds_read_b128 v[24:27], v10 offset:24576
    v_mfma_f32_16x16x32_bf16 v[64:67], v[20:23], v[48:51], v[64:67]
    ds_read_b128 v[28:31], v10 offset:25088
    ds_read_b128 v[32:35], v11 offset:24576
    v_mfma_f32_16x16x32_bf16 v[68:71], v[20:23], v[52:55], v[68:71]
    ds_read_b128 v[36:39], v11 offset:25088
    s_waitcnt vmcnt(12)
    v_mfma_f32_16x16x32_bf16 v[72:75], v[120:123], v[40:43], v[72:75]
    buffer_load_dwordx4 v[20:23], v1, s[24:27], s56 offen offset:1024 sc1
    v_mfma_f32_16x16x32_bf16 v[76:79], v[120:123], v[44:47], v[76:79]
    s_barrier
    v_mfma_f32_16x16x32_bf16 v[80:83], v[120:123], v[48:51], v[80:83]
    buffer_load_dwordx4 v17, s[28:31], s49 offen offset:3072 lds
    v_mfma_f32_16x16x32_bf16 v[84:87], v[120:123], v[52:55], v[84:87]
    s_add_u32 s45, s45, 0x1100000
    s_waitcnt vmcnt(13)
    v_mfma_f32_16x16x32_bf16 v[88:91], v[124:127], v[40:43], v[88:91]
    buffer_load_dwordx4 v[120:123], v1, s[24:27], s56 offen offset:2048 sc1
    v_mfma_f32_16x16x32_bf16 v[92:95], v[124:127], v[44:47], v[92:95]
    ds_write_b128 v8, v[128:131] offset:16384
    v_mfma_f32_16x16x32_bf16 v[96:99], v[124:127], v[48:51], v[96:99]
    ds_write_b128 v8, v[132:135] offset:17408
    v_mfma_f32_16x16x32_bf16 v[100:103], v[124:127], v[52:55], v[100:103]
    s_add_u32 s46, s45, 28672
    s_waitcnt vmcnt(13)
    v_mfma_f32_16x16x32_bf16 v[104:107], v[208:211], v[40:43], v[104:107]
    buffer_load_dwordx4 v[124:127], v1, s[24:27], s56 offen offset:3072 sc1
    v_mfma_f32_16x16x32_bf16 v[108:111], v[208:211], v[44:47], v[108:111]
    s_add_u32 s56, s56, 57344
    s_add_u32 s47, s46, 28672
    v_mfma_f32_16x16x32_bf16 v[112:115], v[208:211], v[48:51], v[112:115]
    ds_write_b128 v8, v[136:139] offset:18432
    v_mfma_f32_16x16x32_bf16 v[116:119], v[208:211], v[52:55], v[116:119]
    s_add_u32 s50, s47, 28672
    s_waitcnt vmcnt(13) lgkmcnt(3)
    v_mfma_f32_16x16x32_bf16 v[56:59], v[212:215], v[24:27], v[56:59]
    buffer_load_dwordx4 v[208:211], v1, s[24:27], s56 offen offset:1024 sc1
    v_mfma_f32_16x16x32_bf16 v[60:63], v[212:215], v[28:31], v[60:63]
    ds_read_b128 v[40:43], v12 offset:24576
    ds_read_b128 v[44:47], v12 offset:25088
    v_mfma_f32_16x16x32_bf16 v[64:67], v[212:215], v[32:35], v[64:67]
    ds_read_b128 v[48:51], v13 offset:24576
    ds_read_b128 v[52:55], v13 offset:25088
    v_mfma_f32_16x16x32_bf16 v[68:71], v[212:215], v[36:39], v[68:71]
    s_add_u32 s98, s40, s39
    s_waitcnt vmcnt(13)
    v_mfma_f32_16x16x32_bf16 v[72:75], v[216:219], v[24:27], v[72:75]
    buffer_load_dwordx4 v[212:215], v1, s[24:27], s56 offen offset:2048 sc1
    v_mfma_f32_16x16x32_bf16 v[76:79], v[216:219], v[28:31], v[76:79]
    ds_write_b128 v8, v[140:143] offset:19456
    v_mfma_f32_16x16x32_bf16 v[80:83], v[216:219], v[32:35], v[80:83]
    s_and_b32 s98, s98, 3
    v_mfma_f32_16x16x32_bf16 v[84:87], v[216:219], v[36:39], v[84:87]
    s_waitcnt vmcnt(13)
    v_mfma_f32_16x16x32_bf16 v[88:91], v[220:223], v[24:27], v[88:91]
    buffer_load_dwordx4 v[216:219], v1, s[24:27], s56 offen offset:3072 sc1
    v_mfma_f32_16x16x32_bf16 v[92:95], v[220:223], v[28:31], v[92:95]
    s_cmp_eq_u32 s98, 3
    s_cselect_b32 s98, 0, s98
    v_mfma_f32_16x16x32_bf16 v[96:99], v[220:223], v[32:35], v[96:99]
    s_lshl_b32 s98, s98, 10
    s_add_u32 s99, s98, 1024
    v_mfma_f32_16x16x32_bf16 v[100:103], v[220:223], v[36:39], v[100:103]
    s_waitcnt vmcnt(12) lgkmcnt(1)
    v_mfma_f32_16x16x32_bf16 v[56:59], v[224:227], v[40:43], v[56:59]
    buffer_load_dwordx4 v[220:223], v1, s[24:27], s56 offen offset:0 sc1
    v_mfma_f32_16x16x32_bf16 v[60:63], v[224:227], v[44:47], v[60:63]
    s_add_u32 s56, s56, 57344
    ds_read_b128 v[24:27], v10 offset:32768
    v_mfma_f32_16x16x32_bf16 v[64:67], v[224:227], v[48:51], v[64:67]
    s_cmp_eq_u32 s56, s57
    s_cselect_b32 s56, s53, s56
    v_mfma_f32_16x16x32_bf16 v[68:71], v[224:227], v[52:55], v[68:71]
    ds_read_b128 v[28:31], v10 offset:33280
    s_waitcnt vmcnt(12)
    v_mfma_f32_16x16x32_bf16 v[72:75], v[228:231], v[40:43], v[72:75]
    buffer_load_dwordx4 v[224:227], v1, s[24:27], s56 offen offset:1024 sc1
    v_mfma_f32_16x16x32_bf16 v[76:79], v[228:231], v[44:47], v[76:79]
    s_barrier
    v_mfma_f32_16x16x32_bf16 v[80:83], v[228:231], v[48:51], v[80:83]
    ds_read_b128 v[32:35], v11 offset:32768
    ds_read_b128 v[36:39], v11 offset:33280
    v_mfma_f32_16x16x32_bf16 v[84:87], v[228:231], v[52:55], v[84:87]
    s_add_u32 m0, s52, 24576
    s_waitcnt vmcnt(11)
    v_mfma_f32_16x16x32_bf16 v[88:91], v[232:235], v[40:43], v[88:91]
    buffer_load_dwordx4 v[228:231], v1, s[24:27], s56 offen offset:2048 sc1
    v_mfma_f32_16x16x32_bf16 v[92:95], v[232:235], v[44:47], v[92:95]
    s_add_u32 s49, s60, 896
    s_and_b32 s49, s49, 2047
    v_mfma_f32_16x16x32_bf16 v[96:99], v[232:235], v[48:51], v[96:99]
    s_add_u32 s49, s49, s58
    v_mfma_f32_16x16x32_bf16 v[100:103], v[232:235], v[52:55], v[100:103]
    s_waitcnt vmcnt(10)
    v_mfma_f32_16x16x32_bf16 v[104:107], v[236:239], v[40:43], v[104:107]
    buffer_load_dwordx4 v[232:235], v1, s[24:27], s56 offen offset:3072 sc1
    v_mfma_f32_16x16x32_bf16 v[108:111], v[236:239], v[44:47], v[108:111]
    s_add_u32 s56, s56, 57344
    v_mfma_f32_16x16x32_bf16 v[112:115], v[236:239], v[48:51], v[112:115]
    buffer_load_dwordx4 v16, s[28:31], s49 offen offset:0 lds
    v_mfma_f32_16x16x32_bf16 v[116:119], v[236:239], v[52:55], v[116:119]
    s_add_u32 s49, s49, 31744
    s_waitcnt vmcnt(11) lgkmcnt(0)
    v_mfma_f32_16x16x32_bf16 v[56:59], v[20:23], v[24:27], v[56:59]
    buffer_load_dwordx4 v[236:239], v1, s[24:27], s56 offen offset:1024 sc1
    v_mfma_f32_16x16x32_bf16 v[60:63], v[20:23], v[28:31], v[60:63]
    ds_read_b128 v[40:43], v12 offset:32768
    ds_read_b128 v[44:47], v12 offset:33280
    v_mfma_f32_16x16x32_bf16 v[64:67], v[20:23], v[32:35], v[64:67]
    ds_read_b128 v[48:51], v13 offset:32768
    ds_read_b128 v[52:55], v13 offset:33280
    v_mfma_f32_16x16x32_bf16 v[68:71], v[20:23], v[36:39], v[68:71]
    s_waitcnt vmcnt(10)
    v_mfma_f32_16x16x32_bf16 v[72:75], v[120:123], v[24:27], v[72:75]
    buffer_load_dwordx4 v[20:23], v1, s[24:27], s56 offen offset:2048 sc1
    v_mfma_f32_16x16x32_bf16 v[76:79], v[120:123], v[28:31], v[76:79]
    buffer_load_dwordx4 v17, s[28:31], s49 offen offset:1024 lds
    v_mfma_f32_16x16x32_bf16 v[80:83], v[120:123], v[32:35], v[80:83]
    s_add_u32 s49, s49, 31744
    v_mfma_f32_16x16x32_bf16 v[84:87], v[120:123], v[36:39], v[84:87]
    s_waitcnt vmcnt(11)
    v_mfma_f32_16x16x32_bf16 v[88:91], v[124:127], v[24:27], v[88:91]
    buffer_load_dwordx4 v[120:123], v1, s[24:27], s56 offen offset:3072 sc1
    v_mfma_f32_16x16x32_bf16 v[92:95], v[124:127], v[28:31], v[92:95]
    buffer_load_dwordx4 v16, s[28:31], s49 offen offset:2048 lds
    v_mfma_f32_16x16x32_bf16 v[96:99], v[124:127], v[32:35], v[96:99]
    s_add_u32 s49, s49, 31744
    v_mfma_f32_16x16x32_bf16 v[100:103], v[124:127], v[36:39], v[100:103]
    s_waitcnt vmcnt(12) lgkmcnt(0)
    v_mfma_f32_16x16x32_bf16 v[56:59], v[208:211], v[40:43], v[56:59]
    buffer_load_dwordx4 v[124:127], v1, s[24:27], s56 offen offset:0 sc1
    v_mfma_f32_16x16x32_bf16 v[60:63], v[208:211], v[44:47], v[60:63]
    s_add_u32 s56, s56, 57344
    ds_read_b128 v[24:27], v10 offset:0
    v_mfma_f32_16x16x32_bf16 v[64:67], v[208:211], v[48:51], v[64:67]
    ds_read_b128 v[28:31], v10 offset:512
    ds_read_b128 v[32:35], v11 offset:0
    v_mfma_f32_16x16x32_bf16 v[68:71], v[208:211], v[52:55], v[68:71]
    ds_read_b128 v[36:39], v11 offset:512
    s_waitcnt vmcnt(12)
    v_mfma_f32_16x16x32_bf16 v[72:75], v[212:215], v[40:43], v[72:75]
    buffer_load_dwordx4 v[208:211], v1, s[24:27], s56 offen offset:1024 sc1
    v_mfma_f32_16x16x32_bf16 v[76:79], v[212:215], v[44:47], v[76:79]
    s_barrier
    v_mfma_f32_16x16x32_bf16 v[80:83], v[212:215], v[48:51], v[80:83]
    buffer_load_dwordx4 v17, s[28:31], s49 offen offset:3072 lds
    v_mfma_f32_16x16x32_bf16 v[84:87], v[212:215], v[52:55], v[84:87]
    s_waitcnt vmcnt(13)
    v_mfma_f32_16x16x32_bf16 v[88:91], v[216:219], v[40:43], v[88:91]
    buffer_load_dwordx4 v[212:215], v1, s[24:27], s56 offen offset:2048 sc1
    v_mfma_f32_16x16x32_bf16 v[92:95], v[216:219], v[44:47], v[92:95]
    ds_write_b128 v8, v[144:147] offset:32768
    v_mfma_f32_16x16x32_bf16 v[96:99], v[216:219], v[48:51], v[96:99]
    ds_write_b128 v8, v[148:151] offset:33792
    v_mfma_f32_16x16x32_bf16 v[100:103], v[216:219], v[52:55], v[100:103]
    s_waitcnt vmcnt(13)
    v_mfma_f32_16x16x32_bf16 v[104:107], v[220:223], v[40:43], v[104:107]
    buffer_load_dwordx4 v[216:219], v1, s[24:27], s56 offen offset:3072 sc1
    v_mfma_f32_16x16x32_bf16 v[108:111], v[220:223], v[44:47], v[108:111]
    s_add_u32 s56, s56, 57344
    v_mfma_f32_16x16x32_bf16 v[112:115], v[220:223], v[48:51], v[112:115]
    ds_write_b128 v8, v[152:155] offset:34816
    v_mfma_f32_16x16x32_bf16 v[116:119], v[220:223], v[52:55], v[116:119]
    s_waitcnt vmcnt(13) lgkmcnt(3)
    v_mfma_f32_16x16x32_bf16 v[56:59], v[224:227], v[24:27], v[56:59]
    buffer_load_dwordx4 v[220:223], v1, s[24:27], s56 offen offset:1024 sc1
    v_mfma_f32_16x16x32_bf16 v[60:63], v[224:227], v[28:31], v[60:63]
    ds_read_b128 v[40:43], v12 offset:0
    ds_read_b128 v[44:47], v12 offset:512
    v_mfma_f32_16x16x32_bf16 v[64:67], v[224:227], v[32:35], v[64:67]
    ds_read_b128 v[48:51], v13 offset:0
    ds_read_b128 v[52:55], v13 offset:512
    v_mfma_f32_16x16x32_bf16 v[68:71], v[224:227], v[36:39], v[68:71]
    s_waitcnt vmcnt(13)
    v_mfma_f32_16x16x32_bf16 v[72:75], v[228:231], v[24:27], v[72:75]
    buffer_load_dwordx4 v[224:227], v1, s[24:27], s56 offen offset:2048 sc1
    v_mfma_f32_16x16x32_bf16 v[76:79], v[228:231], v[28:31], v[76:79]
    ds_write_b128 v8, v[156:159] offset:35840
    v_mfma_f32_16x16x32_bf16 v[80:83], v[228:231], v[32:35], v[80:83]
    s_cmp_eq_u32 s99, 3072
    s_cselect_b32 s99, 0, s99
    v_mfma_f32_16x16x32_bf16 v[84:87], v[228:231], v[36:39], v[84:87]
    s_add_u32 s100, s99, 1024
    s_waitcnt vmcnt(13)
    v_mfma_f32_16x16x32_bf16 v[88:91], v[232:235], v[24:27], v[88:91]
    buffer_load_dwordx4 v[228:231], v1, s[24:27], s56 offen offset:3072 sc1
    v_mfma_f32_16x16x32_bf16 v[92:95], v[232:235], v[28:31], v[92:95]
    s_cmp_eq_u32 s100, 3072
    s_cselect_b32 s100, 0, s100
    v_mfma_f32_16x16x32_bf16 v[96:99], v[232:235], v[32:35], v[96:99]
    s_mov_b32 s32, s12
    s_and_b32 s33, s13, 0xffff
    v_mfma_f32_16x16x32_bf16 v[100:103], v[232:235], v[36:39], v[100:103]
    s_mov_b32 s34, 0x1c0000
    s_waitcnt vmcnt(12) lgkmcnt(1)
    v_mfma_f32_16x16x32_bf16 v[56:59], v[236:239], v[40:43], v[56:59]
    buffer_load_dwordx4 v[232:235], v1, s[24:27], s56 offen offset:0 sc1
    v_mfma_f32_16x16x32_bf16 v[60:63], v[236:239], v[44:47], v[60:63]
    s_add_u32 s56, s56, 57344
    ds_read_b128 v[24:27], v10 offset:8192
    v_mfma_f32_16x16x32_bf16 v[64:67], v[236:239], v[48:51], v[64:67]
    s_cmp_eq_u32 s56, s57
    s_cselect_b32 s56, s53, s56
    v_mfma_f32_16x16x32_bf16 v[68:71], v[236:239], v[52:55], v[68:71]
    ds_read_b128 v[28:31], v10 offset:8704
    s_waitcnt vmcnt(12)
    v_mfma_f32_16x16x32_bf16 v[72:75], v[20:23], v[40:43], v[72:75]
    buffer_load_dwordx4 v[236:239], v1, s[24:27], s56 offen offset:1024 sc1
    v_mfma_f32_16x16x32_bf16 v[76:79], v[20:23], v[44:47], v[76:79]
    s_barrier
    v_mfma_f32_16x16x32_bf16 v[80:83], v[20:23], v[48:51], v[80:83]
    ds_read_b128 v[32:35], v11 offset:8192
    ds_read_b128 v[36:39], v11 offset:8704
    v_mfma_f32_16x16x32_bf16 v[84:87], v[20:23], v[52:55], v[84:87]
    s_add_u32 m0, s52, 0
    s_waitcnt vmcnt(11)
    v_mfma_f32_16x16x32_bf16 v[88:91], v[120:123], v[40:43], v[88:91]
    buffer_load_dwordx4 v[20:23], v1, s[24:27], s56 offen offset:2048 sc1
    v_mfma_f32_16x16x32_bf16 v[92:95], v[120:123], v[44:47], v[92:95]
    s_add_u32 s49, s60, 1152
    s_and_b32 s49, s49, 2047
    v_mfma_f32_16x16x32_bf16 v[96:99], v[120:123], v[48:51], v[96:99]
    s_add_u32 s49, s49, s58
    s_mov_b32 s35, 0x20000
    v_mfma_f32_16x16x32_bf16 v[100:103], v[120:123], v[52:55], v[100:103]
    s_add_u32 s55, s48, 38912
    s_waitcnt vmcnt(10)
    v_mfma_f32_16x16x32_bf16 v[104:107], v[124:127], v[40:43], v[104:107]
    buffer_load_dwordx4 v[120:123], v1, s[24:27], s56 offen offset:3072 sc1
    v_mfma_f32_16x16x32_bf16 v[108:111], v[124:127], v[44:47], v[108:111]
    s_add_u32 s56, s56, 57344
    s_add_u32 s3, s48, 24576
    v_mfma_f32_16x16x32_bf16 v[112:115], v[124:127], v[48:51], v[112:115]
    buffer_load_dwordx4 v16, s[28:31], s49 offen offset:0 lds
    v_mfma_f32_16x16x32_bf16 v[116:119], v[124:127], v[52:55], v[116:119]
    s_add_u32 s49, s49, 31744
    s_waitcnt vmcnt(11) lgkmcnt(0)
    v_mfma_f32_16x16x32_bf16 v[56:59], v[208:211], v[24:27], v[56:59]
    buffer_load_dwordx4 v[124:127], v1, s[24:27], s56 offen offset:1024 sc1
    v_mfma_f32_16x16x32_bf16 v[60:63], v[208:211], v[28:31], v[60:63]
    ds_read_b128 v[40:43], v12 offset:8192
    ds_read_b128 v[44:47], v12 offset:8704
    v_mfma_f32_16x16x32_bf16 v[64:67], v[208:211], v[32:35], v[64:67]
    ds_read_b128 v[48:51], v13 offset:8192
    ds_read_b128 v[52:55], v13 offset:8704
    v_mfma_f32_16x16x32_bf16 v[68:71], v[208:211], v[36:39], v[68:71]
    v_add_u32 v14, s3, v1
    s_waitcnt vmcnt(10)
    v_mfma_f32_16x16x32_bf16 v[72:75], v[212:215], v[24:27], v[72:75]
    buffer_load_dwordx4 v[208:211], v1, s[24:27], s56 offen offset:2048 sc1
    v_mfma_f32_16x16x32_bf16 v[76:79], v[212:215], v[28:31], v[76:79]
    buffer_load_dwordx4 v17, s[28:31], s49 offen offset:1024 lds
    v_mfma_f32_16x16x32_bf16 v[80:83], v[212:215], v[32:35], v[80:83]
    s_add_u32 s49, s49, 31744
    s_sub_u32 s3, 65536, s48
    v_mfma_f32_16x16x32_bf16 v[84:87], v[212:215], v[36:39], v[84:87]
    v_add_u32 v15, s3, v1
    s_waitcnt vmcnt(11)
    v_mfma_f32_16x16x32_bf16 v[88:91], v[216:219], v[24:27], v[88:91]
    buffer_load_dwordx4 v[212:215], v1, s[24:27], s56 offen offset:3072 sc1
    v_mfma_f32_16x16x32_bf16 v[92:95], v[216:219], v[28:31], v[92:95]
    buffer_load_dwordx4 v16, s[28:31], s49 offen offset:2048 lds
    v_mfma_f32_16x16x32_bf16 v[96:99], v[216:219], v[32:35], v[96:99]
    s_add_u32 s49, s49, 31744
    s_xor_b32 s3, s40, s38
    v_mfma_f32_16x16x32_bf16 v[100:103], v[216:219], v[36:39], v[100:103]
    s_waitcnt vmcnt(12) lgkmcnt(0)
    v_mfma_f32_16x16x32_bf16 v[56:59], v[220:223], v[40:43], v[56:59]
    buffer_load_dwordx4 v[216:219], v1, s[24:27], s56 offen offset:0 sc1
    v_mfma_f32_16x16x32_bf16 v[60:63], v[220:223], v[44:47], v[60:63]
    s_add_u32 s56, s56, 57344
    ds_read_b128 v[24:27], v10 offset:16384
    v_mfma_f32_16x16x32_bf16 v[64:67], v[220:223], v[48:51], v[64:67]
    ds_read_b128 v[28:31], v10 offset:16896
    ds_read_b128 v[32:35], v11 offset:16384
    v_mfma_f32_16x16x32_bf16 v[68:71], v[220:223], v[52:55], v[68:71]
    ds_read_b128 v[36:39], v11 offset:16896
    s_waitcnt vmcnt(12)
    v_mfma_f32_16x16x32_bf16 v[72:75], v[224:227], v[40:43], v[72:75]
    buffer_load_dwordx4 v[220:223], v1, s[24:27], s56 offen offset:1024 sc1
    v_mfma_f32_16x16x32_bf16 v[76:79], v[224:227], v[44:47], v[76:79]
    s_barrier
    v_mfma_f32_16x16x32_bf16 v[80:83], v[224:227], v[48:51], v[80:83]
    buffer_load_dwordx4 v17, s[28:31], s49 offen offset:3072 lds
    v_mfma_f32_16x16x32_bf16 v[84:87], v[224:227], v[52:55], v[84:87]
    s_waitcnt vmcnt(13)
    v_mfma_f32_16x16x32_bf16 v[88:91], v[228:231], v[40:43], v[88:91]
    buffer_load_dwordx4 v[224:227], v1, s[24:27], s56 offen offset:2048 sc1
    v_mfma_f32_16x16x32_bf16 v[92:95], v[228:231], v[44:47], v[92:95]
    ds_write_b128 v8, v[160:163] offset:8192
    v_mfma_f32_16x16x32_bf16 v[96:99], v[228:231], v[48:51], v[96:99]
    ds_write_b128 v8, v[164:167] offset:9216
    v_mfma_f32_16x16x32_bf16 v[100:103], v[228:231], v[52:55], v[100:103]
    s_waitcnt vmcnt(13)
    v_mfma_f32_16x16x32_bf16 v[104:107], v[232:235], v[40:43], v[104:107]
    buffer_load_dwordx4 v[228:231], v1, s[24:27], s56 offen offset:3072 sc1
    v_mfma_f32_16x16x32_bf16 v[108:111], v[232:235], v[44:47], v[108:111]
    s_add_u32 s56, s56, 57344
    v_mfma_f32_16x16x32_bf16 v[112:115], v[232:235], v[48:51], v[112:115]
    ds_write_b128 v8, v[168:171] offset:10240
    v_mfma_f32_16x16x32_bf16 v[116:119], v[232:235], v[52:55], v[116:119]
    s_waitcnt vmcnt(13) lgkmcnt(3)
    s_setprio 0
    v_mfma_f32_16x16x32_bf16 v[56:59], v[236:239], v[24:27], v[56:59]
    buffer_load_dwordx4 v[232:235], v1, s[24:27], s56 offen offset:1024 sc1
    v_mfma_f32_16x16x32_bf16 v[60:63], v[236:239], v[28:31], v[60:63]
    ds_read_b128 v[40:43], v12 offset:16384
    ds_read_b128 v[44:47], v12 offset:16896
    v_mfma_f32_16x16x32_bf16 v[64:67], v[236:239], v[32:35], v[64:67]
    ds_read_b128 v[48:51], v13 offset:16384
    ds_read_b128 v[52:55], v13 offset:16896
    v_mfma_f32_16x16x32_bf16 v[68:71], v[236:239], v[36:39], v[68:71]
    s_waitcnt vmcnt(13)
    v_mfma_f32_16x16x32_bf16 v[72:75], v[20:23], v[24:27], v[72:75]
    buffer_load_dwordx4 v[236:239], v1, s[24:27], s56 offen offset:2048 sc1
    v_mfma_f32_16x16x32_bf16 v[76:79], v[20:23], v[28:31], v[76:79]
    ds_write_b128 v8, v[172:175] offset:11264
    v_mfma_f32_16x16x32_bf16 v[80:83], v[20:23], v[32:35], v[80:83]
    s_cmp_eq_u32 s3, 0
    s_cselect_b32 s51, 2, 3
    v_mfma_f32_16x16x32_bf16 v[84:87], v[20:23], v[36:39], v[84:87]
    s_waitcnt vmcnt(13)
    v_mfma_f32_16x16x32_bf16 v[88:91], v[120:123], v[24:27], v[88:91]
    buffer_load_dwordx4 v[20:23], v1, s[24:27], s56 offen offset:3072 sc1
    v_mfma_f32_16x16x32_bf16 v[92:95], v[120:123], v[28:31], v[92:95]
    s_cmp_eq_u32 s3, 4
    s_cselect_b32 s51, 1, s51
    v_mfma_f32_16x16x32_bf16 v[96:99], v[120:123], v[32:35], v[96:99]
    s_mul_i32 s21, s44, 57344
    s_add_u32 s21, s21, 0xd00000
    v_mfma_f32_16x16x32_bf16 v[100:103], v[120:123], v[36:39], v[100:103]
    s_and_b32 s3, s40, 3
    s_waitcnt vmcnt(12) lgkmcnt(1)
    v_mfma_f32_16x16x32_bf16 v[56:59], v[124:127], v[40:43], v[56:59]
    buffer_load_dwordx4 v[120:123], v1, s[24:27], s56 offen offset:0 sc1
    v_mfma_f32_16x16x32_bf16 v[60:63], v[124:127], v[44:47], v[60:63]
    s_add_u32 s56, s56, 57344
    ds_read_b128 v[24:27], v10 offset:24576
    v_mfma_f32_16x16x32_bf16 v[64:67], v[124:127], v[48:51], v[64:67]
    s_cmp_eq_u32 s56, s57
    s_cselect_b32 s56, s53, s56
    v_mfma_f32_16x16x32_bf16 v[68:71], v[124:127], v[52:55], v[68:71]
    ds_read_b128 v[28:31], v10 offset:25088
    s_waitcnt vmcnt(12)
    v_mfma_f32_16x16x32_bf16 v[72:75], v[208:211], v[40:43], v[72:75]
    buffer_load_dwordx4 v[124:127], v1, s[24:27], s56 offen offset:1024 sc1
    v_mfma_f32_16x16x32_bf16 v[76:79], v[208:211], v[44:47], v[76:79]
    s_barrier
    v_mfma_f32_16x16x32_bf16 v[80:83], v[208:211], v[48:51], v[80:83]
    ds_read_b128 v[32:35], v11 offset:24576
    ds_read_b128 v[36:39], v11 offset:25088
    v_mfma_f32_16x16x32_bf16 v[84:87], v[208:211], v[52:55], v[84:87]
    s_add_u32 m0, s52, 16384
    s_waitcnt vmcnt(11)
    v_mfma_f32_16x16x32_bf16 v[88:91], v[212:215], v[40:43], v[88:91]
    buffer_load_dwordx4 v[208:211], v1, s[24:27], s56 offen offset:2048 sc1
    v_mfma_f32_16x16x32_bf16 v[92:95], v[212:215], v[44:47], v[92:95]
    s_add_u32 s49, s60, 1408
    s_and_b32 s49, s49, 2047
    v_mfma_f32_16x16x32_bf16 v[96:99], v[212:215], v[48:51], v[96:99]
    s_add_u32 s49, s49, s58
    s_mul_i32 s22, s3, 7168
    v_mfma_f32_16x16x32_bf16 v[100:103], v[212:215], v[52:55], v[100:103]
    s_add_u32 s21, s21, s22
    s_waitcnt vmcnt(10)
    v_mfma_f32_16x16x32_bf16 v[104:107], v[216:219], v[40:43], v[104:107]
    buffer_load_dwordx4 v[212:215], v1, s[24:27], s56 offen offset:3072 sc1
    v_mfma_f32_16x16x32_bf16 v[108:111], v[216:219], v[44:47], v[108:111]
    s_add_u32 s56, s56, 57344
    s_lshr_b32 s3, s40, 2
    v_mfma_f32_16x16x32_bf16 v[112:115], v[216:219], v[48:51], v[112:115]
    buffer_load_dwordx4 v16, s[28:31], s49 offen offset:0 lds
    v_mfma_f32_16x16x32_bf16 v[116:119], v[216:219], v[52:55], v[116:119]
    s_add_u32 s49, s49, 31744
    s_waitcnt vmcnt(11) lgkmcnt(0)
    v_mfma_f32_16x16x32_bf16 v[56:59], v[220:223], v[24:27], v[56:59]
    buffer_load_dwordx4 v[216:219], v1, s[24:27], s56 offen offset:1024 sc1
    v_mfma_f32_16x16x32_bf16 v[60:63], v[220:223], v[28:31], v[60:63]
    ds_read_b128 v[40:43], v12 offset:24576
    ds_read_b128 v[44:47], v12 offset:25088
    v_mfma_f32_16x16x32_bf16 v[64:67], v[220:223], v[32:35], v[64:67]
    ds_read_b128 v[48:51], v13 offset:24576
    ds_read_b128 v[52:55], v13 offset:25088
    v_mfma_f32_16x16x32_bf16 v[68:71], v[220:223], v[36:39], v[68:71]
    s_xor_b32 s20, s3, s40
    s_waitcnt vmcnt(10)
    v_mfma_f32_16x16x32_bf16 v[72:75], v[224:227], v[24:27], v[72:75]
    buffer_load_dwordx4 v[220:223], v1, s[24:27], s56 offen offset:2048 sc1
    v_mfma_f32_16x16x32_bf16 v[76:79], v[224:227], v[28:31], v[76:79]
    buffer_load_dwordx4 v17, s[28:31], s49 offen offset:1024 lds
    v_mfma_f32_16x16x32_bf16 v[80:83], v[224:227], v[32:35], v[80:83]
    s_add_u32 s49, s49, 31744
    s_and_b32 s20, s20, 1
    v_mfma_f32_16x16x32_bf16 v[84:87], v[224:227], v[36:39], v[84:87]
    s_mul_i32 s20, s20, 28672
    s_waitcnt vmcnt(11)
    v_mfma_f32_16x16x32_bf16 v[88:91], v[228:231], v[24:27], v[88:91]
    buffer_load_dwordx4 v[224:227], v1, s[24:27], s56 offen offset:3072 sc1
    v_mfma_f32_16x16x32_bf16 v[92:95], v[228:231], v[28:31], v[92:95]
    buffer_load_dwordx4 v16, s[28:31], s49 offen offset:2048 lds
    v_mfma_f32_16x16x32_bf16 v[96:99], v[228:231], v[32:35], v[96:99]
    s_add_u32 s49, s49, 31744
    s_add_u32 s20, s20, s21
    v_mfma_f32_16x16x32_bf16 v[100:103], v[228:231], v[36:39], v[100:103]
    s_add_u32 s20, s20, 6144
    s_waitcnt vmcnt(12) lgkmcnt(0)
    v_mfma_f32_16x16x32_bf16 v[56:59], v[232:235], v[40:43], v[56:59]
    buffer_load_dwordx4 v[228:231], v1, s[24:27], s56 offen offset:0 sc1
    v_mfma_f32_16x16x32_bf16 v[60:63], v[232:235], v[44:47], v[60:63]
    s_add_u32 s56, s56, 57344
    ds_read_b128 v[24:27], v10 offset:32768
    v_mfma_f32_16x16x32_bf16 v[64:67], v[232:235], v[48:51], v[64:67]
    ds_read_b128 v[28:31], v10 offset:33280
    ds_read_b128 v[32:35], v11 offset:32768
    v_mfma_f32_16x16x32_bf16 v[68:71], v[232:235], v[52:55], v[68:71]
    ds_read_b128 v[36:39], v11 offset:33280
    s_waitcnt vmcnt(12)
    v_mfma_f32_16x16x32_bf16 v[72:75], v[236:239], v[40:43], v[72:75]
    buffer_load_dwordx4 v[232:235], v1, s[24:27], s56 offen offset:1024 sc1
    v_mfma_f32_16x16x32_bf16 v[76:79], v[236:239], v[44:47], v[76:79]
    s_barrier
    v_mfma_f32_16x16x32_bf16 v[80:83], v[236:239], v[48:51], v[80:83]
    buffer_load_dwordx4 v17, s[28:31], s49 offen offset:3072 lds
    v_mfma_f32_16x16x32_bf16 v[84:87], v[236:239], v[52:55], v[84:87]
    s_mul_i32 s3, s3, 3072
    s_waitcnt vmcnt(13)
    v_mfma_f32_16x16x32_bf16 v[88:91], v[20:23], v[40:43], v[88:91]
    buffer_load_dwordx4 v[236:239], v1, s[24:27], s56 offen offset:2048 sc1
    v_mfma_f32_16x16x32_bf16 v[92:95], v[20:23], v[44:47], v[92:95]
    ds_write_b128 v8, v[176:179] offset:24576
    v_mfma_f32_16x16x32_bf16 v[96:99], v[20:23], v[48:51], v[96:99]
    ds_write_b128 v8, v[180:183] offset:25600
    v_mfma_f32_16x16x32_bf16 v[100:103], v[20:23], v[52:55], v[100:103]
    s_add_u32 s21, s21, s3
    s_waitcnt vmcnt(13)
    v_mfma_f32_16x16x32_bf16 v[104:107], v[120:123], v[40:43], v[104:107]
    buffer_load_dwordx4 v[20:23], v1, s[24:27], s56 offen offset:3072 sc1
    v_mfma_f32_16x16x32_bf16 v[108:111], v[120:123], v[44:47], v[108:111]
    s_add_u32 s56, s56, 57344
    s_add_u32 s22, s21, 28672
    v_mfma_f32_16x16x32_bf16 v[112:115], v[120:123], v[48:51], v[112:115]
    ds_write_b128 v8, v[184:187] offset:26624
    v_mfma_f32_16x16x32_bf16 v[116:119], v[120:123], v[52:55], v[116:119]
    s_waitcnt vmcnt(13) lgkmcnt(3)
    v_mfma_f32_16x16x32_bf16 v[56:59], v[124:127], v[24:27], v[56:59]
    buffer_load_dwordx4 v[120:123], v1, s[24:27], s56 offen offset:1024 sc1
    v_mfma_f32_16x16x32_bf16 v[60:63], v[124:127], v[28:31], v[60:63]
    ds_read_b128 v[40:43], v12 offset:32768
    ds_read_b128 v[44:47], v12 offset:33280
    v_mfma_f32_16x16x32_bf16 v[64:67], v[124:127], v[32:35], v[64:67]
    ds_read_b128 v[48:51], v13 offset:32768
    ds_read_b128 v[52:55], v13 offset:33280
    v_mfma_f32_16x16x32_bf16 v[68:71], v[124:127], v[36:39], v[68:71]
    s_waitcnt vmcnt(13)
    v_mfma_f32_16x16x32_bf16 v[72:75], v[208:211], v[24:27], v[72:75]
    buffer_load_dwordx4 v[124:127], v1, s[24:27], s56 offen offset:2048 sc1
    v_mfma_f32_16x16x32_bf16 v[76:79], v[208:211], v[28:31], v[76:79]
    ds_write_b128 v8, v[188:191] offset:27648
    v_mfma_f32_16x16x32_bf16 v[80:83], v[208:211], v[32:35], v[80:83]
    v_mfma_f32_16x16x32_bf16 v[84:87], v[208:211], v[36:39], v[84:87]
    s_waitcnt vmcnt(13)
    v_mfma_f32_16x16x32_bf16 v[88:91], v[212:215], v[24:27], v[88:91]
    buffer_load_dwordx4 v[208:211], v1, s[24:27], s56 offen offset:3072 sc1
    v_mfma_f32_16x16x32_bf16 v[92:95], v[212:215], v[28:31], v[92:95]
    v_mfma_f32_16x16x32_bf16 v[96:99], v[212:215], v[32:35], v[96:99]
    v_mfma_f32_16x16x32_bf16 v[100:103], v[212:215], v[36:39], v[100:103]
    s_waitcnt vmcnt(12) lgkmcnt(1)
    v_mfma_f32_16x16x32_bf16 v[56:59], v[216:219], v[40:43], v[56:59]
    buffer_load_dwordx4 v[212:215], v1, s[24:27], s56 offen offset:0 sc1
    v_mfma_f32_16x16x32_bf16 v[60:63], v[216:219], v[44:47], v[60:63]
    s_add_u32 s56, s56, 57344
    ds_read_b128 v[24:27], v10 offset:0
    v_mfma_f32_16x16x32_bf16 v[64:67], v[216:219], v[48:51], v[64:67]
    s_cmp_eq_u32 s56, s57
    s_cselect_b32 s56, s53, s56
    v_mfma_f32_16x16x32_bf16 v[68:71], v[216:219], v[52:55], v[68:71]
    ds_read_b128 v[28:31], v10 offset:512
    s_waitcnt vmcnt(12)
    v_mfma_f32_16x16x32_bf16 v[72:75], v[220:223], v[40:43], v[72:75]
    buffer_load_dwordx4 v[216:219], v1, s[24:27], s56 offen offset:1024 sc1
    v_mfma_f32_16x16x32_bf16 v[76:79], v[220:223], v[44:47], v[76:79]
    s_barrier
    v_mfma_f32_16x16x32_bf16 v[80:83], v[220:223], v[48:51], v[80:83]
    ds_read_b128 v[32:35], v11 offset:0
    ds_read_b128 v[36:39], v11 offset:512
    v_mfma_f32_16x16x32_bf16 v[84:87], v[220:223], v[52:55], v[84:87]
    s_add_u32 m0, s52, 32768
    s_waitcnt vmcnt(11)
    v_mfma_f32_16x16x32_bf16 v[88:91], v[224:227], v[40:43], v[88:91]
    buffer_load_dwordx4 v[220:223], v1, s[24:27], s56 offen offset:2048 sc1
    v_mfma_f32_16x16x32_bf16 v[92:95], v[224:227], v[44:47], v[92:95]
    s_add_u32 s49, s60, 1664
    s_and_b32 s49, s49, 2047
    v_mfma_f32_16x16x32_bf16 v[96:99], v[224:227], v[48:51], v[96:99]
    s_add_u32 s49, s49, s58
    v_mfma_f32_16x16x32_bf16 v[100:103], v[224:227], v[52:55], v[100:103]
    s_waitcnt vmcnt(10)
    v_mfma_f32_16x16x32_bf16 v[104:107], v[228:231], v[40:43], v[104:107]
    buffer_load_dwordx4 v[224:227], v1, s[24:27], s56 offen offset:3072 sc1
    v_mfma_f32_16x16x32_bf16 v[108:111], v[228:231], v[44:47], v[108:111]
    s_add_u32 s56, s56, 57344
    v_mfma_f32_16x16x32_bf16 v[112:115], v[228:231], v[48:51], v[112:115]
    buffer_load_dwordx4 v16, s[28:31], s49 offen offset:0 lds
    v_mfma_f32_16x16x32_bf16 v[116:119], v[228:231], v[52:55], v[116:119]
    s_add_u32 s49, s49, 31744
    s_waitcnt vmcnt(11) lgkmcnt(0)
    v_mfma_f32_16x16x32_bf16 v[56:59], v[232:235], v[24:27], v[56:59]
    buffer_load_dwordx4 v[228:231], v1, s[24:27], s56 offen offset:1024 sc1
    v_mfma_f32_16x16x32_bf16 v[60:63], v[232:235], v[28:31], v[60:63]
    ds_read_b128 v[40:43], v12 offset:0
    ds_read_b128 v[44:47], v12 offset:512
    v_mfma_f32_16x16x32_bf16 v[64:67], v[232:235], v[32:35], v[64:67]
    ds_read_b128 v[48:51], v13 offset:0
    ds_read_b128 v[52:55], v13 offset:512
    v_mfma_f32_16x16x32_bf16 v[68:71], v[232:235], v[36:39], v[68:71]
    s_waitcnt vmcnt(10)
    v_mfma_f32_16x16x32_bf16 v[72:75], v[236:239], v[24:27], v[72:75]
    buffer_load_dwordx4 v[232:235], v1, s[24:27], s56 offen offset:2048 sc1
    v_mfma_f32_16x16x32_bf16 v[76:79], v[236:239], v[28:31], v[76:79]
    buffer_load_dwordx4 v17, s[28:31], s49 offen offset:1024 lds
    v_mfma_f32_16x16x32_bf16 v[80:83], v[236:239], v[32:35], v[80:83]
    s_add_u32 s49, s49, 31744
    v_mfma_f32_16x16x32_bf16 v[84:87], v[236:239], v[36:39], v[84:87]
    s_waitcnt vmcnt(11)
    v_mfma_f32_16x16x32_bf16 v[88:91], v[20:23], v[24:27], v[88:91]
    buffer_load_dwordx4 v[236:239], v1, s[24:27], s56 offen offset:3072 sc1
    v_mfma_f32_16x16x32_bf16 v[92:95], v[20:23], v[28:31], v[92:95]
    buffer_load_dwordx4 v16, s[28:31], s49 offen offset:2048 lds
    v_mfma_f32_16x16x32_bf16 v[96:99], v[20:23], v[32:35], v[96:99]
    s_add_u32 s49, s49, 31744
    v_mfma_f32_16x16x32_bf16 v[100:103], v[20:23], v[36:39], v[100:103]
    s_waitcnt vmcnt(12) lgkmcnt(0)
    v_mfma_f32_16x16x32_bf16 v[56:59], v[120:123], v[40:43], v[56:59]
    buffer_load_dwordx4 v[20:23], v1, s[24:27], s56 offen offset:0 sc1
    v_mfma_f32_16x16x32_bf16 v[60:63], v[120:123], v[44:47], v[60:63]
    s_add_u32 s56, s56, 57344
    ds_read_b128 v[24:27], v10 offset:8192
    v_mfma_f32_16x16x32_bf16 v[64:67], v[120:123], v[48:51], v[64:67]
    ds_read_b128 v[28:31], v10 offset:8704
    ds_read_b128 v[32:35], v11 offset:8192
    v_mfma_f32_16x16x32_bf16 v[68:71], v[120:123], v[52:55], v[68:71]
    ds_read_b128 v[36:39], v11 offset:8704
    s_waitcnt vmcnt(12)
    v_mfma_f32_16x16x32_bf16 v[72:75], v[124:127], v[40:43], v[72:75]
    buffer_load_dwordx4 v[120:123], v1, s[24:27], s56 offen offset:1024 sc1
    v_mfma_f32_16x16x32_bf16 v[76:79], v[124:127], v[44:47], v[76:79]
    s_barrier
    v_mfma_f32_16x16x32_bf16 v[80:83], v[124:127], v[48:51], v[80:83]
    buffer_load_dwordx4 v17, s[28:31], s49 offen offset:3072 lds
    v_mfma_f32_16x16x32_bf16 v[84:87], v[124:127], v[52:55], v[84:87]
    s_waitcnt vmcnt(13)
    v_mfma_f32_16x16x32_bf16 v[88:91], v[208:211], v[40:43], v[88:91]
    buffer_load_dwordx4 v[124:127], v1, s[24:27], s56 offen offset:2048 sc1
    v_mfma_f32_16x16x32_bf16 v[92:95], v[208:211], v[44:47], v[92:95]
    ds_write_b128 v8, v[192:195] offset:0
    v_mfma_f32_16x16x32_bf16 v[96:99], v[208:211], v[48:51], v[96:99]
    ds_write_b128 v8, v[196:199] offset:1024
    v_mfma_f32_16x16x32_bf16 v[100:103], v[208:211], v[52:55], v[100:103]
    s_waitcnt vmcnt(13)
    v_mfma_f32_16x16x32_bf16 v[104:107], v[212:215], v[40:43], v[104:107]
    buffer_load_dwordx4 v[208:211], v1, s[24:27], s56 offen offset:3072 sc1
    v_mfma_f32_16x16x32_bf16 v[108:111], v[212:215], v[44:47], v[108:111]
    s_add_u32 s56, s56, 57344
    v_mfma_f32_16x16x32_bf16 v[112:115], v[212:215], v[48:51], v[112:115]
    ds_write_b128 v8, v[200:203] offset:2048
    v_mfma_f32_16x16x32_bf16 v[116:119], v[212:215], v[52:55], v[116:119]
    s_waitcnt vmcnt(13) lgkmcnt(3)
    v_mfma_f32_16x16x32_bf16 v[56:59], v[216:219], v[24:27], v[56:59]
    buffer_load_dwordx4 v[212:215], v1, s[24:27], s56 offen offset:1024 sc1
    v_mfma_f32_16x16x32_bf16 v[60:63], v[216:219], v[28:31], v[60:63]
    ds_read_b128 v[40:43], v12 offset:8192
    ds_read_b128 v[44:47], v12 offset:8704
    v_mfma_f32_16x16x32_bf16 v[64:67], v[216:219], v[32:35], v[64:67]
    ds_read_b128 v[48:51], v13 offset:8192
    ds_read_b128 v[52:55], v13 offset:8704
    v_mfma_f32_16x16x32_bf16 v[68:71], v[216:219], v[36:39], v[68:71]
    s_waitcnt vmcnt(13)
    v_mfma_f32_16x16x32_bf16 v[72:75], v[220:223], v[24:27], v[72:75]
    buffer_load_dwordx4 v[216:219], v1, s[24:27], s56 offen offset:2048 sc1
    v_mfma_f32_16x16x32_bf16 v[76:79], v[220:223], v[28:31], v[76:79]
    ds_write_b128 v8, v[204:207] offset:3072
    v_mfma_f32_16x16x32_bf16 v[80:83], v[220:223], v[32:35], v[80:83]
    v_mfma_f32_16x16x32_bf16 v[84:87], v[220:223], v[36:39], v[84:87]
    s_waitcnt vmcnt(13)
    v_mfma_f32_16x16x32_bf16 v[88:91], v[224:227], v[24:27], v[88:91]
    buffer_load_dwordx4 v[220:223], v1, s[24:27], s56 offen offset:3072 sc1
    v_mfma_f32_16x16x32_bf16 v[92:95], v[224:227], v[28:31], v[92:95]
    v_mfma_f32_16x16x32_bf16 v[96:99], v[224:227], v[32:35], v[96:99]
    v_mfma_f32_16x16x32_bf16 v[100:103], v[224:227], v[36:39], v[100:103]
    s_waitcnt vmcnt(12) lgkmcnt(1)
    v_mfma_f32_16x16x32_bf16 v[56:59], v[228:231], v[40:43], v[56:59]
    buffer_load_dwordx4 v[224:227], v1, s[24:27], s56 offen offset:0 sc1
    v_mfma_f32_16x16x32_bf16 v[60:63], v[228:231], v[44:47], v[60:63]
    s_add_u32 s56, s56, 57344
    ds_read_b128 v[24:27], v10 offset:16384
    v_mfma_f32_16x16x32_bf16 v[64:67], v[228:231], v[48:51], v[64:67]
    s_cmp_eq_u32 s56, s57
    s_cselect_b32 s56, s53, s56
    v_mfma_f32_16x16x32_bf16 v[68:71], v[228:231], v[52:55], v[68:71]
    ds_read_b128 v[28:31], v10 offset:16896
    s_waitcnt vmcnt(12)
    v_mfma_f32_16x16x32_bf16 v[72:75], v[232:235], v[40:43], v[72:75]
    buffer_load_dwordx4 v[228:231], v1, s[24:27], s56 offen offset:1024 sc1
    v_mfma_f32_16x16x32_bf16 v[76:79], v[232:235], v[44:47], v[76:79]
    s_barrier
    v_mfma_f32_16x16x32_bf16 v[80:83], v[232:235], v[48:51], v[80:83]
    ds_read_b128 v[32:35], v11 offset:16384
    ds_read_b128 v[36:39], v11 offset:16896
    v_mfma_f32_16x16x32_bf16 v[84:87], v[232:235], v[52:55], v[84:87]
    s_add_u32 m0, s52, 8192
    s_waitcnt vmcnt(11)
    v_mfma_f32_16x16x32_bf16 v[88:91], v[236:239], v[40:43], v[88:91]
    buffer_load_dwordx4 v[232:235], v1, s[24:27], s56 offen offset:2048 sc1
    v_mfma_f32_16x16x32_bf16 v[92:95], v[236:239], v[44:47], v[92:95]
    s_add_u32 s49, s60, 1920
    s_and_b32 s49, s49, 2047
    v_mfma_f32_16x16x32_bf16 v[96:99], v[236:239], v[48:51], v[96:99]
    s_add_u32 s49, s49, s58
    v_mfma_f32_16x16x32_bf16 v[100:103], v[236:239], v[52:55], v[100:103]
    s_waitcnt vmcnt(10)
    v_mfma_f32_16x16x32_bf16 v[104:107], v[20:23], v[40:43], v[104:107]
    buffer_load_dwordx4 v[236:239], v1, s[24:27], s56 offen offset:3072 sc1
    v_mfma_f32_16x16x32_bf16 v[108:111], v[20:23], v[44:47], v[108:111]
    s_add_u32 s56, s56, 57344
    v_mfma_f32_16x16x32_bf16 v[112:115], v[20:23], v[48:51], v[112:115]
    buffer_load_dwordx4 v16, s[28:31], s49 offen offset:0 lds
    v_mfma_f32_16x16x32_bf16 v[116:119], v[20:23], v[52:55], v[116:119]
    s_add_u32 s49, s49, 31744
    s_waitcnt vmcnt(11) lgkmcnt(0)
    v_mfma_f32_16x16x32_bf16 v[56:59], v[120:123], v[24:27], v[56:59]
    buffer_load_dwordx4 v[20:23], v1, s[24:27], s56 offen offset:1024 sc1
    v_mfma_f32_16x16x32_bf16 v[60:63], v[120:123], v[28:31], v[60:63]
    ds_read_b128 v[40:43], v12 offset:16384
    ds_read_b128 v[44:47], v12 offset:16896
    v_mfma_f32_16x16x32_bf16 v[64:67], v[120:123], v[32:35], v[64:67]
    ds_read_b128 v[48:51], v13 offset:16384
    ds_read_b128 v[52:55], v13 offset:16896
    v_mfma_f32_16x16x32_bf16 v[68:71], v[120:123], v[36:39], v[68:71]
    s_waitcnt vmcnt(10)
    v_mfma_f32_16x16x32_bf16 v[72:75], v[124:127], v[24:27], v[72:75]
    buffer_load_dwordx4 v[120:123], v1, s[24:27], s56 offen offset:2048 sc1
    v_mfma_f32_16x16x32_bf16 v[76:79], v[124:127], v[28:31], v[76:79]
    buffer_load_dwordx4 v17, s[28:31], s49 offen offset:1024 lds
    v_mfma_f32_16x16x32_bf16 v[80:83], v[124:127], v[32:35], v[80:83]
    s_add_u32 s49, s49, 31744
    v_mfma_f32_16x16x32_bf16 v[84:87], v[124:127], v[36:39], v[84:87]
    s_waitcnt vmcnt(11)
    v_mfma_f32_16x16x32_bf16 v[88:91], v[208:211], v[24:27], v[88:91]
    buffer_load_dwordx4 v[124:127], v1, s[24:27], s56 offen offset:3072 sc1
    v_mfma_f32_16x16x32_bf16 v[92:95], v[208:211], v[28:31], v[92:95]
    buffer_load_dwordx4 v16, s[28:31], s49 offen offset:2048 lds
    v_mfma_f32_16x16x32_bf16 v[96:99], v[208:211], v[32:35], v[96:99]
    s_add_u32 s49, s49, 31744
    v_mfma_f32_16x16x32_bf16 v[100:103], v[208:211], v[36:39], v[100:103]
    s_waitcnt vmcnt(12) lgkmcnt(0)
    v_mfma_f32_16x16x32_bf16 v[56:59], v[212:215], v[40:43], v[56:59]
    buffer_load_dwordx4 v[208:211], v1, s[24:27], s56 offen offset:0 sc1
    v_mfma_f32_16x16x32_bf16 v[60:63], v[212:215], v[44:47], v[60:63]
    s_add_u32 s56, s56, 57344
    ds_read_b128 v[24:27], v10 offset:24576
    v_mfma_f32_16x16x32_bf16 v[64:67], v[212:215], v[48:51], v[64:67]
    ds_read_b128 v[28:31], v10 offset:25088
    ds_read_b128 v[32:35], v11 offset:24576
    v_mfma_f32_16x16x32_bf16 v[68:71], v[212:215], v[52:55], v[68:71]
    ds_read_b128 v[36:39], v11 offset:25088
    s_waitcnt vmcnt(12)
    v_mfma_f32_16x16x32_bf16 v[72:75], v[216:219], v[40:43], v[72:75]
    buffer_load_dwordx4 v[212:215], v1, s[24:27], s56 offen offset:1024 sc1
    v_mfma_f32_16x16x32_bf16 v[76:79], v[216:219], v[44:47], v[76:79]
    s_barrier
    v_mfma_f32_16x16x32_bf16 v[80:83], v[216:219], v[48:51], v[80:83]
    buffer_load_dwordx4 v17, s[28:31], s49 offen offset:3072 lds
    v_mfma_f32_16x16x32_bf16 v[84:87], v[216:219], v[52:55], v[84:87]
    s_lshl_b32 s60, s43, 12
    s_waitcnt vmcnt(13)
    v_mfma_f32_16x16x32_bf16 v[88:91], v[220:223], v[40:43], v[88:91]
    buffer_load_dwordx4 v[216:219], v1, s[24:27], s56 offen offset:2048 sc1
    v_mfma_f32_16x16x32_bf16 v[92:95], v[220:223], v[44:47], v[92:95]
    s_add_u32 s60, s60, 0xb8000
    s_lshl_b32 s49, s39, 10
    v_mfma_f32_16x16x32_bf16 v[96:99], v[220:223], v[48:51], v[96:99]
    s_add_u32 s49, s49, 0xb0000
    s_lshl_b32 s54, s40, 7
    v_mfma_f32_16x16x32_bf16 v[100:103], v[220:223], v[52:55], v[100:103]
    s_add_u32 s54, s54, s49
    s_waitcnt vmcnt(13)
    v_mfma_f32_16x16x32_bf16 v[104:107], v[224:227], v[40:43], v[104:107]
    buffer_load_dwordx4 v[220:223], v1, s[24:27], s56 offen offset:3072 sc1
    v_mfma_f32_16x16x32_bf16 v[108:111], v[224:227], v[44:47], v[108:111]
    s_add_u32 s56, s56, 57344
    v_and_b32 v16, 1, v0
    v_mfma_f32_16x16x32_bf16 v[112:115], v[224:227], v[48:51], v[112:115]
    v_lshl_add_u32 v16, v16, 2, s38
    v_lshlrev_b32 v16, 7, v16
    v_mfma_f32_16x16x32_bf16 v[116:119], v[224:227], v[52:55], v[116:119]
    v_lshrrev_b32 v17, 5, v1
    s_waitcnt vmcnt(13) lgkmcnt(0)
    v_mfma_f32_16x16x32_bf16 v[56:59], v[228:231], v[24:27], v[56:59]
    buffer_load_dwordx4 v[224:227], v1, s[24:27], s56 offen offset:1024 sc1
    v_mfma_f32_16x16x32_bf16 v[60:63], v[228:231], v[28:31], v[60:63]
    ds_read_b128 v[40:43], v12 offset:24576
    ds_read_b128 v[44:47], v12 offset:25088
    v_mfma_f32_16x16x32_bf16 v[64:67], v[228:231], v[32:35], v[64:67]
    ds_read_b128 v[48:51], v13 offset:24576
    ds_read_b128 v[52:55], v13 offset:25088
    v_mfma_f32_16x16x32_bf16 v[68:71], v[228:231], v[36:39], v[68:71]
    v_mul_u32_u24 v17, 4096, v17
    s_waitcnt vmcnt(13)
    v_mfma_f32_16x16x32_bf16 v[72:75], v[232:235], v[24:27], v[72:75]
    buffer_load_dwordx4 v[228:231], v1, s[24:27], s56 offen offset:2048 sc1
    v_mfma_f32_16x16x32_bf16 v[76:79], v[232:235], v[28:31], v[76:79]
    v_and_or_b32 v17, v1, 16, v17
    s_lshl_b32 s52, s39, 2
    v_mfma_f32_16x16x32_bf16 v[80:83], v[232:235], v[32:35], v[80:83]
    s_add_u32 s52, s52, s38
    s_lshl_b32 s52, s52, 5
    v_mfma_f32_16x16x32_bf16 v[84:87], v[232:235], v[36:39], v[84:87]
    s_mul_i32 s3, s43, 262144
    s_waitcnt vmcnt(13)
    v_mfma_f32_16x16x32_bf16 v[88:91], v[236:239], v[24:27], v[88:91]
    buffer_load_dwordx4 v[232:235], v1, s[24:27], s56 offen offset:3072 sc1
    v_mfma_f32_16x16x32_bf16 v[92:95], v[236:239], v[28:31], v[92:95]
    s_add_u32 s52, s52, s3
    s_add_u32 s52, s52, 0xb00000
    v_mfma_f32_16x16x32_bf16 v[96:99], v[236:239], v[32:35], v[96:99]
    s_mov_b32 m0, s55
    v_mfma_f32_16x16x32_bf16 v[100:103], v[236:239], v[36:39], v[100:103]
    s_waitcnt vmcnt(12) lgkmcnt(0)
    v_mfma_f32_16x16x32_bf16 v[56:59], v[20:23], v[40:43], v[56:59]
    buffer_load_dwordx4 v[236:239], v1, s[24:27], s56 offen offset:0 sc1
    v_mfma_f32_16x16x32_bf16 v[60:63], v[20:23], v[44:47], v[60:63]
    s_add_u32 s56, s56, 57344
    ds_read_b128 v[24:27], v10 offset:32768
    v_mfma_f32_16x16x32_bf16 v[64:67], v[20:23], v[48:51], v[64:67]
    s_cmp_eq_u32 s56, s57
    s_cselect_b32 s56, s53, s56
    v_mfma_f32_16x16x32_bf16 v[68:71], v[20:23], v[52:55], v[68:71]
    ds_read_b128 v[28:31], v10 offset:33280
    s_waitcnt vmcnt(12)
    v_mfma_f32_16x16x32_bf16 v[72:75], v[120:123], v[40:43], v[72:75]
    buffer_load_dwordx4 v[20:23], v1, s[24:27], s56 offen offset:1024 sc1
    v_mfma_f32_16x16x32_bf16 v[76:79], v[120:123], v[44:47], v[76:79]
    s_barrier
    v_mfma_f32_16x16x32_bf16 v[80:83], v[120:123], v[48:51], v[80:83]
    ds_read_b128 v[32:35], v11 offset:32768
    ds_read_b128 v[36:39], v11 offset:33280
    v_mfma_f32_16x16x32_bf16 v[84:87], v[120:123], v[52:55], v[84:87]
    s_waitcnt vmcnt(11)
    v_mfma_f32_16x16x32_bf16 v[88:91], v[124:127], v[40:43], v[88:91]
    buffer_load_dwordx4 v[120:123], v1, s[24:27], s56 offen offset:2048 sc1
    v_mfma_f32_16x16x32_bf16 v[92:95], v[124:127], v[44:47], v[92:95]
    v_mfma_f32_16x16x32_bf16 v[96:99], v[124:127], v[48:51], v[96:99]
    v_mfma_f32_16x16x32_bf16 v[100:103], v[124:127], v[52:55], v[100:103]
    s_waitcnt vmcnt(10)
    v_mfma_f32_16x16x32_bf16 v[104:107], v[208:211], v[40:43], v[104:107]
    buffer_load_dwordx4 v[124:127], v1, s[24:27], s56 offen offset:3072 sc1
    v_mfma_f32_16x16x32_bf16 v[108:111], v[208:211], v[44:47], v[108:111]
    s_add_u32 s56, s56, 57344
    v_mfma_f32_16x16x32_bf16 v[112:115], v[208:211], v[48:51], v[112:115]
    v_mfma_f32_16x16x32_bf16 v[116:119], v[208:211], v[52:55], v[116:119]
    s_waitcnt vmcnt(10) lgkmcnt(0)
    v_mfma_f32_16x16x32_bf16 v[56:59], v[212:215], v[24:27], v[56:59]
    buffer_load_dwordx4 v[208:211], v1, s[24:27], s56 offen offset:1024 sc1
    v_mfma_f32_16x16x32_bf16 v[60:63], v[212:215], v[28:31], v[60:63]
    ds_read_b128 v[40:43], v12 offset:32768
    ds_read_b128 v[44:47], v12 offset:33280
    v_mfma_f32_16x16x32_bf16 v[64:67], v[212:215], v[32:35], v[64:67]
    ds_read_b128 v[48:51], v13 offset:32768
    ds_read_b128 v[52:55], v13 offset:33280
    v_mfma_f32_16x16x32_bf16 v[68:71], v[212:215], v[36:39], v[68:71]
    s_waitcnt vmcnt(9)
    v_mfma_f32_16x16x32_bf16 v[72:75], v[216:219], v[24:27], v[72:75]
    buffer_load_dwordx4 v[212:215], v1, s[24:27], s56 offen offset:2048 sc1
    v_mfma_f32_16x16x32_bf16 v[76:79], v[216:219], v[28:31], v[76:79]
    v_mfma_f32_16x16x32_bf16 v[80:83], v[216:219], v[32:35], v[80:83]
    v_mfma_f32_16x16x32_bf16 v[84:87], v[216:219], v[36:39], v[84:87]
    s_waitcnt vmcnt(9)
    v_mfma_f32_16x16x32_bf16 v[88:91], v[220:223], v[24:27], v[88:91]
    buffer_load_dwordx4 v[216:219], v1, s[24:27], s56 offen offset:3072 sc1
    v_mfma_f32_16x16x32_bf16 v[92:95], v[220:223], v[28:31], v[92:95]
    v_mfma_f32_16x16x32_bf16 v[96:99], v[220:223], v[32:35], v[96:99]
    v_mfma_f32_16x16x32_bf16 v[100:103], v[220:223], v[36:39], v[100:103]
    s_waitcnt vmcnt(9) lgkmcnt(0)
    v_mfma_f32_16x16x32_bf16 v[56:59], v[224:227], v[40:43], v[56:59]
    buffer_load_dwordx4 v[220:223], v1, s[24:27], s56 offen offset:0 sc1
    v_mfma_f32_16x16x32_bf16 v[60:63], v[224:227], v[44:47], v[60:63]
    s_add_u32 s56, s56, 57344
    ds_read_b128 v[24:27], v10 offset:0
    v_mfma_f32_16x16x32_bf16 v[64:67], v[224:227], v[48:51], v[64:67]
    ds_read_b128 v[28:31], v10 offset:512
    ds_read_b128 v[32:35], v11 offset:0
    v_mfma_f32_16x16x32_bf16 v[68:71], v[224:227], v[52:55], v[68:71]
    ds_read_b128 v[36:39], v11 offset:512
    s_waitcnt vmcnt(9)
    v_mfma_f32_16x16x32_bf16 v[72:75], v[228:231], v[40:43], v[72:75]
    buffer_load_dwordx4 v[224:227], v1, s[24:27], s56 offen offset:1024 sc1
    v_mfma_f32_16x16x32_bf16 v[76:79], v[228:231], v[44:47], v[76:79]
    s_barrier
    v_mfma_f32_16x16x32_bf16 v[80:83], v[228:231], v[48:51], v[80:83]
    v_mfma_f32_16x16x32_bf16 v[84:87], v[228:231], v[52:55], v[84:87]
    s_waitcnt vmcnt(9)
    v_mfma_f32_16x16x32_bf16 v[88:91], v[232:235], v[40:43], v[88:91]
    buffer_load_dwordx4 v[228:231], v1, s[24:27], s56 offen offset:2048 sc1
    v_mfma_f32_16x16x32_bf16 v[92:95], v[232:235], v[44:47], v[92:95]
    v_mfma_f32_16x16x32_bf16 v[96:99], v[232:235], v[48:51], v[96:99]
    v_mfma_f32_16x16x32_bf16 v[100:103], v[232:235], v[52:55], v[100:103]
    s_waitcnt vmcnt(9)
    v_mfma_f32_16x16x32_bf16 v[104:107], v[236:239], v[40:43], v[104:107]
    buffer_load_dwordx4 v[232:235], v1, s[24:27], s56 offen offset:3072 sc1
    v_mfma_f32_16x16x32_bf16 v[108:111], v[236:239], v[44:47], v[108:111]
    s_add_u32 s56, s56, 57344
    v_mfma_f32_16x16x32_bf16 v[112:115], v[236:239], v[48:51], v[112:115]
    v_mfma_f32_16x16x32_bf16 v[116:119], v[236:239], v[52:55], v[116:119]
    s_waitcnt vmcnt(9) lgkmcnt(0)
    v_mfma_f32_16x16x32_bf16 v[56:59], v[20:23], v[24:27], v[56:59]
    buffer_load_dwordx4 v[236:239], v1, s[24:27], s56 offen offset:1024 sc1
    v_mfma_f32_16x16x32_bf16 v[60:63], v[20:23], v[28:31], v[60:63]
    ds_read_b128 v[40:43], v12 offset:0
    ds_read_b128 v[44:47], v12 offset:512
    v_mfma_f32_16x16x32_bf16 v[64:67], v[20:23], v[32:35], v[64:67]
    ds_read_b128 v[48:51], v13 offset:0
    ds_read_b128 v[52:55], v13 offset:512
    v_mfma_f32_16x16x32_bf16 v[68:71], v[20:23], v[36:39], v[68:71]
    s_waitcnt vmcnt(9)
    v_mfma_f32_16x16x32_bf16 v[72:75], v[120:123], v[24:27], v[72:75]
    buffer_load_dwordx4 v[20:23], v1, s[24:27], s56 offen offset:2048 sc1
    v_mfma_f32_16x16x32_bf16 v[76:79], v[120:123], v[28:31], v[76:79]
    v_mfma_f32_16x16x32_bf16 v[80:83], v[120:123], v[32:35], v[80:83]
    v_mfma_f32_16x16x32_bf16 v[84:87], v[120:123], v[36:39], v[84:87]
    s_waitcnt vmcnt(9)
    v_mfma_f32_16x16x32_bf16 v[88:91], v[124:127], v[24:27], v[88:91]
    buffer_load_dwordx4 v[120:123], v1, s[24:27], s56 offen offset:3072 sc1
    v_mfma_f32_16x16x32_bf16 v[92:95], v[124:127], v[28:31], v[92:95]
    v_mfma_f32_16x16x32_bf16 v[96:99], v[124:127], v[32:35], v[96:99]
    v_mfma_f32_16x16x32_bf16 v[100:103], v[124:127], v[36:39], v[100:103]
    s_waitcnt vmcnt(9) lgkmcnt(0)
    v_mfma_f32_16x16x32_bf16 v[56:59], v[208:211], v[40:43], v[56:59]
    buffer_load_dwordx4 v[124:127], v1, s[24:27], s56 offen offset:0 sc1
    v_mfma_f32_16x16x32_bf16 v[60:63], v[208:211], v[44:47], v[60:63]
    ds_read_b128 v[24:27], v10 offset:8192
    ds_read_b128 v[28:31], v10 offset:8704
    v_mfma_f32_16x16x32_bf16 v[64:67], v[208:211], v[48:51], v[64:67]
    ds_read_b128 v[32:35], v11 offset:8192
    ds_read_b128 v[36:39], v11 offset:8704
    v_mfma_f32_16x16x32_bf16 v[68:71], v[208:211], v[52:55], v[68:71]
    s_waitcnt vmcnt(9)
    v_mfma_f32_16x16x32_bf16 v[72:75], v[212:215], v[40:43], v[72:75]
    v_add_u32 v19, s98, v1
    buffer_load_dwordx4 v[128:131], v19, s[24:27], s45 offen offset:0 sc1
    v_mfma_f32_16x16x32_bf16 v[76:79], v[212:215], v[44:47], v[76:79]
    s_barrier
    v_mfma_f32_16x16x32_bf16 v[80:83], v[212:215], v[48:51], v[80:83]
    buffer_load_dwordx4 v[132:135], v19, s[24:27], s46 offen offset:0 sc1
    v_mfma_f32_16x16x32_bf16 v[84:87], v[212:215], v[52:55], v[84:87]
    s_waitcnt vmcnt(10)
    v_mfma_f32_16x16x32_bf16 v[88:91], v[216:219], v[40:43], v[88:91]
    buffer_load_dwordx4 v[136:139], v19, s[24:27], s47 offen offset:0 sc1
    v_mfma_f32_16x16x32_bf16 v[92:95], v[216:219], v[44:47], v[92:95]
    buffer_load_dwordx4 v[140:143], v19, s[24:27], s50 offen offset:0 sc1
    v_mfma_f32_16x16x32_bf16 v[96:99], v[216:219], v[48:51], v[96:99]
    v_add_u32 v19, s99, v1
    buffer_load_dwordx4 v[144:147], v19, s[24:27], s45 offen offset:0 sc1
    v_mfma_f32_16x16x32_bf16 v[100:103], v[216:219], v[52:55], v[100:103]
    s_waitcnt vmcnt(12)
    v_mfma_f32_16x16x32_bf16 v[104:107], v[220:223], v[40:43], v[104:107]
    buffer_load_dwordx4 v[148:151], v19, s[24:27], s46 offen offset:0 sc1
    v_mfma_f32_16x16x32_bf16 v[108:111], v[220:223], v[44:47], v[108:111]
    buffer_load_dwordx4 v[152:155], v19, s[24:27], s47 offen offset:0 sc1
    v_mfma_f32_16x16x32_bf16 v[112:115], v[220:223], v[48:51], v[112:115]
    buffer_load_dwordx4 v[156:159], v19, s[24:27], s50 offen offset:0 sc1
    v_mfma_f32_16x16x32_bf16 v[116:119], v[220:223], v[52:55], v[116:119]
    s_waitcnt vmcnt(14) lgkmcnt(0)
    v_mfma_f32_16x16x32_bf16 v[56:59], v[224:227], v[24:27], v[56:59]
    ds_read_b128 v[40:43], v12 offset:8192
    ds_read_b128 v[44:47], v12 offset:8704
    v_mfma_f32_16x16x32_bf16 v[60:63], v[224:227], v[28:31], v[60:63]
    ds_read_b128 v[48:51], v13 offset:8192
    ds_read_b128 v[52:55], v13 offset:8704
    v_mfma_f32_16x16x32_bf16 v[64:67], v[224:227], v[32:35], v[64:67]
    v_add_u32 v19, s100, v1
    buffer_load_dwordx4 v[160:163], v19, s[24:27], s45 offen offset:0 sc1
    v_mfma_f32_16x16x32_bf16 v[68:71], v[224:227], v[36:39], v[68:71]
    s_waitcnt vmcnt(14)
    v_mfma_f32_16x16x32_bf16 v[72:75], v[228:231], v[24:27], v[72:75]
    buffer_load_dwordx4 v[164:167], v19, s[24:27], s46 offen offset:0 sc1
    v_mfma_f32_16x16x32_bf16 v[76:79], v[228:231], v[28:31], v[76:79]
    v_mfma_f32_16x16x32_bf16 v[80:83], v[228:231], v[32:35], v[80:83]
    v_mfma_f32_16x16x32_bf16 v[84:87], v[228:231], v[36:39], v[84:87]
    s_waitcnt vmcnt(14)
    v_mfma_f32_16x16x32_bf16 v[88:91], v[232:235], v[24:27], v[88:91]
    v_mfma_f32_16x16x32_bf16 v[92:95], v[232:235], v[28:31], v[92:95]
    v_mfma_f32_16x16x32_bf16 v[96:99], v[232:235], v[32:35], v[96:99]
    v_mfma_f32_16x16x32_bf16 v[100:103], v[232:235], v[36:39], v[100:103]
    s_waitcnt vmcnt(13) lgkmcnt(0)
    v_mfma_f32_16x16x32_bf16 v[64:67], v[236:239], v[48:51], v[64:67]
    buffer_load_dwordx2 v[252:253], v18, s[24:27], s60 offen sc1
    v_mfma_f32_16x16x32_bf16 v[68:71], v[236:239], v[52:55], v[68:71]
    s_waitcnt vmcnt(13)
    v_mfma_f32_16x16x32_bf16 v[80:83], v[20:23], v[48:51], v[80:83]
    v_mfma_f32_16x16x32_bf16 v[84:87], v[20:23], v[52:55], v[84:87]
    s_waitcnt vmcnt(12)
    v_mfma_f32_16x16x32_bf16 v[96:99], v[120:123], v[48:51], v[96:99]
    v_mfma_f32_16x16x32_bf16 v[100:103], v[120:123], v[52:55], v[100:103]
    s_waitcnt vmcnt(11)
    v_mfma_f32_16x16x32_bf16 v[112:115], v[124:127], v[48:51], v[112:115]
    v_mfma_f32_16x16x32_bf16 v[116:119], v[124:127], v[52:55], v[116:119]
    v_mfma_f32_16x16x32_bf16 v[104:107], v[124:127], v[40:43], v[104:107]
    v_mfma_f32_16x16x32_bf16 v[108:111], v[124:127], v[44:47], v[108:111]
    v_mfma_f32_16x16x32_bf16 v[88:91], v[120:123], v[40:43], v[88:91]
    v_mfma_f32_16x16x32_bf16 v[92:95], v[120:123], v[44:47], v[92:95]
    v_mfma_f32_16x16x32_bf16 v[72:75], v[20:23], v[40:43], v[72:75]
    v_mfma_f32_16x16x32_bf16 v[76:79], v[20:23], v[44:47], v[76:79]
    v_mfma_f32_16x16x32_bf16 v[56:59], v[236:239], v[40:43], v[56:59]
    v_mfma_f32_16x16x32_bf16 v[60:63], v[236:239], v[44:47], v[60:63]
    ds_write_b128 v14, v[64:67] offset:0
    buffer_load_dwordx4 v[168:171], v19, s[24:27], s47 offen offset:0 sc1
    ds_write_b128 v14, v[68:71] offset:1024
    buffer_load_dwordx4 v[172:175], v19, s[24:27], s50 offen offset:0 sc1
    ds_write_b128 v14, v[80:83] offset:2048
    v_add_u32 v19, s98, v1
    buffer_load_dwordx4 v[176:179], v19, s[24:27], s45 offen offset:3072 sc1
    ds_write_b128 v14, v[84:87] offset:3072
    buffer_load_dwordx4 v[180:183], v19, s[24:27], s46 offen offset:3072 sc1
    ds_write_b128 v14, v[96:99] offset:4096
    buffer_load_dwordx4 v[184:187], v19, s[24:27], s47 offen offset:3072 sc1
    ds_write_b128 v14, v[100:103] offset:5120
    buffer_load_dwordx4 v[188:191], v19, s[24:27], s50 offen offset:3072 sc1
    ds_write_b128 v14, v[112:115] offset:6144
    v_add_u32 v19, s99, v1
    buffer_load_dwordx4 v[192:195], v19, s[24:27], s45 offen offset:3072 sc1
    ds_write_b128 v14, v[116:119] offset:7168
    buffer_load_dwordx4 v[196:199], v19, s[24:27], s46 offen offset:3072 sc1
    ds_write_b128 v14, v[104:107] offset:8192
    ds_write_b128 v14, v[108:111] offset:9216
    s_waitcnt lgkmcnt(0)
    s_barrier
    ds_read_b128 v[64:67], v15 offset:0
    ds_read_b128 v[80:83], v15 offset:2048
    ds_read_b128 v[96:99], v15 offset:4096
    ds_read_b128 v[68:71], v15 offset:1024
    ds_read_b128 v[84:87], v15 offset:3072
    ds_read_b128 v[100:103], v15 offset:5120
    s_waitcnt lgkmcnt(4)
    v_pk_add_f32 v[56:57], v[56:57], v[64:65] op_sel:[0,0] op_sel_hi:[1,1]
    v_pk_add_f32 v[58:59], v[58:59], v[66:67] op_sel:[0,0] op_sel_hi:[1,1]
    v_pk_add_f32 v[72:73], v[72:73], v[80:81] op_sel:[0,0] op_sel_hi:[1,1]
    v_pk_add_f32 v[74:75], v[74:75], v[82:83] op_sel:[0,0] op_sel_hi:[1,1]
    v_lshlrev_b32 v64, 16, v240
    v_and_b32 v65, 0xffff0000, v240
    v_lshlrev_b32 v66, 16, v241
    v_and_b32 v67, 0xffff0000, v241
    v_lshlrev_b32 v80, 16, v244
    v_and_b32 v81, 0xffff0000, v244
    v_lshlrev_b32 v82, 16, v245
    v_and_b32 v83, 0xffff0000, v245
    v_pk_mul_f32 v[56:57], v[56:57], v[64:65] op_sel:[0,0] op_sel_hi:[1,1]
    v_pk_mul_f32 v[58:59], v[58:59], v[66:67] op_sel:[0,0] op_sel_hi:[1,1]
    v_pk_mul_f32 v[72:73], v[72:73], v[80:81] op_sel:[0,0] op_sel_hi:[1,1]
    v_pk_mul_f32 v[74:75], v[74:75], v[82:83] op_sel:[0,0] op_sel_hi:[1,1]
    v_cvt_pk_bf16_f32 v24, v56, v57
    v_cvt_pk_bf16_f32 v25, v58, v59
    v_cvt_pk_bf16_f32 v26, v72, v73
    v_cvt_pk_bf16_f32 v27, v74, v75
    v_min_u32 v24, -2, v24
    v_min_u32 v25, -2, v25
    v_min_u32 v26, -2, v26
    v_min_u32 v27, -2, v27
    buffer_store_dwordx4 v[24:27], v1, s[24:27], s21 offen offset:2048 sc1
    s_waitcnt lgkmcnt(3)
    v_pk_add_f32 v[88:89], v[88:89], v[96:97] op_sel:[0,0] op_sel_hi:[1,1]
    v_pk_add_f32 v[90:91], v[90:91], v[98:99] op_sel:[0,0] op_sel_hi:[1,1]
    v_lshlrev_b32 v96, 16, v248
    v_and_b32 v97, 0xffff0000, v248
    v_lshlrev_b32 v98, 16, v249
    v_and_b32 v99, 0xffff0000, v249
    v_pk_mul_f32 v[88:89], v[88:89], v[96:97] op_sel:[0,0] op_sel_hi:[1,1]
    v_pk_mul_f32 v[90:91], v[90:91], v[98:99] op_sel:[0,0] op_sel_hi:[1,1]
    v_cvt_pk_bf16_f32 v28, v88, v89
    v_cvt_pk_bf16_f32 v29, v90, v91
    v_min_u32 v28, -2, v28
    v_min_u32 v29, -2, v29
    s_waitcnt lgkmcnt(1)
    v_pk_add_f32 v[60:61], v[60:61], v[68:69] op_sel:[0,0] op_sel_hi:[1,1]
    v_pk_add_f32 v[62:63], v[62:63], v[70:71] op_sel:[0,0] op_sel_hi:[1,1]
    v_pk_add_f32 v[76:77], v[76:77], v[84:85] op_sel:[0,0] op_sel_hi:[1,1]
    v_pk_add_f32 v[78:79], v[78:79], v[86:87] op_sel:[0,0] op_sel_hi:[1,1]
    v_lshlrev_b32 v68, 16, v242
    v_and_b32 v69, 0xffff0000, v242
    v_lshlrev_b32 v70, 16, v243
    v_and_b32 v71, 0xffff0000, v243
    v_lshlrev_b32 v84, 16, v246
    v_and_b32 v85, 0xffff0000, v246
    v_lshlrev_b32 v86, 16, v247
    v_and_b32 v87, 0xffff0000, v247
    v_pk_mul_f32 v[60:61], v[60:61], v[68:69] op_sel:[0,0] op_sel_hi:[1,1]
    v_pk_mul_f32 v[62:63], v[62:63], v[70:71] op_sel:[0,0] op_sel_hi:[1,1]
    v_pk_mul_f32 v[76:77], v[76:77], v[84:85] op_sel:[0,0] op_sel_hi:[1,1]
    v_pk_mul_f32 v[78:79], v[78:79], v[86:87] op_sel:[0,0] op_sel_hi:[1,1]
    v_cvt_pk_bf16_f32 v32, v60, v61
    v_cvt_pk_bf16_f32 v33, v62, v63
    v_cvt_pk_bf16_f32 v34, v76, v77
    v_cvt_pk_bf16_f32 v35, v78, v79
    v_min_u32 v32, -2, v32
    v_min_u32 v33, -2, v33
    v_min_u32 v34, -2, v34
    v_min_u32 v35, -2, v35
    buffer_store_dwordx4 v[32:35], v1, s[24:27], s22 offen offset:2048 sc1
    s_waitcnt lgkmcnt(0)
    v_pk_add_f32 v[92:93], v[92:93], v[100:101] op_sel:[0,0] op_sel_hi:[1,1]
    v_pk_add_f32 v[94:95], v[94:95], v[102:103] op_sel:[0,0] op_sel_hi:[1,1]
    v_lshlrev_b32 v100, 16, v250
    v_and_b32 v101, 0xffff0000, v250
    v_lshlrev_b32 v102, 16, v251
    v_and_b32 v103, 0xffff0000, v251
    v_pk_mul_f32 v[92:93], v[92:93], v[100:101] op_sel:[0,0] op_sel_hi:[1,1]
    v_pk_mul_f32 v[94:95], v[94:95], v[102:103] op_sel:[0,0] op_sel_hi:[1,1]
    v_cvt_pk_bf16_f32 v30, v92, v93
    v_cvt_pk_bf16_f32 v31, v94, v95
    v_min_u32 v30, -2, v30
    v_min_u32 v31, -2, v31
    s_bitcmp1_b32 s40, 0
    s_cbranch_scc0 L_nsh
    v_swap_b32 v28, v30
    v_swap_b32 v29, v31
L_nsh:
    buffer_store_dwordx4 v[28:31], v1, s[24:27], s20 offen sc1
    s_waitcnt vmcnt(11)
    s_barrier
    s_cmp_eq_u32 s40, 7
    s_cbranch_scc1 L_m_tail
    v_cmp_ne_u64 s[62:63], v[252:253], s[36:37]
    s_nop 0
    s_cmp_eq_u64 s[62:63], 0
    s_cbranch_scc1 L_fs_1_ok
    s_mov_b32 s61, 16384
L_fs_1:
    buffer_load_dwordx2 v[252:253], v18, s[24:27], s60 offen sc1
    s_waitcnt vmcnt(0)
    v_cmp_ne_u64 s[62:63], v[252:253], s[36:37]
    s_nop 0
    s_cmp_eq_u64 s[62:63], 0
    s_cbranch_scc1 L_fs_1_ok
    s_sleep 2
    s_sub_u32 s61, s61, 1
    s_cbranch_scc0 L_fs_1
L_fs_1_ok:
    s_add_u32 s3, s52, 130048
    buffer_load_dwordx4 v17, s[24:27], s52 offen sc1 lds
    buffer_load_dwordx4 v17, s[24:27], s3 offen offset:1024 sc1 lds
    s_lshl_b32 s52, s43, 7
    buffer_load_dwordx4 v[200:203], v19, s[24:27], s47 offen offset:3072 sc1
    buffer_load_dwordx4 v[204:207], v19, s[24:27], s50 offen offset:3072 sc1
    v_add_u32 v19, s100, v1
    buffer_load_dwordx4 v[208:211], v19, s[24:27], s45 offen offset:3072 sc1
    buffer_load_dwordx4 v[212:215], v19, s[24:27], s46 offen offset:3072 sc1
    buffer_load_dwordx4 v[216:219], v19, s[24:27], s47 offen offset:3072 sc1
    buffer_load_dwordx4 v[220:223], v19, s[24:27], s50 offen offset:3072 sc1
    v_add_u32 v19, 3072, v1
    buffer_load_dwordx4 v[224:227], v19, s[24:27], s45 offen offset:3072 sc1
    buffer_load_dwordx4 v[228:231], v19, s[24:27], s46 offen offset:3072 sc1
    buffer_load_dwordx4 v[232:235], v19, s[24:27], s47 offen offset:3072 sc1
    buffer_load_dwordx4 v[236:239], v19, s[24:27], s50 offen offset:3072 sc1
    buffer_load_dwordx2 v[8:9], v16, s[24:27], s49 offen sc1
    s_mul_i32 s44, s39, 114688
    s_mul_i32 s53, s38, 7168
    s_add_u32 s44, s44, s53
    s_add_u32 s44, s44, 0xd00000
    s_xor_b32 s56, s38, 0
    s_mul_i32 s56, s56, 28672
    s_add_u32 s56, s56, s44
    s_xor_b32 s57, s38, 1
    s_mul_i32 s57, s57, 28672
    s_add_u32 s57, s57, s44
    s_xor_b32 s58, s38, 2
    s_mul_i32 s58, s58, 28672
    s_add_u32 s58, s58, s44
    s_xor_b32 s59, s38, 3
    s_mul_i32 s59, s59, 28672
    s_add_u32 s59, s59, s44
    s_lshl_b32 s61, s39, 6
    s_lshl_b32 s3, s41, 2
    s_add_u32 s61, s61, s3
    s_add_u32 s61, s61, 32
    v_and_b32 v11, 12, v2
    v_add3_u32 v11, s61, v2, v11
    v_mul_u32_u24 v11, 896, v11
    v_lshl_add_u32 v11, v3, 4, v11
    v_lshlrev_b32 v12, 8, v3
    v_lshl_add_u32 v12, v2, 3, v12
    v_add_u32 v12, s55, v12
    s_add_u32 s3, s48, 12288
    v_add_u32 v10, s3, v1
    s_waitcnt vmcnt(0)
L_k3:
    s_mov_b32 s61, 16384
L_fh:
    v_cmp_ne_u64 s[62:63], v[8:9], s[36:37]
    s_nop 0
    s_and_b32 s62, s62, s51
    s_cbranch_scc0 L_k3AB
L_fh1:
    buffer_load_dwordx2 v[8:9], v16, s[24:27], s49 offen sc1
    s_sub_u32 s61, s61, 1
    s_waitcnt vmcnt(0)
    s_cbranch_scc0 L_fh
L_k3AB:
    v_add_u32 v19, s98, v1
    buffer_load_dwordx4 v[24:27], v19, s[24:27], s56 offen offset:0 sc1
    buffer_load_dwordx4 v[28:31], v19, s[24:27], s57 offen offset:0 sc1
    buffer_load_dwordx4 v[32:35], v19, s[24:27], s58 offen offset:0 sc1
    buffer_load_dwordx4 v[36:39], v19, s[24:27], s59 offen offset:0 sc1
    v_add_u32 v19, s99, v1
    buffer_load_dwordx4 v[40:43], v19, s[24:27], s56 offen offset:0 sc1
    buffer_load_dwordx4 v[44:47], v19, s[24:27], s57 offen offset:0 sc1
    buffer_load_dwordx4 v[48:51], v19, s[24:27], s58 offen offset:0 sc1
    buffer_load_dwordx4 v[52:55], v19, s[24:27], s59 offen offset:0 sc1
    v_add_u32 v19, s100, v1
    buffer_load_dwordx4 v[240:243], v19, s[24:27], s56 offen offset:0 sc1
    buffer_load_dwordx4 v[244:247], v19, s[24:27], s57 offen offset:0 sc1
    buffer_load_dwordx4 v[248:251], v19, s[24:27], s58 offen offset:0 sc1
    buffer_load_dwordx4 v[4:7], v19, s[24:27], s59 offen offset:0 sc1
    v_add_u32 v19, s98, v1
    buffer_load_dwordx4 v[120:123], v19, s[24:27], s56 offen offset:3072 sc1
    buffer_load_dwordx4 v[124:127], v19, s[24:27], s57 offen offset:3072 sc1
    buffer_load_dwordx4 v[20:23], v19, s[24:27], s58 offen offset:3072 sc1
    buffer_load_dwordx4 v[14:17], v19, s[24:27], s59 offen offset:3072 sc1
    s_waitcnt vmcnt(15)
    v_mfma_f32_16x16x32_bf16 v[56:59], v[128:131], v[24:27], 0
    v_max3_u32 v13, v24, v25, 0
    v_mfma_f32_16x16x32_bf16 v[60:63], v[132:135], v[24:27], 0
    v_mfma_f32_16x16x32_bf16 v[64:67], v[136:139], v[24:27], 0
    v_max3_u32 v13, v26, v27, v13
    v_mfma_f32_16x16x32_bf16 v[68:71], v[140:143], v[24:27], 0
    v_add_u32 v19, s99, v1
    buffer_load_dwordx4 v[24:27], v19, s[24:27], s56 offen offset:3072 sc1
    s_waitcnt vmcnt(15)
    v_mfma_f32_16x16x32_bf16 v[72:75], v[128:131], v[28:31], 0
    v_max3_u32 v13, v28, v29, v13
    v_mfma_f32_16x16x32_bf16 v[76:79], v[132:135], v[28:31], 0
    v_mfma_f32_16x16x32_bf16 v[80:83], v[136:139], v[28:31], 0
    v_max3_u32 v13, v30, v31, v13
    v_mfma_f32_16x16x32_bf16 v[84:87], v[140:143], v[28:31], 0
    buffer_load_dwordx4 v[28:31], v19, s[24:27], s57 offen offset:3072 sc1
    s_waitcnt vmcnt(15)
    v_mfma_f32_16x16x32_bf16 v[88:91], v[128:131], v[32:35], 0
    v_max3_u32 v13, v32, v33, v13
    v_mfma_f32_16x16x32_bf16 v[92:95], v[132:135], v[32:35], 0
    v_mfma_f32_16x16x32_bf16 v[96:99], v[136:139], v[32:35], 0
    v_max3_u32 v13, v34, v35, v13
    v_mfma_f32_16x16x32_bf16 v[100:103], v[140:143], v[32:35], 0
    buffer_load_dwordx4 v[32:35], v19, s[24:27], s58 offen offset:3072 sc1
    s_waitcnt vmcnt(15)
    v_mfma_f32_16x16x32_bf16 v[104:107], v[128:131], v[36:39], 0
    v_max3_u32 v13, v36, v37, v13
    v_mfma_f32_16x16x32_bf16 v[108:111], v[132:135], v[36:39], 0
    v_mfma_f32_16x16x32_bf16 v[112:115], v[136:139], v[36:39], 0
    v_max3_u32 v13, v38, v39, v13
    v_mfma_f32_16x16x32_bf16 v[116:119], v[140:143], v[36:39], 0
    buffer_load_dwordx4 v[36:39], v19, s[24:27], s59 offen offset:3072 sc1
    v_add_u32 v19, s100, v1
    buffer_load_dwordx4 v[128:131], v19, s[24:27], s56 offen offset:3072 sc1
    buffer_load_dwordx4 v[132:135], v19, s[24:27], s57 offen offset:3072 sc1
    buffer_load_dwordx4 v[136:139], v19, s[24:27], s58 offen offset:3072 sc1
    buffer_load_dwordx4 v[140:143], v19, s[24:27], s59 offen offset:3072 sc1
    s_waitcnt vmcnt(19)
    v_mfma_f32_16x16x32_bf16 v[56:59], v[144:147], v[40:43], v[56:59]
    v_max3_u32 v13, v40, v41, v13
    v_mfma_f32_16x16x32_bf16 v[60:63], v[148:151], v[40:43], v[60:63]
    v_mfma_f32_16x16x32_bf16 v[64:67], v[152:155], v[40:43], v[64:67]
    v_max3_u32 v13, v42, v43, v13
    v_mfma_f32_16x16x32_bf16 v[68:71], v[156:159], v[40:43], v[68:71]
    v_add_u32 v19, 3072, v1
    buffer_load_dwordx4 v[40:43], v19, s[24:27], s56 offen offset:3072 sc1
    s_waitcnt vmcnt(19)
    v_mfma_f32_16x16x32_bf16 v[72:75], v[144:147], v[44:47], v[72:75]
    v_max3_u32 v13, v44, v45, v13
    v_mfma_f32_16x16x32_bf16 v[76:79], v[148:151], v[44:47], v[76:79]
    v_mfma_f32_16x16x32_bf16 v[80:83], v[152:155], v[44:47], v[80:83]
    v_max3_u32 v13, v46, v47, v13
    v_mfma_f32_16x16x32_bf16 v[84:87], v[156:159], v[44:47], v[84:87]
    buffer_load_dwordx4 v[44:47], v19, s[24:27], s57 offen offset:3072 sc1
    s_waitcnt vmcnt(19)
    v_mfma_f32_16x16x32_bf16 v[88:91], v[144:147], v[48:51], v[88:91]
    v_max3_u32 v13, v48, v49, v13
    v_mfma_f32_16x16x32_bf16 v[92:95], v[148:151], v[48:51], v[92:95]
    v_mfma_f32_16x16x32_bf16 v[96:99], v[152:155], v[48:51], v[96:99]
    v_max3_u32 v13, v50, v51, v13
    v_mfma_f32_16x16x32_bf16 v[100:103], v[156:159], v[48:51], v[100:103]
    buffer_load_dwordx4 v[48:51], v19, s[24:27], s58 offen offset:3072 sc1
    s_waitcnt vmcnt(19)
    v_mfma_f32_16x16x32_bf16 v[104:107], v[144:147], v[52:55], v[104:107]
    v_max3_u32 v13, v52, v53, v13
    v_mfma_f32_16x16x32_bf16 v[108:111], v[148:151], v[52:55], v[108:111]
    v_mfma_f32_16x16x32_bf16 v[112:115], v[152:155], v[52:55], v[112:115]
    v_max3_u32 v13, v54, v55, v13
    v_mfma_f32_16x16x32_bf16 v[116:119], v[156:159], v[52:55], v[116:119]
    buffer_load_dwordx4 v[52:55], v19, s[24:27], s59 offen offset:3072 sc1
    s_waitcnt vmcnt(19)
    v_mfma_f32_16x16x32_bf16 v[56:59], v[160:163], v[240:243], v[56:59]
    v_max3_u32 v13, v240, v241, v13
    v_mfma_f32_16x16x32_bf16 v[60:63], v[164:167], v[240:243], v[60:63]
    v_mfma_f32_16x16x32_bf16 v[64:67], v[168:171], v[240:243], v[64:67]
    v_max3_u32 v13, v242, v243, v13
    v_mfma_f32_16x16x32_bf16 v[68:71], v[172:175], v[240:243], v[68:71]
    s_waitcnt vmcnt(18)
    v_mfma_f32_16x16x32_bf16 v[72:75], v[160:163], v[244:247], v[72:75]
    v_max3_u32 v13, v244, v245, v13
    v_mfma_f32_16x16x32_bf16 v[76:79], v[164:167], v[244:247], v[76:79]
    v_mfma_f32_16x16x32_bf16 v[80:83], v[168:171], v[244:247], v[80:83]
    v_max3_u32 v13, v246, v247, v13
    v_mfma_f32_16x16x32_bf16 v[84:87], v[172:175], v[244:247], v[84:87]
    s_waitcnt vmcnt(17)
    v_mfma_f32_16x16x32_bf16 v[88:91], v[160:163], v[248:251], v[88:91]
    v_max3_u32 v13, v248, v249, v13
    v_mfma_f32_16x16x32_bf16 v[92:95], v[164:167], v[248:251], v[92:95]
    v_mfma_f32_16x16x32_bf16 v[96:99], v[168:171], v[248:251], v[96:99]
    v_max3_u32 v13, v250, v251, v13
    v_mfma_f32_16x16x32_bf16 v[100:103], v[172:175], v[248:251], v[100:103]
    s_waitcnt vmcnt(16)
    v_mfma_f32_16x16x32_bf16 v[104:107], v[160:163], v[4:7], v[104:107]
    v_max3_u32 v13, v4, v5, v13
    v_mfma_f32_16x16x32_bf16 v[108:111], v[164:167], v[4:7], v[108:111]
    v_mfma_f32_16x16x32_bf16 v[112:115], v[168:171], v[4:7], v[112:115]
    v_max3_u32 v13, v6, v7, v13
    v_mfma_f32_16x16x32_bf16 v[116:119], v[172:175], v[4:7], v[116:119]
    buffer_load_dwordx4 v[144:147], v11, s[16:19], s52 offen offset:0
    buffer_load_dwordx4 v[148:151], v11, s[16:19], s52 offen offset:64
    ds_read_b64_tr_b16 v[152:153], v12 offset:0
    ds_read_b64_tr_b16 v[154:155], v12 offset:128
    ds_read_b64_tr_b16 v[156:157], v12 offset:1024
    ds_read_b64_tr_b16 v[158:159], v12 offset:1152
    s_waitcnt vmcnt(17)
    v_mfma_f32_16x16x32_bf16 v[56:59], v[176:179], v[120:123], v[56:59]
    v_max3_u32 v13, v120, v121, v13
    v_mfma_f32_16x16x32_bf16 v[60:63], v[180:183], v[120:123], v[60:63]
    v_mfma_f32_16x16x32_bf16 v[64:67], v[184:187], v[120:123], v[64:67]
    v_max3_u32 v13, v122, v123, v13
    v_mfma_f32_16x16x32_bf16 v[68:71], v[188:191], v[120:123], v[68:71]
    s_waitcnt vmcnt(16)
    v_mfma_f32_16x16x32_bf16 v[72:75], v[176:179], v[124:127], v[72:75]
    v_max3_u32 v13, v124, v125, v13
    v_mfma_f32_16x16x32_bf16 v[76:79], v[180:183], v[124:127], v[76:79]
    v_mfma_f32_16x16x32_bf16 v[80:83], v[184:187], v[124:127], v[80:83]
    v_max3_u32 v13, v126, v127, v13
    v_mfma_f32_16x16x32_bf16 v[84:87], v[188:191], v[124:127], v[84:87]
    s_waitcnt vmcnt(15)
    v_mfma_f32_16x16x32_bf16 v[88:91], v[176:179], v[20:23], v[88:91]
    v_max3_u32 v13, v20, v21, v13
    v_mfma_f32_16x16x32_bf16 v[92:95], v[180:183], v[20:23], v[92:95]
    v_mfma_f32_16x16x32_bf16 v[96:99], v[184:187], v[20:23], v[96:99]
    v_max3_u32 v13, v22, v23, v13
    v_mfma_f32_16x16x32_bf16 v[100:103], v[188:191], v[20:23], v[100:103]
    s_waitcnt vmcnt(14)
    v_mfma_f32_16x16x32_bf16 v[104:107], v[176:179], v[14:17], v[104:107]
    v_max3_u32 v13, v14, v15, v13
    v_mfma_f32_16x16x32_bf16 v[108:111], v[180:183], v[14:17], v[108:111]
    v_mfma_f32_16x16x32_bf16 v[112:115], v[184:187], v[14:17], v[112:115]
    v_max3_u32 v13, v16, v17, v13
    v_mfma_f32_16x16x32_bf16 v[116:119], v[188:191], v[14:17], v[116:119]
    s_waitcnt vmcnt(13)
    v_mfma_f32_16x16x32_bf16 v[56:59], v[192:195], v[24:27], v[56:59]
    v_max3_u32 v13, v24, v25, v13
    s_waitcnt lgkmcnt(0)
    v_mfma_f32_16x16x32_bf16 v[60:63], v[196:199], v[24:27], v[60:63]
    v_lshlrev_b32 v240, 16, v152
    v_and_b32 v241, 0xffff0000, v152
    v_mfma_f32_16x16x32_bf16 v[64:67], v[200:203], v[24:27], v[64:67]
    v_max3_u32 v13, v26, v27, v13
    v_lshlrev_b32 v242, 16, v153
    v_mfma_f32_16x16x32_bf16 v[68:71], v[204:207], v[24:27], v[68:71]
    v_and_b32 v243, 0xffff0000, v153
    v_lshlrev_b32 v244, 16, v154
    s_waitcnt vmcnt(12)
    v_mfma_f32_16x16x32_bf16 v[72:75], v[192:195], v[28:31], v[72:75]
    v_max3_u32 v13, v28, v29, v13
    v_and_b32 v245, 0xffff0000, v154
    v_mfma_f32_16x16x32_bf16 v[76:79], v[196:199], v[28:31], v[76:79]
    v_lshlrev_b32 v246, 16, v155
    v_and_b32 v247, 0xffff0000, v155
    v_mfma_f32_16x16x32_bf16 v[80:83], v[200:203], v[28:31], v[80:83]
    v_max3_u32 v13, v30, v31, v13
    v_lshlrev_b32 v248, 16, v156
    v_mfma_f32_16x16x32_bf16 v[84:87], v[204:207], v[28:31], v[84:87]
    v_and_b32 v249, 0xffff0000, v156
    v_lshlrev_b32 v250, 16, v157
    s_waitcnt vmcnt(11)
    v_mfma_f32_16x16x32_bf16 v[88:91], v[192:195], v[32:35], v[88:91]
    v_max3_u32 v13, v32, v33, v13
    v_and_b32 v251, 0xffff0000, v157
    v_mfma_f32_16x16x32_bf16 v[92:95], v[196:199], v[32:35], v[92:95]
    v_lshlrev_b32 v4, 16, v158
    v_and_b32 v5, 0xffff0000, v158
    v_mfma_f32_16x16x32_bf16 v[96:99], v[200:203], v[32:35], v[96:99]
    v_max3_u32 v13, v34, v35, v13
    v_lshlrev_b32 v6, 16, v159
    v_mfma_f32_16x16x32_bf16 v[100:103], v[204:207], v[32:35], v[100:103]
    v_and_b32 v7, 0xffff0000, v159
    s_waitcnt vmcnt(10)
    v_mfma_f32_16x16x32_bf16 v[104:107], v[192:195], v[36:39], v[104:107]
    v_max3_u32 v13, v36, v37, v13
    v_mfma_f32_16x16x32_bf16 v[108:111], v[196:199], v[36:39], v[108:111]
    v_mfma_f32_16x16x32_bf16 v[112:115], v[200:203], v[36:39], v[112:115]
    v_max3_u32 v13, v38, v39, v13
    v_mfma_f32_16x16x32_bf16 v[116:119], v[204:207], v[36:39], v[116:119]
    s_waitcnt vmcnt(9)
    v_mfma_f32_16x16x32_bf16 v[56:59], v[208:211], v[128:131], v[56:59]
    v_max3_u32 v13, v128, v129, v13
    s_xor_b32 s50, s38, 1
    v_mfma_f32_16x16x32_bf16 v[60:63], v[212:215], v[128:131], v[60:63]
    s_and_b32 s53, s50, 1
    s_mul_i32 s53, s53, 40960
    v_mfma_f32_16x16x32_bf16 v[64:67], v[216:219], v[128:131], v[64:67]
    v_max3_u32 v13, v130, v131, v13
    s_lshr_b32 s50, s50, 1
    v_mfma_f32_16x16x32_bf16 v[68:71], v[220:223], v[128:131], v[68:71]
    s_mul_i32 s50, s50, 12288
    s_add_u32 s50, s50, s53
    s_waitcnt vmcnt(8)
    v_mfma_f32_16x16x32_bf16 v[72:75], v[208:211], v[132:135], v[72:75]
    v_max3_u32 v13, v132, v133, v13
    v_add_u32 v161, s50, v1
    v_mfma_f32_16x16x32_bf16 v[76:79], v[212:215], v[132:135], v[76:79]
    s_xor_b32 s50, s38, 2
    s_and_b32 s53, s50, 1
    v_mfma_f32_16x16x32_bf16 v[80:83], v[216:219], v[132:135], v[80:83]
    v_max3_u32 v13, v134, v135, v13
    s_mul_i32 s53, s53, 40960
    v_mfma_f32_16x16x32_bf16 v[84:87], v[220:223], v[132:135], v[84:87]
    s_lshr_b32 s50, s50, 1
    s_mul_i32 s50, s50, 12288
    s_waitcnt vmcnt(7)
    v_mfma_f32_16x16x32_bf16 v[88:91], v[208:211], v[136:139], v[88:91]
    v_max3_u32 v13, v136, v137, v13
    s_add_u32 s50, s50, s53
    v_mfma_f32_16x16x32_bf16 v[92:95], v[212:215], v[136:139], v[92:95]
    v_add_u32 v162, s50, v1
    s_xor_b32 s50, s38, 3
    v_mfma_f32_16x16x32_bf16 v[96:99], v[216:219], v[136:139], v[96:99]
    v_max3_u32 v13, v138, v139, v13
    s_and_b32 s53, s50, 1
    v_mfma_f32_16x16x32_bf16 v[100:103], v[220:223], v[136:139], v[100:103]
    s_mul_i32 s53, s53, 40960
    s_lshr_b32 s50, s50, 1
    s_waitcnt vmcnt(6)
    v_mfma_f32_16x16x32_bf16 v[104:107], v[208:211], v[140:143], v[104:107]
    v_max3_u32 v13, v140, v141, v13
    s_mul_i32 s50, s50, 12288
    v_mfma_f32_16x16x32_bf16 v[108:111], v[212:215], v[140:143], v[108:111]
    s_add_u32 s50, s50, s53
    v_add_u32 v163, s50, v1
    v_mfma_f32_16x16x32_bf16 v[112:115], v[216:219], v[140:143], v[112:115]
    v_max3_u32 v13, v142, v143, v13
    v_mfma_f32_16x16x32_bf16 v[116:119], v[220:223], v[140:143], v[116:119]
    s_waitcnt vmcnt(4)
    v_swap_b32 v42, v44
    v_swap_b32 v43, v45
    s_nop 1
    v_mfma_f32_16x16x32_bf16 v[72:75], v[224:227], v[44:47], v[72:75]
    v_max3_u32 v13, v44, v45, v13
    v_mfma_f32_16x16x32_bf16 v[76:79], v[228:231], v[44:47], v[76:79]
    v_mfma_f32_16x16x32_bf16 v[80:83], v[232:235], v[44:47], v[80:83]
    v_max3_u32 v13, v46, v47, v13
    v_mfma_f32_16x16x32_bf16 v[84:87], v[236:239], v[44:47], v[84:87]
    s_waitcnt vmcnt(2)
    v_swap_b32 v50, v52
    v_swap_b32 v51, v53
    s_nop 1
    v_mfma_f32_16x16x32_bf16 v[88:91], v[224:227], v[48:51], v[88:91]
    v_max3_u32 v13, v48, v49, v13
    v_mfma_f32_16x16x32_bf16 v[92:95], v[228:231], v[48:51], v[92:95]
    v_mfma_f32_16x16x32_bf16 v[96:99], v[232:235], v[48:51], v[96:99]
    v_max3_u32 v13, v50, v51, v13
    v_mfma_f32_16x16x32_bf16 v[100:103], v[236:239], v[48:51], v[100:103]
    ds_write_b128 v10, v[72:75] offset:0
    ds_write_b128 v10, v[76:79] offset:1024
    ds_write_b128 v10, v[80:83] offset:2048
    ds_write_b128 v10, v[84:87] offset:3072
    v_mfma_f32_16x16x32_bf16 v[104:107], v[224:227], v[52:55], v[104:107]
    v_max3_u32 v13, v52, v53, v13
    v_mfma_f32_16x16x32_bf16 v[108:111], v[228:231], v[52:55], v[108:111]
    v_mfma_f32_16x16x32_bf16 v[112:115], v[232:235], v[52:55], v[112:115]
    v_max3_u32 v13, v54, v55, v13
    v_mfma_f32_16x16x32_bf16 v[116:119], v[236:239], v[52:55], v[116:119]
    ds_write_b128 v10, v[88:91] offset:4096
    ds_write_b128 v10, v[92:95] offset:5120
    ds_write_b128 v10, v[96:99] offset:6144
    ds_write_b128 v10, v[100:103] offset:7168
    v_mfma_f32_16x16x32_bf16 v[56:59], v[224:227], v[40:43], v[56:59]
    v_max3_u32 v13, v40, v41, v13
    v_mfma_f32_16x16x32_bf16 v[60:63], v[228:231], v[40:43], v[60:63]
    v_mfma_f32_16x16x32_bf16 v[64:67], v[232:235], v[40:43], v[64:67]
    v_max3_u32 v13, v42, v43, v13
    v_mfma_f32_16x16x32_bf16 v[68:71], v[236:239], v[40:43], v[68:71]
    ds_write_b128 v10, v[104:107] offset:8192
    ds_write_b128 v10, v[108:111] offset:9216
    ds_write_b128 v10, v[112:115] offset:10240
    ds_write_b128 v10, v[116:119] offset:11264
    s_waitcnt vmcnt(0)
    v_cmp_eq_u32 vcc, -1, v13
    v_lshlrev_b32 v124, 16, v144
    v_and_b32 v125, 0xffff0000, v144
    v_lshlrev_b32 v126, 16, v145
    v_and_b32 v127, 0xffff0000, v145
    v_lshlrev_b32 v20, 16, v146
    v_and_b32 v21, 0xffff0000, v146
    s_cbranch_vccnz L_redo
L_k3ok:
    v_lshlrev_b32 v22, 16, v147
    v_and_b32 v23, 0xffff0000, v147
    v_lshlrev_b32 v14, 16, v148
    v_and_b32 v15, 0xffff0000, v148
    v_lshlrev_b32 v16, 16, v149
    v_and_b32 v17, 0xffff0000, v149
    v_lshlrev_b32 v176, 16, v150
    v_and_b32 v177, 0xffff0000, v150
    v_lshlrev_b32 v178, 16, v151
    v_and_b32 v179, 0xffff0000, v151
    s_waitcnt lgkmcnt(0)
    s_barrier
    ds_read_b128 v[72:75], v161 offset:0
    ds_read_b128 v[88:91], v162 offset:4096
    ds_read_b128 v[104:107], v163 offset:8192
    ds_read_b128 v[76:79], v161 offset:1024
    ds_read_b128 v[92:95], v162 offset:5120
    ds_read_b128 v[108:111], v163 offset:9216
    ds_read_b128 v[80:83], v161 offset:2048
    ds_read_b128 v[96:99], v162 offset:6144
    ds_read_b128 v[112:115], v163 offset:10240
    ds_read_b128 v[84:87], v161 offset:3072
    ds_read_b128 v[100:103], v162 offset:7168
    ds_read_b128 v[116:119], v163 offset:11264
    v_mov_b32 v8, 0xbfb8aa3b
    s_waitcnt lgkmcnt(6)
    v_pk_add_f32 v[56:57], v[56:57], v[72:73] op_sel:[0,0] op_sel_hi:[1,1]
    v_pk_add_f32 v[88:89], v[88:89], v[104:105] op_sel:[0,0] op_sel_hi:[1,1]
    v_pk_add_f32 v[58:59], v[58:59], v[74:75] op_sel:[0,0] op_sel_hi:[1,1]
    v_pk_add_f32 v[90:91], v[90:91], v[106:107] op_sel:[0,0] op_sel_hi:[1,1]
    v_pk_add_f32 v[60:61], v[60:61], v[76:77] op_sel:[0,0] op_sel_hi:[1,1]
    v_pk_add_f32 v[92:93], v[92:93], v[108:109] op_sel:[0,0] op_sel_hi:[1,1]
    v_pk_add_f32 v[62:63], v[62:63], v[78:79] op_sel:[0,0] op_sel_hi:[1,1]
    v_pk_add_f32 v[94:95], v[94:95], v[110:111] op_sel:[0,0] op_sel_hi:[1,1]
    v_pk_add_f32 v[56:57], v[56:57], v[88:89] op_sel:[0,0] op_sel_hi:[1,1]
    v_pk_add_f32 v[58:59], v[58:59], v[90:91] op_sel:[0,0] op_sel_hi:[1,1]
    v_pk_add_f32 v[60:61], v[60:61], v[92:93] op_sel:[0,0] op_sel_hi:[1,1]
    v_pk_add_f32 v[62:63], v[62:63], v[94:95] op_sel:[0,0] op_sel_hi:[1,1]
    v_cvt_pk_bf16_f32 v56, 0, v56
    v_cvt_pk_bf16_f32 v57, 0, v57
    v_cvt_pk_bf16_f32 v58, 0, v58
    v_cvt_pk_bf16_f32 v59, 0, v59
    v_cvt_pk_bf16_f32 v60, 0, v60
    v_cvt_pk_bf16_f32 v61, 0, v61
    v_cvt_pk_bf16_f32 v62, 0, v62
    v_cvt_pk_bf16_f32 v63, 0, v63
    v_pk_mul_f32 v[164:165], v[56:57], v[8:9] op_sel:[0,0] op_sel_hi:[1,0]
    v_pk_mul_f32 v[166:167], v[58:59], v[8:9] op_sel:[0,0] op_sel_hi:[1,0]
    v_pk_mul_f32 v[168:169], v[60:61], v[8:9] op_sel:[0,0] op_sel_hi:[1,0]
    v_pk_mul_f32 v[170:171], v[62:63], v[8:9] op_sel:[0,0] op_sel_hi:[1,0]
    v_exp_f32 v164, v164
    v_exp_f32 v165, v165
    v_exp_f32 v166, v166
    v_exp_f32 v167, v167
    v_exp_f32 v168, v168
    v_exp_f32 v169, v169
    v_exp_f32 v170, v170
    v_exp_f32 v171, v171
    v_pk_add_f32 v[164:165], v[164:165], 1.0 op_sel_hi:[1,0]
    v_pk_add_f32 v[166:167], v[166:167], 1.0 op_sel_hi:[1,0]
    v_pk_add_f32 v[168:169], v[168:169], 1.0 op_sel_hi:[1,0]
    v_pk_add_f32 v[170:171], v[170:171], 1.0 op_sel_hi:[1,0]
    v_rcp_f32 v164, v164
    v_rcp_f32 v165, v165
    v_rcp_f32 v166, v166
    v_rcp_f32 v167, v167
    v_rcp_f32 v168, v168
    v_rcp_f32 v169, v169
    v_rcp_f32 v170, v170
    v_rcp_f32 v171, v171
    v_pk_mul_f32 v[56:57], v[56:57], v[164:165] op_sel:[0,0] op_sel_hi:[1,1]
    v_pk_mul_f32 v[58:59], v[58:59], v[166:167] op_sel:[0,0] op_sel_hi:[1,1]
    v_pk_mul_f32 v[60:61], v[60:61], v[168:169] op_sel:[0,0] op_sel_hi:[1,1]
    v_pk_mul_f32 v[62:63], v[62:63], v[170:171] op_sel:[0,0] op_sel_hi:[1,1]
    v_cvt_pk_bf16_f32 v56, 0, v56
    v_cvt_pk_bf16_f32 v57, 0, v57
    v_cvt_pk_bf16_f32 v58, 0, v58
    v_cvt_pk_bf16_f32 v59, 0, v59
    v_cvt_pk_bf16_f32 v60, 0, v60
    v_cvt_pk_bf16_f32 v61, 0, v61
    v_cvt_pk_bf16_f32 v62, 0, v62
    v_cvt_pk_bf16_f32 v63, 0, v63
    v_pk_mul_f32 v[56:57], v[56:57], v[240:241] op_sel:[0,0] op_sel_hi:[1,1]
    v_pk_mul_f32 v[58:59], v[58:59], v[242:243] op_sel:[0,0] op_sel_hi:[1,1]
    v_pk_mul_f32 v[60:61], v[60:61], v[244:245] op_sel:[0,0] op_sel_hi:[1,1]
    v_pk_mul_f32 v[62:63], v[62:63], v[246:247] op_sel:[0,0] op_sel_hi:[1,1]
    v_cvt_pk_bf16_f32 v56, 0, v56
    v_cvt_pk_bf16_f32 v57, 0, v57
    v_cvt_pk_bf16_f32 v58, 0, v58
    v_cvt_pk_bf16_f32 v59, 0, v59
    v_cvt_pk_bf16_f32 v60, 0, v60
    v_cvt_pk_bf16_f32 v61, 0, v61
    v_cvt_pk_bf16_f32 v62, 0, v62
    v_cvt_pk_bf16_f32 v63, 0, v63
    v_pk_add_f32 v[56:57], v[56:57], v[124:125] op_sel:[0,0] op_sel_hi:[1,1]
    v_pk_add_f32 v[58:59], v[58:59], v[126:127] op_sel:[0,0] op_sel_hi:[1,1]
    v_pk_add_f32 v[60:61], v[60:61], v[20:21] op_sel:[0,0] op_sel_hi:[1,1]
    v_pk_add_f32 v[62:63], v[62:63], v[22:23] op_sel:[0,0] op_sel_hi:[1,1]
    v_cvt_pk_bf16_f32 v144, v56, v57
    v_cvt_pk_bf16_f32 v145, v58, v59
    v_cvt_pk_bf16_f32 v146, v60, v61
    v_cvt_pk_bf16_f32 v147, v62, v63
    buffer_store_dwordx4 v[144:147], v11, s[32:35], s52 offen offset:0 sc0 sc1
    s_waitcnt lgkmcnt(0)
    v_pk_add_f32 v[64:65], v[64:65], v[80:81] op_sel:[0,0] op_sel_hi:[1,1]
    v_pk_add_f32 v[96:97], v[96:97], v[112:113] op_sel:[0,0] op_sel_hi:[1,1]
    v_pk_add_f32 v[66:67], v[66:67], v[82:83] op_sel:[0,0] op_sel_hi:[1,1]
    v_pk_add_f32 v[98:99], v[98:99], v[114:115] op_sel:[0,0] op_sel_hi:[1,1]
    v_pk_add_f32 v[68:69], v[68:69], v[84:85] op_sel:[0,0] op_sel_hi:[1,1]
    v_pk_add_f32 v[100:101], v[100:101], v[116:117] op_sel:[0,0] op_sel_hi:[1,1]
    v_pk_add_f32 v[70:71], v[70:71], v[86:87] op_sel:[0,0] op_sel_hi:[1,1]
    v_pk_add_f32 v[102:103], v[102:103], v[118:119] op_sel:[0,0] op_sel_hi:[1,1]
    v_pk_add_f32 v[64:65], v[64:65], v[96:97] op_sel:[0,0] op_sel_hi:[1,1]
    v_pk_add_f32 v[66:67], v[66:67], v[98:99] op_sel:[0,0] op_sel_hi:[1,1]
    v_pk_add_f32 v[68:69], v[68:69], v[100:101] op_sel:[0,0] op_sel_hi:[1,1]
    v_pk_add_f32 v[70:71], v[70:71], v[102:103] op_sel:[0,0] op_sel_hi:[1,1]
    v_cvt_pk_bf16_f32 v64, 0, v64
    v_cvt_pk_bf16_f32 v65, 0, v65
    v_cvt_pk_bf16_f32 v66, 0, v66
    v_cvt_pk_bf16_f32 v67, 0, v67
    v_cvt_pk_bf16_f32 v68, 0, v68
    v_cvt_pk_bf16_f32 v69, 0, v69
    v_cvt_pk_bf16_f32 v70, 0, v70
    v_cvt_pk_bf16_f32 v71, 0, v71
    v_pk_mul_f32 v[172:173], v[64:65], v[8:9] op_sel:[0,0] op_sel_hi:[1,0]
    v_pk_mul_f32 v[174:175], v[66:67], v[8:9] op_sel:[0,0] op_sel_hi:[1,0]
    v_pk_mul_f32 v[120:121], v[68:69], v[8:9] op_sel:[0,0] op_sel_hi:[1,0]
    v_pk_mul_f32 v[122:123], v[70:71], v[8:9] op_sel:[0,0] op_sel_hi:[1,0]
    v_exp_f32 v172, v172
    v_exp_f32 v173, v173
    v_exp_f32 v174, v174
    v_exp_f32 v175, v175
    v_exp_f32 v120, v120
    v_exp_f32 v121, v121
    v_exp_f32 v122, v122
    v_exp_f32 v123, v123
    v_pk_add_f32 v[172:173], v[172:173], 1.0 op_sel_hi:[1,0]
    v_pk_add_f32 v[174:175], v[174:175], 1.0 op_sel_hi:[1,0]
    v_pk_add_f32 v[120:121], v[120:121], 1.0 op_sel_hi:[1,0]
    v_pk_add_f32 v[122:123], v[122:123], 1.0 op_sel_hi:[1,0]
    v_rcp_f32 v172, v172
    v_rcp_f32 v173, v173
    v_rcp_f32 v174, v174
    v_rcp_f32 v175, v175
    v_rcp_f32 v120, v120
    v_rcp_f32 v121, v121
    v_rcp_f32 v122, v122
    v_rcp_f32 v123, v123
    v_pk_mul_f32 v[64:65], v[64:65], v[172:173] op_sel:[0,0] op_sel_hi:[1,1]
    v_pk_mul_f32 v[66:67], v[66:67], v[174:175] op_sel:[0,0] op_sel_hi:[1,1]
    v_pk_mul_f32 v[68:69], v[68:69], v[120:121] op_sel:[0,0] op_sel_hi:[1,1]
    v_pk_mul_f32 v[70:71], v[70:71], v[122:123] op_sel:[0,0] op_sel_hi:[1,1]
    v_cvt_pk_bf16_f32 v64, 0, v64
    v_cvt_pk_bf16_f32 v65, 0, v65
    v_cvt_pk_bf16_f32 v66, 0, v66
    v_cvt_pk_bf16_f32 v67, 0, v67
    v_cvt_pk_bf16_f32 v68, 0, v68
    v_cvt_pk_bf16_f32 v69, 0, v69
    v_cvt_pk_bf16_f32 v70, 0, v70
    v_cvt_pk_bf16_f32 v71, 0, v71
    v_pk_mul_f32 v[64:65], v[64:65], v[248:249] op_sel:[0,0] op_sel_hi:[1,1]
    v_pk_mul_f32 v[66:67], v[66:67], v[250:251] op_sel:[0,0] op_sel_hi:[1,1]
    v_pk_mul_f32 v[68:69], v[68:69], v[4:5] op_sel:[0,0] op_sel_hi:[1,1]
    v_pk_mul_f32 v[70:71], v[70:71], v[6:7] op_sel:[0,0] op_sel_hi:[1,1]
    v_cvt_pk_bf16_f32 v64, 0, v64
    v_cvt_pk_bf16_f32 v65, 0, v65
    v_cvt_pk_bf16_f32 v66, 0, v66
    v_cvt_pk_bf16_f32 v67, 0, v67
    v_cvt_pk_bf16_f32 v68, 0, v68
    v_cvt_pk_bf16_f32 v69, 0, v69
    v_cvt_pk_bf16_f32 v70, 0, v70
    v_cvt_pk_bf16_f32 v71, 0, v71
    v_pk_add_f32 v[64:65], v[64:65], v[14:15] op_sel:[0,0] op_sel_hi:[1,1]
    v_pk_add_f32 v[66:67], v[66:67], v[16:17] op_sel:[0,0] op_sel_hi:[1,1]
    v_pk_add_f32 v[68:69], v[68:69], v[176:177] op_sel:[0,0] op_sel_hi:[1,1]
    v_pk_add_f32 v[70:71], v[70:71], v[178:179] op_sel:[0,0] op_sel_hi:[1,1]
    v_cvt_pk_bf16_f32 v148, v64, v65
    v_cvt_pk_bf16_f32 v149, v66, v67
    v_cvt_pk_bf16_f32 v150, v68, v69
    v_cvt_pk_bf16_f32 v151, v70, v71
    buffer_store_dwordx4 v[148:151], v11, s[32:35], s52 offen offset:64 sc0 sc1
    s_branch L_m_done
L_redo:
    s_min_u32 s61, s61, 16384
    s_sub_u32 s61, s61, 256
    s_cbranch_scc1 L_k3ok
    s_waitcnt vmcnt(0) lgkmcnt(0)
    s_mul_i32 s45, s43, 114688
    s_mul_i32 s46, s38, 7168
    s_add_u32 s45, s45, s46
    s_add_u32 s45, s45, 0x1100000
    s_add_u32 s46, s45, 28672
    s_add_u32 s47, s46, 28672
    s_add_u32 s50, s47, 28672
    v_add_u32 v19, s98, v1
    buffer_load_dwordx4 v[128:131], v19, s[24:27], s45 offen offset:0 sc1
    buffer_load_dwordx4 v[132:135], v19, s[24:27], s46 offen offset:0 sc1
    buffer_load_dwordx4 v[136:139], v19, s[24:27], s47 offen offset:0 sc1
    buffer_load_dwordx4 v[140:143], v19, s[24:27], s50 offen offset:0 sc1
    v_add_u32 v19, s99, v1
    buffer_load_dwordx4 v[144:147], v19, s[24:27], s45 offen offset:0 sc1
    buffer_load_dwordx4 v[148:151], v19, s[24:27], s46 offen offset:0 sc1
    buffer_load_dwordx4 v[152:155], v19, s[24:27], s47 offen offset:0 sc1
    buffer_load_dwordx4 v[156:159], v19, s[24:27], s50 offen offset:0 sc1
    v_add_u32 v19, s100, v1
    buffer_load_dwordx4 v[160:163], v19, s[24:27], s45 offen offset:0 sc1
    buffer_load_dwordx4 v[164:167], v19, s[24:27], s46 offen offset:0 sc1
    buffer_load_dwordx4 v[168:171], v19, s[24:27], s47 offen offset:0 sc1
    buffer_load_dwordx4 v[172:175], v19, s[24:27], s50 offen offset:0 sc1
    v_add_u32 v19, s98, v1
    buffer_load_dwordx4 v[176:179], v19, s[24:27], s45 offen offset:3072 sc1
    buffer_load_dwordx4 v[180:183], v19, s[24:27], s46 offen offset:3072 sc1
    buffer_load_dwordx4 v[184:187], v19, s[24:27], s47 offen offset:3072 sc1
    buffer_load_dwordx4 v[188:191], v19, s[24:27], s50 offen offset:3072 sc1
    v_add_u32 v19, s99, v1
    buffer_load_dwordx4 v[192:195], v19, s[24:27], s45 offen offset:3072 sc1
    buffer_load_dwordx4 v[196:199], v19, s[24:27], s46 offen offset:3072 sc1
    buffer_load_dwordx4 v[200:203], v19, s[24:27], s47 offen offset:3072 sc1
    buffer_load_dwordx4 v[204:207], v19, s[24:27], s50 offen offset:3072 sc1
    v_add_u32 v19, s100, v1
    buffer_load_dwordx4 v[208:211], v19, s[24:27], s45 offen offset:3072 sc1
    buffer_load_dwordx4 v[212:215], v19, s[24:27], s46 offen offset:3072 sc1
    buffer_load_dwordx4 v[216:219], v19, s[24:27], s47 offen offset:3072 sc1
    buffer_load_dwordx4 v[220:223], v19, s[24:27], s50 offen offset:3072 sc1
    v_add_u32 v19, 3072, v1
    buffer_load_dwordx4 v[224:227], v19, s[24:27], s45 offen offset:3072 sc1
    buffer_load_dwordx4 v[228:231], v19, s[24:27], s46 offen offset:3072 sc1
    buffer_load_dwordx4 v[232:235], v19, s[24:27], s47 offen offset:3072 sc1
    buffer_load_dwordx4 v[236:239], v19, s[24:27], s50 offen offset:3072 sc1
    s_waitcnt vmcnt(0)
    s_branch L_k3AB
L_m_tail:
    s_add_u32 s46, s39, s38
    s_cmp_lg_u32 s46, 0
    s_cbranch_scc1 L_m_done
    v_lshrrev_b32 v16, 4, v1
    v_lshlrev_b32 v16, 7, v16
    s_mov_b32 s61, 16384
L_ep_all:
    s_mov_b32 s46, 0xb0000
    buffer_load_dwordx2 v[56:57], v16, s[24:27], s46 offen sc1
    s_mov_b32 s46, 0xb2000
    buffer_load_dwordx2 v[58:59], v16, s[24:27], s46 offen sc1
    s_mov_b32 s46, 0xb4000
    buffer_load_dwordx2 v[60:61], v16, s[24:27], s46 offen sc1
    s_mov_b32 s46, 0xb6000
    buffer_load_dwordx2 v[62:63], v16, s[24:27], s46 offen sc1
    s_mov_b32 s46, 0xb8000
    buffer_load_dwordx2 v[64:65], v16, s[24:27], s46 offen sc1
    s_mov_b32 s46, 0xba000
    buffer_load_dwordx2 v[66:67], v16, s[24:27], s46 offen sc1
    s_mov_b32 s46, 0xbc000
    buffer_load_dwordx2 v[68:69], v16, s[24:27], s46 offen sc1
    s_mov_b32 s46, 0xbd000
    buffer_load_dwordx2 v[70:71], v16, s[24:27], s46 offen sc1
    s_waitcnt vmcnt(0)
    v_cmp_ne_u64 s[62:63], v[56:57], s[36:37]
    v_cmp_ne_u64 s[64:65], v[58:59], s[36:37]
    s_nop 0
    s_or_b64 s[62:63], s[62:63], s[64:65]
    v_cmp_ne_u64 s[64:65], v[60:61], s[36:37]
    s_nop 0
    s_or_b64 s[62:63], s[62:63], s[64:65]
    v_cmp_ne_u64 s[64:65], v[62:63], s[36:37]
    s_nop 0
    s_or_b64 s[62:63], s[62:63], s[64:65]
    v_cmp_ne_u64 s[64:65], v[64:65], s[36:37]
    s_nop 0
    s_or_b64 s[62:63], s[62:63], s[64:65]
    v_cmp_ne_u64 s[64:65], v[66:67], s[36:37]
    s_nop 0
    s_or_b64 s[62:63], s[62:63], s[64:65]
    v_cmp_ne_u64 s[64:65], v[68:69], s[36:37]
    s_nop 0
    s_or_b64 s[62:63], s[62:63], s[64:65]
    v_cmp_ne_u64 s[64:65], v[70:71], s[36:37]
    s_nop 0
    s_or_b64 s[62:63], s[62:63], s[64:65]
    s_cmp_eq_u64 s[62:63], 0
    s_cbranch_scc1 L_ep_all_ok
    s_sleep 12
    s_sub_u32 s61, s61, 1
    s_cbranch_scc0 L_ep_all
L_ep_all_ok:
    s_mov_b32 s46, 0
    s_mov_b64 exec, 1
    buffer_store_dwordx2 v[254:255], v1, s[24:27], s46 offen sc1
    s_mov_b64 exec, -1
L_m_done:
    s_endpgm
L_side:
    s_load_dwordx8 s[4:11], s[0:1], 8
    s_load_dwordx4 s[12:15], s[0:1], 40
    s_load_dwordx2 s[18:19], s[0:1], 112
    s_load_dwordx2 s[16:17], s[0:1], 72
    v_lshrrev_b32 v4, 6, v0
    v_and_b32 v12, 63, v0
    v_readfirstlane_b32 s38, v4
    v_and_b32 v2, 15, v0
    v_lshrrev_b32 v3, 4, v12
    v_lshlrev_b32 v1, 4, v12
    s_sub_u32 s39, s2, 256
    s_lshl_b32 s40, s39, 10
    s_lshl_b32 s41, s39, 2
    s_lshl_b32 s47, s38, 10
    s_waitcnt lgkmcnt(0)
    s_cmp_eq_u32 s38, 1
    s_cselect_b64 s[4:5], s[6:7], s[4:5]
    s_cmp_eq_u32 s38, 2
    s_cselect_b64 s[4:5], s[8:9], s[4:5]
    s_cmp_eq_u32 s38, 3
    s_cselect_b64 s[4:5], s[10:11], s[4:5]
    s_mov_b32 s28, s4
    s_and_b32 s29, s5, 0xffff
    s_mov_b32 s30, 0x38000
    s_mov_b32 s31, 0x20000
    s_add_u32 m0, s47, 72736
    s_mov_b32 s24, s18
    s_and_b32 s25, s19, 0xffff
    s_mov_b32 s26, 0x1400000
    s_mov_b32 s27, 0x20000
    buffer_load_dwordx4 v1, s[28:31], s40 offen lds
    s_load_dwordx2 s[36:37], s[18:19], 0
    s_load_dword s62, s[12:13], s41
    s_load_dword s63, s[14:15], s41
    s_lshr_b32 s44, s39, 3
    s_mul_i32 s45, s44, 37
    s_lshr_b32 s45, s45, 8
    s_mul_i32 s46, s45, 7
    s_sub_u32 s44, s44, s46
    s_lshl_b32 s44, s44, 2
    s_add_u32 s44, s44, s38
    s_and_b32 s46, s39, 1
    s_lshl_b32 s45, s45, 1
    s_add_u32 s45, s45, 1
    s_sub_u32 s45, s45, s46
    s_and_b32 s47, s45, 4
    s_sub_u32 s46, s47, s46
    s_and_b32 s46, s46, 7
    s_lshl_b32 s46, s46, 8
    s_and_b32 s47, s39, 6
    s_lshl_b32 s47, s47, 2
    s_add_u32 s45, s45, s47
    s_lshl_b32 s45, s45, 18
    s_add_u32 s45, s45, s46
    s_mov_b32 s20, s16
    s_and_b32 s21, s17, 0xffff
    s_mov_b32 s22, 0x800000
    s_mov_b32 s23, 0x20000
    v_lshrrev_b32 v208, 2, v2
    v_mad_u32_u24 v208, v208, 28, s44
    v_min_u32 v208, 63, v208
    v_and_b32 v209, 1, v0
    v_and_b32 v210, 2, v0
    v_lshlrev_b32 v209, 7, v209
    v_lshl_add_u32 v209, v210, 10, v209
    v_lshl_add_u32 v78, v208, 12, v209
    s_mov_b32 s58, s45
    s_mov_b64 exec, 0xfff
    buffer_load_dword v211, v78, s[20:23], s58 offen
    s_mov_b64 exec, -1
    s_lshr_b32 s40, s38, 1
    s_and_b32 s41, s38, 1
    s_mul_i32 s44, s38, 15360
    s_add_u32 s44, s44, 9280
    v_and_b32 v4, 12, v0
    v_lshrrev_b32 v9, 1, v3
    v_add_u32 v4, v4, v9
    v_mul_u32_u24 v4, 240, v4
    v_and_b32 v5, 1, v3
    v_lshl_add_u32 v4, v5, 5, v4
    v_and_b32 v5, 3, v0
    v_lshlrev_b32 v5, 3, v5
    v_add3_u32 v232, v4, v5, s44
    v_mul_u32_u24 v233, 240, v0
    v_add_u32 v235, s44, v1
    v_lshlrev_b32 v236, 4, v0
    s_mov_b32 s50, 0x24522001
    s_mov_b32 s51, 0x24522123
    s_cmp_eq_u32 s38, 1
    s_cselect_b32 s50, 0x24522021, s50
    s_cselect_b32 s51, 0x2122041, s51
    s_cmp_eq_u32 s38, 2
    s_cselect_b32 s50, 0x4008081, s50
    s_cselect_b32 s51, 0x24448901, s51
    s_cmp_eq_u32 s38, 3
    s_cselect_b32 s50, 0x24448d89, s50
    s_cselect_b32 s51, 0x24448d89, s51
    v_cmp_eq_u32 vcc, 1, v9
    v_mov_b32 v6, s50
    v_mov_b32 v9, s51
    v_cndmask_b32 v6, v6, v9, vcc
    v_bfe_u32 v7, v6, 11, 10
    v_lshrrev_b32 v8, 21, v6
    v_and_b32 v6, 0x7ff, v6
    v_and_b32 v9, 31, v0
    v_add_lshl_u32 v228, v6, v9, 1
    v_lshl_add_u32 v229, v7, 2, v228
    v_lshl_add_u32 v231, v8, 2, v229
    v_lshl_add_u32 v230, v8, 2, v228
    v_lshlrev_b32 v10, 4, v0
    v_sub_u32 v10, 4094, v10
    v_cvt_f32_i32 v10, v10
    s_movk_i32 s50, 290
    v_add_f32 v212, 0x80000000, v10
    v_add_f32 v213, 0xc0000000, v10
    v_add_f32 v214, 0xc0800000, v10
    v_add_f32 v215, 0xc0c00000, v10
    v_add_f32 v216, 0xc1000000, v10
    v_add_f32 v217, 0xc1200000, v10
    v_add_f32 v218, 0xc1400000, v10
    v_add_f32 v219, 0xc1600000, v10
    v_add_f32 v220, 0xc1800000, v10
    v_add_f32 v221, 0xc1900000, v10
    v_add_f32 v222, 0xc1a00000, v10
    v_cvt_pk_bf16_f32 v212, 0, v212
    v_cvt_pk_bf16_f32 v213, 0, v213
    v_cvt_pk_bf16_f32 v214, 0, v214
    v_cvt_pk_bf16_f32 v215, 0, v215
    v_cvt_pk_bf16_f32 v216, 0, v216
    v_cvt_pk_bf16_f32 v217, 0, v217
    v_cvt_pk_bf16_f32 v218, 0, v218
    v_cvt_pk_bf16_f32 v219, 0, v219
    v_cvt_pk_bf16_f32 v220, 0, v220
    v_cvt_pk_bf16_f32 v221, 0, v221
    v_cvt_pk_bf16_f32 v222, 0, v222
    v_cvt_i32_f32 v212, v212
    v_cvt_i32_f32 v213, v213
    v_cvt_i32_f32 v214, v214
    v_cvt_i32_f32 v215, v215
    v_cvt_i32_f32 v216, v216
    v_cvt_i32_f32 v217, v217
    v_cvt_i32_f32 v218, v218
    v_cvt_i32_f32 v219, v219
    v_cvt_i32_f32 v220, v220
    v_cvt_i32_f32 v221, v221
    v_cvt_i32_f32 v222, v222
    v_and_b32 v80, 14, v212
    v_and_b32 v81, 14, v213
    v_and_b32 v82, 14, v214
    v_and_b32 v83, 14, v215
    v_and_b32 v84, 14, v216
    v_and_b32 v85, 14, v217
    v_and_b32 v86, 14, v218
    v_and_b32 v87, 14, v219
    v_and_b32 v88, 14, v220
    v_and_b32 v89, 14, v221
    v_and_b32 v90, 14, v222
    v_ashrrev_i32 v212, 4, v212
    v_ashrrev_i32 v213, 4, v213
    v_ashrrev_i32 v214, 4, v214
    v_ashrrev_i32 v215, 4, v215
    v_ashrrev_i32 v216, 4, v216
    v_ashrrev_i32 v217, 4, v217
    v_ashrrev_i32 v218, 4, v218
    v_ashrrev_i32 v219, 4, v219
    v_ashrrev_i32 v220, 4, v220
    v_ashrrev_i32 v221, 4, v221
    v_ashrrev_i32 v222, 4, v222
    v_mad_u32_u24 v80, v80, s50, 2
    v_mad_u32_u24 v81, v81, s50, 2
    v_mad_u32_u24 v82, v82, s50, 2
    v_mad_u32_u24 v83, v83, s50, 2
    v_mad_u32_u24 v84, v84, s50, 2
    v_mad_u32_u24 v85, v85, s50, 2
    v_mad_u32_u24 v86, v86, s50, 2
    v_mad_u32_u24 v87, v87, s50, 2
    v_mad_u32_u24 v88, v88, s50, 2
    v_mad_u32_u24 v89, v89, s50, 2
    v_mad_u32_u24 v90, v90, s50, 2
    v_lshl_add_u32 v212, v212, 1, v80
    v_lshl_add_u32 v213, v213, 1, v81
    v_lshl_add_u32 v214, v214, 1, v82
    v_lshl_add_u32 v215, v215, 1, v83
    v_lshl_add_u32 v216, v216, 1, v84
    v_lshl_add_u32 v217, v217, 1, v85
    v_lshl_add_u32 v218, v218, 1, v86
    v_lshl_add_u32 v219, v219, 1, v87
    v_lshl_add_u32 v220, v220, 1, v88
    v_lshl_add_u32 v221, v221, 1, v89
    v_lshl_add_u32 v222, v222, 1, v90
    v_mul_u32_u24 v234, 580, v2
    v_mov_b32 v8, 0
    ds_write_b16 v234, v8 offset:0
    v_lshlrev_b32 v28, 1, v0
    v_add_u32 v28, 72736, v28
    v_lshrrev_b32 v29, 1, v1
    v_add_u32 v29, 74784, v29
    s_lshl_b32 s59, s39, 7
    s_add_u32 s59, s59, 0xb8000
    s_mov_b32 s60, 0
    s_waitcnt lgkmcnt(0)
    s_add_u32 s36, s36, 2
    s_addc_u32 s37, s37, 0
    s_or_b32 s36, s36, 1
    v_mov_b32 v78, s36
    v_mov_b32 v79, s37
    s_mov_b32 s46, 0x3fb8aa3b
    s_lshl_b32 s44, s62, 16
    s_and_b32 s45, s62, 0xffff0000
    v_mov_b32 v10, s44
    v_mov_b32 v11, s45
    v_mul_f32 v8, 0x3fb8aa3b, v10
    v_mul_f32 v9, 0x3fb8aa3b, v11
    v_rndne_f32 v8, v8
    v_rndne_f32 v9, v9
    v_fma_f32 v12, v10, s46, -v8
    v_fma_f32 v13, v11, s46, -v9
    v_fmac_f32 v12, 0x32a57060, v10
    v_fmac_f32 v13, 0x32a57060, v11
    v_exp_f32 v12, v12
    v_exp_f32 v13, v13
    v_cvt_i32_f32 v8, v8
    v_cvt_i32_f32 v9, v9
    v_ldexp_f32 v12, v12, v8
    v_ldexp_f32 v13, v13, v9
    v_cvt_pk_bf16_f32 v12, 0, v12
    v_cvt_pk_bf16_f32 v13, 0, v13
    v_mov_b32 v37, s63
    v_and_b32 v30, 31, v0
    v_lshlrev_b32 v30, 7, v30
    s_mov_b32 s35, 0xa9000
    s_waitcnt vmcnt(0)
    s_barrier
    ds_read_b64 v[24:25], v29 offset:0
    ds_read_b64 v[26:27], v29 offset:1024
    ds_read_b64 v[32:33], v29 offset:512
    ds_read_b64 v[34:35], v29 offset:1536
    ds_read_u16 v20, v28 offset:0
    ds_read_u16 v21, v28 offset:1024
    ds_read_u16 v22, v28 offset:2048
    ds_read_u16 v23, v28 offset:3072
    ds_read_u16 v208, v28 offset:512
    ds_read_u16 v209, v28 offset:1536
    ds_read_u16 v210, v28 offset:2560
    ds_read_u16 v211, v28 offset:3584
    s_waitcnt lgkmcnt(8)
    v_and_b32 v24, 0x7f807f80, v24
    v_and_b32 v32, 0x7f807f80, v32
    v_and_b32 v25, 0x7f807f80, v25
    v_and_b32 v33, 0x7f807f80, v33
    v_and_b32 v26, 0x7f807f80, v26
    v_and_b32 v34, 0x7f807f80, v34
    v_and_b32 v27, 0x7f807f80, v27
    v_and_b32 v35, 0x7f807f80, v35
    v_pk_max_u16 v24, v24, v25
    v_pk_max_u16 v32, v32, v33
    v_pk_max_u16 v26, v26, v27
    v_pk_max_u16 v34, v34, v35
    v_pk_max_u16 v24, v24, v26
    v_pk_max_u16 v32, v32, v34
    v_lshrrev_b32 v25, 16, v24
    v_lshrrev_b32 v33, 16, v32
    v_and_b32 v24, 0xffff, v24
    v_and_b32 v32, 0xffff, v32
    v_max_u32 v24, v24, v25
    v_max_u32 v32, v32, v33
    s_waitcnt lgkmcnt(0)
    v_lshlrev_b32 v20, 16, v20
    v_lshlrev_b32 v208, 16, v208
    v_max_u32_dpp v24, v24, v24 row_ror:8 row_mask:0xf bank_mask:0xf
    v_max_u32_dpp v32, v32, v32 row_ror:8 row_mask:0xf bank_mask:0xf
    v_lshlrev_b32 v21, 16, v21
    v_lshlrev_b32 v209, 16, v209
    v_max_u32_dpp v24, v24, v24 row_ror:4 row_mask:0xf bank_mask:0xf
    v_max_u32_dpp v32, v32, v32 row_ror:4 row_mask:0xf bank_mask:0xf
    v_lshlrev_b32 v22, 16, v22
    v_lshlrev_b32 v210, 16, v210
    v_max_u32_dpp v24, v24, v24 row_ror:2 row_mask:0xf bank_mask:0xf
    v_max_u32_dpp v32, v32, v32 row_ror:2 row_mask:0xf bank_mask:0xf
    v_lshlrev_b32 v23, 16, v23
    v_lshlrev_b32 v211, 16, v211
    v_max_u32_dpp v24, v24, v24 row_ror:1 row_mask:0xf bank_mask:0xf
    v_max_u32_dpp v32, v32, v32 row_ror:1 row_mask:0xf bank_mask:0xf
    v_mul_f32 v8, 0x3fb8aa3b, v20
    v_mul_f32 v9, 0x3fb8aa3b, v208
    v_rndne_f32 v8, v8
    v_rndne_f32 v9, v9
    v_fma_f32 v15, v20, s46, -v8
    v_fma_f32 v17, v208, s46, -v9
    v_readlane_b32 s50, v24, 0
    v_readlane_b32 s54, v32, 0
    v_readlane_b32 s51, v24, 16
    v_readlane_b32 s55, v32, 16
    v_readlane_b32 s52, v24, 32
    v_readlane_b32 s56, v32, 32
    v_readlane_b32 s53, v24, 48
    v_readlane_b32 s57, v32, 48
    v_fmac_f32 v15, 0x32a57060, v20
    v_fmac_f32 v17, 0x32a57060, v208
    v_exp_f32 v15, v15
    v_exp_f32 v17, v17
    v_cvt_i32_f32 v8, v8
    v_cvt_i32_f32 v9, v9
    v_ldexp_f32 v15, v15, v8
    v_ldexp_f32 v17, v17, v9
    v_cvt_pk_bf16_f32 v15, 0, v15
    v_cvt_pk_bf16_f32 v17, 0, v17
    s_max_u32 s50, s50, s51
    s_max_u32 s54, s54, s55
    s_max_u32 s52, s52, s53
    s_max_u32 s56, s56, s57
    s_max_u32 s50, s50, s52
    s_max_u32 s54, s54, s56
    s_lshr_b32 s50, s50, 7
    s_lshr_b32 s54, s54, 7
    s_max_u32 s50, s50, 1
    s_max_u32 s54, s54, 1
    s_min_u32 s50, s50, 253
    s_min_u32 s54, s54, 253
    s_sub_u32 s51, 254, s50
    s_sub_u32 s55, 254, s54
    s_lshl_b32 s51, s51, 23
    s_lshl_b32 s55, s55, 23
    s_lshl_b32 s50, s50, 23
    s_lshl_b32 s54, s54, 23
    v_mul_f32 v15, v15, v12
    v_mul_f32 v17, v17, v13
    v_mul_f32 v16, v21, v12
    v_mul_f32 v18, v209, v13
    v_mul_f32 v15, 0xbfb8aa3b, v15
    v_mul_f32 v17, 0xbfb8aa3b, v17
    v_mul_f32 v16, 0x3e22f983, v16
    v_mul_f32 v18, 0x3e22f983, v18
    v_mul_f32 v22, s51, v22
    v_mul_f32 v210, s55, v210
    v_mul_f32 v23, s51, v23
    v_mul_f32 v211, s55, v211
    v_mul_f32 v76, s50, v12
    v_mul_f32 v77, s54, v13
    v_add_f32 v76, v76, v76
    v_add_f32 v77, v77, v77
    v_mul_f32 v46, 0x41000000, v15
    v_mul_f32 v47, 0x41000000, v16
    v_mul_f32 v50, 0x43800000, v15
    v_mul_f32 v51, 0x43800000, v16
    v_fract_f32 v41, v16
    v_fract_f32 v47, v47
    v_fract_f32 v51, v51
    v_exp_f32 v52, v15
    v_exp_f32 v55, v46
    v_exp_f32 v57, v50
    v_cos_f32 v40, v41
    v_cos_f32 v46, v47
    v_cos_f32 v50, v51
    v_sin_f32 v41, v41
    v_sin_f32 v47, v47
    v_sin_f32 v51, v51
    v_mul_f32 v40, v40, v52
    v_mul_f32 v41, v41, v52
    v_mul_f32 v46, v46, v55
    v_mul_f32 v47, v47, v55
    v_mul_f32 v50, v50, v57
    v_mul_f32 v51, v51, v57
    v_cvt_pk_f16_f32 v120, 1.0, v46
    v_cvt_pk_f16_f32 v124, 0, -v47
    v_mul_f32 v42, v41, v41
    v_mul_f32 v43, v41, v40
    v_mul_f32 v56, v47, v47
    v_mul_f32 v57, v47, v46
    v_fma_f32 v42, v40, v40, -v42
    v_fmac_f32 v43, v40, v41
    v_fma_f32 v56, v46, v46, -v56
    v_fmac_f32 v57, v46, v47
    v_mul_f32 v44, v43, v43
    v_mul_f32 v45, v43, v42
    v_mul_f32 v58, v57, v47
    v_mul_f32 v59, v57, v46
    v_fma_f32 v44, v42, v42, -v44
    v_fmac_f32 v45, v42, v43
    v_fma_f32 v58, v56, v46, -v58
    v_fmac_f32 v59, v56, v47
    v_mul_f32 v70, v23, v45
    v_mul_f32 v71, v23, v44
    v_cvt_pk_f16_f32 v121, v56, v58
    v_cvt_pk_f16_f32 v125, -v57, -v59
    v_fma_f32 v70, v22, v44, -v70
    v_fmac_f32 v71, v22, v45
    v_mul_f32 v60, v59, v47
    v_mul_f32 v61, v59, v46
    v_mul_f32 v72, v23, v43
    v_mul_f32 v73, v23, v42
    v_fma_f32 v60, v58, v46, -v60
    v_fmac_f32 v61, v58, v47
    v_fma_f32 v72, v22, v42, -v72
    v_fmac_f32 v73, v22, v43
    v_mul_f32 v62, v61, v47
    v_mul_f32 v63, v61, v46
    v_cvt_pk_f16_f32 v96, v22, v70
    v_cvt_pk_f16_f32 v100, v23, v71
    v_fma_f32 v62, v60, v46, -v62
    v_fmac_f32 v63, v60, v47
    v_mul_f32 v74, v71, v43
    v_mul_f32 v75, v71, v42
    v_cvt_pk_f16_f32 v122, v60, v62
    v_cvt_pk_f16_f32 v126, -v61, -v63
    v_fma_f32 v74, v70, v42, -v74
    v_fmac_f32 v75, v70, v43
    v_mul_f32 v64, v63, v47
    v_mul_f32 v65, v63, v46
    v_cvt_pk_f16_f32 v88, v40, v41
    v_cvt_pk_f16_f32 v89, v50, v51
    v_fma_f32 v64, v62, v46, -v64
    v_fmac_f32 v65, v62, v47
    v_mul_f32 v70, v23, v51
    v_mul_f32 v71, v23, v50
    v_mul_f32 v66, v65, v47
    v_mul_f32 v67, v65, v46
    v_fma_f32 v70, v22, v50, -v70
    v_fmac_f32 v71, v22, v51
    v_fma_f32 v66, v64, v46, -v66
    v_fmac_f32 v67, v64, v47
    v_cvt_pk_f16_f32 v97, v72, v74
    v_cvt_pk_f16_f32 v101, v73, v75
    v_cvt_pk_f16_f32 v123, v64, v66
    v_cvt_pk_f16_f32 v127, -v65, -v67
    v_cvt_pk_f16_f32 v115, v22, v70
    v_cvt_pk_f16_f32 v119, v23, v71
    v_mul_f32 v48, v67, v47
    v_mul_f32 v49, v67, v46
    v_mul_f32 v70, v51, v51
    v_mul_f32 v71, v51, v50
    v_fma_f32 v48, v66, v46, -v48
    v_fmac_f32 v49, v66, v47
    v_fma_f32 v70, v50, v50, -v70
    v_fmac_f32 v71, v50, v51
    v_mul_f32 v80, v49, v49
    v_mul_f32 v81, v49, v48
    v_pk_mul_f16 v98, v100, v88 op_sel:[0,1] op_sel_hi:[1,1]
    v_pk_mul_f16 v99, v101, v88 op_sel:[0,1] op_sel_hi:[1,1]
    v_fma_f32 v80, v48, v48, -v80
    v_fmac_f32 v81, v48, v49
    v_pk_mul_f16 v102, v96, v88 op_sel:[0,1] op_sel_hi:[1,1]
    v_pk_mul_f16 v103, v97, v88 op_sel:[0,1] op_sel_hi:[1,1]
    v_mul_f32 v82, v81, v49
    v_mul_f32 v83, v81, v48
    v_pk_fma_f16 v98, v96, v88, v98 op_sel:[0,0,0] op_sel_hi:[1,0,1] neg_lo:[0,0,1] neg_hi:[0,0,1]
    v_pk_fma_f16 v99, v97, v88, v99 op_sel:[0,0,0] op_sel_hi:[1,0,1] neg_lo:[0,0,1] neg_hi:[0,0,1]
    v_fma_f32 v82, v80, v48, -v82
    v_fmac_f32 v83, v80, v49
    v_pk_fma_f16 v102, v100, v88, v102 op_sel:[0,0,0] op_sel_hi:[1,0,1]
    v_pk_fma_f16 v103, v101, v88, v103 op_sel:[0,0,0] op_sel_hi:[1,0,1]
    v_cvt_pk_f16_f32 v84, v48, v49
    v_cvt_pk_f16_f32 v85, v80, v81
    v_cvt_pk_f16_f32 v90, v70, v71
    v_mul_f32 v72, v71, v51
    v_cvt_pk_f16_f32 v86, v82, v83
    v_pk_mul_f16 v128, v124, v84 op_sel:[0,1] op_sel_hi:[1,1]
    v_mul_f32 v73, v71, v50
    v_fma_f32 v72, v70, v50, -v72
    v_pk_mul_f16 v129, v125, v84 op_sel:[0,1] op_sel_hi:[1,1]
    v_pk_mul_f16 v130, v126, v84 op_sel:[0,1] op_sel_hi:[1,1]
    v_fmac_f32 v73, v70, v51
    v_mul_f32 v74, v71, v71
    v_pk_mul_f16 v131, v127, v84 op_sel:[0,1] op_sel_hi:[1,1]
    v_pk_mul_f16 v132, v120, v84 op_sel:[0,1] op_sel_hi:[1,1]
    v_mul_f32 v75, v71, v70
    v_fma_f32 v74, v70, v70, -v74
    v_pk_mul_f16 v133, v121, v84 op_sel:[0,1] op_sel_hi:[1,1]
    v_pk_mul_f16 v134, v122, v84 op_sel:[0,1] op_sel_hi:[1,1]
    v_fmac_f32 v75, v70, v71
    v_pk_mul_f16 v104, v100, v89 op_sel:[0,1] op_sel_hi:[1,1]
    v_pk_mul_f16 v135, v123, v84 op_sel:[0,1] op_sel_hi:[1,1]
    v_pk_fma_f16 v128, v120, v84, v128 op_sel:[0,0,0] op_sel_hi:[1,0,1]
    v_pk_mul_f16 v105, v101, v89 op_sel:[0,1] op_sel_hi:[1,1]
    v_pk_mul_f16 v108, v96, v89 op_sel:[0,1] op_sel_hi:[1,1]
    v_pk_fma_f16 v129, v121, v84, v129 op_sel:[0,0,0] op_sel_hi:[1,0,1]
    v_pk_fma_f16 v130, v122, v84, v130 op_sel:[0,0,0] op_sel_hi:[1,0,1]
    v_pk_mul_f16 v109, v97, v89 op_sel:[0,1] op_sel_hi:[1,1]
    v_pk_fma_f16 v104, v96, v89, v104 op_sel:[0,0,0] op_sel_hi:[1,0,1] neg_lo:[0,0,1] neg_hi:[0,0,1]
    v_pk_fma_f16 v131, v123, v84, v131 op_sel:[0,0,0] op_sel_hi:[1,0,1]
    v_pk_fma_f16 v132, v124, v84, v132 op_sel:[0,0,0] op_sel_hi:[1,0,1] neg_lo:[0,0,1] neg_hi:[0,0,1]
    v_pk_fma_f16 v105, v97, v89, v105 op_sel:[0,0,0] op_sel_hi:[1,0,1] neg_lo:[0,0,1] neg_hi:[0,0,1]
    v_pk_fma_f16 v108, v100, v89, v108 op_sel:[0,0,0] op_sel_hi:[1,0,1]
    v_pk_fma_f16 v133, v125, v84, v133 op_sel:[0,0,0] op_sel_hi:[1,0,1] neg_lo:[0,0,1] neg_hi:[0,0,1]
    v_pk_fma_f16 v134, v126, v84, v134 op_sel:[0,0,0] op_sel_hi:[1,0,1] neg_lo:[0,0,1] neg_hi:[0,0,1]
    v_pk_fma_f16 v109, v101, v89, v109 op_sel:[0,0,0] op_sel_hi:[1,0,1]
    v_cvt_pk_f16_f32 v91, v72, v73
    v_pk_fma_f16 v135, v127, v84, v135 op_sel:[0,0,0] op_sel_hi:[1,0,1] neg_lo:[0,0,1] neg_hi:[0,0,1]
    v_pk_mul_f16 v136, v124, v85 op_sel:[0,1] op_sel_hi:[1,1]
    v_cvt_pk_f16_f32 v92, v74, v75
    v_mul_f32 v72, v75, v71
    v_pk_mul_f16 v137, v125, v85 op_sel:[0,1] op_sel_hi:[1,1]
    v_pk_mul_f16 v138, v126, v85 op_sel:[0,1] op_sel_hi:[1,1]
    v_mul_f32 v73, v75, v70
    v_fma_f32 v72, v74, v70, -v72
    v_pk_mul_f16 v139, v127, v85 op_sel:[0,1] op_sel_hi:[1,1]
    v_pk_mul_f16 v140, v120, v85 op_sel:[0,1] op_sel_hi:[1,1]
    v_fmac_f32 v73, v74, v71
    v_mul_f32 v22, v75, v75
    v_pk_mul_f16 v141, v121, v85 op_sel:[0,1] op_sel_hi:[1,1]
    v_pk_mul_f16 v142, v122, v85 op_sel:[0,1] op_sel_hi:[1,1]
    v_mul_f32 v23, v75, v74
    v_fma_f32 v22, v74, v74, -v22
    v_pk_mul_f16 v143, v123, v85 op_sel:[0,1] op_sel_hi:[1,1]
    v_pk_fma_f16 v136, v120, v85, v136 op_sel:[0,0,0] op_sel_hi:[1,0,1]
    v_fmac_f32 v23, v74, v75
    v_pk_mul_f16 v106, v100, v90 op_sel:[0,1] op_sel_hi:[1,1]
    v_pk_fma_f16 v137, v121, v85, v137 op_sel:[0,0,0] op_sel_hi:[1,0,1]
    v_pk_fma_f16 v138, v122, v85, v138 op_sel:[0,0,0] op_sel_hi:[1,0,1]
    v_pk_mul_f16 v107, v100, v91 op_sel:[0,1] op_sel_hi:[1,1]
    v_pk_mul_f16 v110, v96, v90 op_sel:[0,1] op_sel_hi:[1,1]
    v_pk_fma_f16 v139, v123, v85, v139 op_sel:[0,0,0] op_sel_hi:[1,0,1]
    v_pk_fma_f16 v140, v124, v85, v140 op_sel:[0,0,0] op_sel_hi:[1,0,1] neg_lo:[0,0,1] neg_hi:[0,0,1]
    v_pk_mul_f16 v111, v96, v91 op_sel:[0,1] op_sel_hi:[1,1]
    v_pk_fma_f16 v106, v96, v90, v106 op_sel:[0,0,0] op_sel_hi:[1,0,1] neg_lo:[0,0,1] neg_hi:[0,0,1]
    v_pk_fma_f16 v141, v125, v85, v141 op_sel:[0,0,0] op_sel_hi:[1,0,1] neg_lo:[0,0,1] neg_hi:[0,0,1]
    v_pk_fma_f16 v142, v126, v85, v142 op_sel:[0,0,0] op_sel_hi:[1,0,1] neg_lo:[0,0,1] neg_hi:[0,0,1]
    v_pk_fma_f16 v107, v96, v91, v107 op_sel:[0,0,0] op_sel_hi:[1,0,1] neg_lo:[0,0,1] neg_hi:[0,0,1]
    v_pk_fma_f16 v110, v100, v90, v110 op_sel:[0,0,0] op_sel_hi:[1,0,1]
    v_pk_fma_f16 v143, v127, v85, v143 op_sel:[0,0,0] op_sel_hi:[1,0,1] neg_lo:[0,0,1] neg_hi:[0,0,1]
    v_pk_mul_f16 v144, v124, v86 op_sel:[0,1] op_sel_hi:[1,1]
    v_pk_fma_f16 v111, v100, v91, v111 op_sel:[0,0,0] op_sel_hi:[1,0,1]
    v_cvt_pk_f16_f32 v93, v72, v73
    v_pk_mul_f16 v145, v125, v86 op_sel:[0,1] op_sel_hi:[1,1]
    v_pk_mul_f16 v146, v126, v86 op_sel:[0,1] op_sel_hi:[1,1]
    v_cvt_pk_f16_f32 v94, v22, v23
    v_pk_mul_f16 v112, v119, v92 op_sel:[0,1] op_sel_hi:[1,1]
    v_pk_mul_f16 v147, v127, v86 op_sel:[0,1] op_sel_hi:[1,1]
    v_pk_mul_f16 v148, v120, v86 op_sel:[0,1] op_sel_hi:[1,1]
    v_pk_mul_f16 v113, v119, v93 op_sel:[0,1] op_sel_hi:[1,1]
    v_pk_mul_f16 v114, v119, v94 op_sel:[0,1] op_sel_hi:[1,1]
    v_pk_mul_f16 v149, v121, v86 op_sel:[0,1] op_sel_hi:[1,1]
    v_pk_mul_f16 v150, v122, v86 op_sel:[0,1] op_sel_hi:[1,1]
    v_pk_mul_f16 v116, v115, v92 op_sel:[0,1] op_sel_hi:[1,1]
    v_pk_mul_f16 v117, v115, v93 op_sel:[0,1] op_sel_hi:[1,1]
    v_pk_mul_f16 v151, v123, v86 op_sel:[0,1] op_sel_hi:[1,1]
    v_pk_fma_f16 v144, v120, v86, v144 op_sel:[0,0,0] op_sel_hi:[1,0,1]
    v_pk_mul_f16 v118, v115, v94 op_sel:[0,1] op_sel_hi:[1,1]
    v_pk_fma_f16 v112, v115, v92, v112 op_sel:[0,0,0] op_sel_hi:[1,0,1] neg_lo:[0,0,1] neg_hi:[0,0,1]
    v_pk_fma_f16 v145, v121, v86, v145 op_sel:[0,0,0] op_sel_hi:[1,0,1]
    v_pk_fma_f16 v146, v122, v86, v146 op_sel:[0,0,0] op_sel_hi:[1,0,1]
    v_pk_fma_f16 v113, v115, v93, v113 op_sel:[0,0,0] op_sel_hi:[1,0,1] neg_lo:[0,0,1] neg_hi:[0,0,1]
    v_pk_fma_f16 v114, v115, v94, v114 op_sel:[0,0,0] op_sel_hi:[1,0,1] neg_lo:[0,0,1] neg_hi:[0,0,1]
    v_pk_fma_f16 v147, v123, v86, v147 op_sel:[0,0,0] op_sel_hi:[1,0,1]
    v_pk_fma_f16 v148, v124, v86, v148 op_sel:[0,0,0] op_sel_hi:[1,0,1] neg_lo:[0,0,1] neg_hi:[0,0,1]
    v_pk_fma_f16 v116, v119, v92, v116 op_sel:[0,0,0] op_sel_hi:[1,0,1]
    v_pk_fma_f16 v117, v119, v93, v117 op_sel:[0,0,0] op_sel_hi:[1,0,1]
    v_pk_fma_f16 v149, v125, v86, v149 op_sel:[0,0,0] op_sel_hi:[1,0,1] neg_lo:[0,0,1] neg_hi:[0,0,1]
    v_pk_fma_f16 v150, v126, v86, v150 op_sel:[0,0,0] op_sel_hi:[1,0,1] neg_lo:[0,0,1] neg_hi:[0,0,1]
    v_pk_fma_f16 v118, v119, v94, v118 op_sel:[0,0,0] op_sel_hi:[1,0,1]
    v_pk_fma_f16 v151, v127, v86, v151 op_sel:[0,0,0] op_sel_hi:[1,0,1] neg_lo:[0,0,1] neg_hi:[0,0,1]
    ds_write_b128 v233, v[96:99] offset:9280
    ds_write_b128 v233, v[100:103] offset:9328
    ds_write_b128 v233, v[104:107] offset:9296
    ds_write_b128 v233, v[108:111] offset:9344
    ds_write_b128 v233, v[112:115] offset:9312
    ds_write_b128 v233, v[116:119] offset:9360
    ds_write_b128 v233, v[120:123] offset:9376
    ds_write_b128 v233, v[124:127] offset:9440
    ds_write_b128 v233, v[128:131] offset:9392
    ds_write_b128 v233, v[132:135] offset:9456
    ds_write_b128 v233, v[136:139] offset:9408
    ds_write_b128 v233, v[140:143] offset:9472
    ds_write_b128 v233, v[144:147] offset:9424
    ds_write_b128 v233, v[148:151] offset:9488
    ds_read_b64_tr_b16 v[96:97], v232 offset:0
    ds_read_b64_tr_b16 v[98:99], v232 offset:48
    ds_read_b64_tr_b16 v[100:101], v232 offset:96
    ds_read_b64_tr_b16 v[102:103], v232 offset:160
    ds_read_b64_tr_b16 v[104:105], v232 offset:480
    ds_read_b64_tr_b16 v[106:107], v232 offset:528
    ds_read_b64_tr_b16 v[108:109], v232 offset:576
    ds_read_b64_tr_b16 v[110:111], v232 offset:640
    ds_read_b64_tr_b16 v[112:113], v232 offset:3840
    ds_read_b64_tr_b16 v[114:115], v232 offset:3888
    ds_read_b64_tr_b16 v[116:117], v232 offset:3936
    ds_read_b64_tr_b16 v[118:119], v232 offset:4000
    ds_read_b64_tr_b16 v[120:121], v232 offset:4320
    ds_read_b64_tr_b16 v[122:123], v232 offset:4368
    ds_read_b64_tr_b16 v[124:125], v232 offset:4416
    ds_read_b64_tr_b16 v[126:127], v232 offset:4480
    ds_read_b64_tr_b16 v[128:129], v232 offset:7680
    ds_read_b64_tr_b16 v[130:131], v232 offset:7728
    ds_read_b64_tr_b16 v[132:133], v232 offset:7776
    ds_read_b64_tr_b16 v[134:135], v232 offset:7840
    ds_read_b64_tr_b16 v[136:137], v232 offset:8160
    ds_read_b64_tr_b16 v[138:139], v232 offset:8208
    ds_read_b64_tr_b16 v[140:141], v232 offset:8256
    ds_read_b64_tr_b16 v[142:143], v232 offset:8320
    ds_read_b64_tr_b16 v[144:145], v232 offset:11520
    ds_read_b64_tr_b16 v[146:147], v232 offset:11568
    ds_read_b64_tr_b16 v[148:149], v232 offset:11616
    ds_read_b64_tr_b16 v[150:151], v232 offset:11680
    v_mul_f32 v46, 0x41000000, v17
    v_mul_f32 v47, 0x41000000, v18
    v_mul_f32 v50, 0x43800000, v17
    v_mul_f32 v51, 0x43800000, v18
    v_fract_f32 v41, v18
    v_fract_f32 v47, v47
    v_fract_f32 v51, v51
    v_exp_f32 v52, v17
    v_exp_f32 v55, v46
    v_exp_f32 v57, v50
    v_cos_f32 v40, v41
    v_cos_f32 v46, v47
    v_cos_f32 v50, v51
    v_sin_f32 v41, v41
    v_sin_f32 v47, v47
    v_sin_f32 v51, v51
    v_mul_f32 v40, v40, v52
    v_mul_f32 v41, v41, v52
    v_mul_f32 v46, v46, v55
    v_mul_f32 v47, v47, v55
    v_mul_f32 v50, v50, v57
    v_mul_f32 v51, v51, v57
    v_cvt_pk_f16_f32 v176, 1.0, v46
    v_cvt_pk_f16_f32 v180, 0, -v47
    v_mul_f32 v42, v41, v41
    v_mul_f32 v43, v41, v40
    v_mul_f32 v56, v47, v47
    v_mul_f32 v57, v47, v46
    v_fma_f32 v42, v40, v40, -v42
    v_fmac_f32 v43, v40, v41
    s_waitcnt lgkmcnt(15)
    v_mfma_f32_32x32x16_f16 v[240:255], v[96:99], v[100:103], 0
    ds_read_b64_tr_b16 v[96:97], v232 offset:12000
    ds_read_b64_tr_b16 v[98:99], v232 offset:12048
    ds_read_b64_tr_b16 v[100:101], v232 offset:12096
    ds_read_b64_tr_b16 v[102:103], v232 offset:12160
    s_waitcnt lgkmcnt(15)
    v_mfma_f32_32x32x16_f16 v[240:255], v[104:107], v[108:111], v[240:255]
    v_fma_f32 v56, v46, v46, -v56
    v_fmac_f32 v57, v46, v47
    v_mul_f32 v44, v43, v43
    v_mul_f32 v45, v43, v42
    v_mul_f32 v58, v57, v47
    s_waitcnt lgkmcnt(15)
    v_mfma_f32_32x32x16_f16 v[240:255], v[112:115], v[116:119], v[240:255]
    v_mul_f32 v59, v57, v46
    v_fma_f32 v44, v42, v42, -v44
    v_fmac_f32 v45, v42, v43
    v_fma_f32 v58, v56, v46, -v58
    v_fmac_f32 v59, v56, v47
    s_waitcnt lgkmcnt(15)
    v_mfma_f32_32x32x16_f16 v[240:255], v[120:123], v[124:127], v[240:255]
    v_mul_f32 v70, v211, v45
    v_mul_f32 v71, v211, v44
    v_cvt_pk_f16_f32 v177, v56, v58
    v_cvt_pk_f16_f32 v181, -v57, -v59
    v_fma_f32 v70, v210, v44, -v70
    s_waitcnt lgkmcnt(12)
    v_mfma_f32_32x32x16_f16 v[240:255], v[128:131], v[132:135], v[240:255]
    v_fmac_f32 v71, v210, v45
    v_mul_f32 v60, v59, v47
    v_mul_f32 v61, v59, v46
    v_mul_f32 v72, v211, v43
    v_mul_f32 v73, v211, v42
    s_waitcnt lgkmcnt(8)
    v_mfma_f32_32x32x16_f16 v[240:255], v[136:139], v[140:143], v[240:255]
    v_fma_f32 v60, v58, v46, -v60
    v_fmac_f32 v61, v58, v47
    v_fma_f32 v72, v210, v42, -v72
    v_fmac_f32 v73, v210, v43
    v_mul_f32 v62, v61, v47
    s_waitcnt lgkmcnt(4)
    v_mfma_f32_32x32x16_f16 v[240:255], v[144:147], v[148:151], v[240:255]
    v_mul_f32 v63, v61, v46
    v_cvt_pk_f16_f32 v152, v210, v70
    v_cvt_pk_f16_f32 v156, v211, v71
    v_fma_f32 v62, v60, v46, -v62
    v_fmac_f32 v63, v60, v47
    s_waitcnt lgkmcnt(0)
    v_mfma_f32_32x32x16_f16 v[240:255], v[96:99], v[100:103], v[240:255]
    v_mul_f32 v74, v71, v43
    v_mul_f32 v75, v71, v42
    v_cvt_pk_f16_f32 v178, v60, v62
    v_cvt_pk_f16_f32 v182, -v61, -v63
    v_fma_f32 v74, v70, v42, -v74
    v_fmac_f32 v75, v70, v43
    v_mul_f32 v64, v63, v47
    v_mul_f32 v65, v63, v46
    v_cvt_pk_f16_f32 v88, v40, v41
    v_cvt_pk_f16_f32 v89, v50, v51
    v_fma_f32 v64, v62, v46, -v64
    v_fmac_f32 v65, v62, v47
    v_mul_f32 v70, v211, v51
    v_mul_f32 v71, v211, v50
    v_mul_f32 v66, v65, v47
    v_mul_f32 v67, v65, v46
    v_fma_f32 v70, v210, v50, -v70
    v_fmac_f32 v71, v210, v51
    v_fma_f32 v66, v64, v46, -v66
    v_fmac_f32 v67, v64, v47
    v_cvt_pk_f16_f32 v153, v72, v74
    v_cvt_pk_f16_f32 v157, v73, v75
    v_cvt_pk_f16_f32 v179, v64, v66
    v_cvt_pk_f16_f32 v183, -v65, -v67
    v_cvt_pk_f16_f32 v171, v210, v70
    v_cvt_pk_f16_f32 v175, v211, v71
    v_mul_f32 v48, v67, v47
    v_mul_f32 v49, v67, v46
    v_mul_f32 v70, v51, v51
    v_mul_f32 v71, v51, v50
    v_fma_f32 v48, v66, v46, -v48
    v_fmac_f32 v49, v66, v47
    v_fma_f32 v70, v50, v50, -v70
    v_fmac_f32 v71, v50, v51
    v_mul_f32 v80, v49, v49
    v_mul_f32 v81, v49, v48
    v_pk_mul_f16 v154, v156, v88 op_sel:[0,1] op_sel_hi:[1,1]
    v_pk_mul_f16 v155, v157, v88 op_sel:[0,1] op_sel_hi:[1,1]
    v_fma_f32 v80, v48, v48, -v80
    v_fmac_f32 v81, v48, v49
    v_pk_mul_f16 v158, v152, v88 op_sel:[0,1] op_sel_hi:[1,1]
    v_pk_mul_f16 v159, v153, v88 op_sel:[0,1] op_sel_hi:[1,1]
    v_mul_f32 v82, v81, v49
    v_mul_f32 v83, v81, v48
    v_pk_fma_f16 v154, v152, v88, v154 op_sel:[0,0,0] op_sel_hi:[1,0,1] neg_lo:[0,0,1] neg_hi:[0,0,1]
    v_pk_fma_f16 v155, v153, v88, v155 op_sel:[0,0,0] op_sel_hi:[1,0,1] neg_lo:[0,0,1] neg_hi:[0,0,1]
    v_fma_f32 v82, v80, v48, -v82
    v_fmac_f32 v83, v80, v49
    v_pk_fma_f16 v158, v156, v88, v158 op_sel:[0,0,0] op_sel_hi:[1,0,1]
    v_pk_fma_f16 v159, v157, v88, v159 op_sel:[0,0,0] op_sel_hi:[1,0,1]
    v_cvt_pk_f16_f32 v84, v48, v49
    v_cvt_pk_f16_f32 v85, v80, v81
    v_cvt_pk_f16_f32 v90, v70, v71
    v_mul_f32 v72, v71, v51
    v_cvt_pk_f16_f32 v86, v82, v83
    v_pk_mul_f16 v184, v180, v84 op_sel:[0,1] op_sel_hi:[1,1]
    v_mul_f32 v73, v71, v50
    v_fma_f32 v72, v70, v50, -v72
    v_pk_mul_f16 v185, v181, v84 op_sel:[0,1] op_sel_hi:[1,1]
    v_pk_mul_f16 v186, v182, v84 op_sel:[0,1] op_sel_hi:[1,1]
    v_fmac_f32 v73, v70, v51
    v_mul_f32 v74, v71, v71
    v_pk_mul_f16 v187, v183, v84 op_sel:[0,1] op_sel_hi:[1,1]
    v_pk_mul_f16 v188, v176, v84 op_sel:[0,1] op_sel_hi:[1,1]
    v_mul_f32 v75, v71, v70
    v_fma_f32 v74, v70, v70, -v74
    v_pk_mul_f16 v189, v177, v84 op_sel:[0,1] op_sel_hi:[1,1]
    v_pk_mul_f16 v190, v178, v84 op_sel:[0,1] op_sel_hi:[1,1]
    v_fmac_f32 v75, v70, v71
    v_pk_mul_f16 v160, v156, v89 op_sel:[0,1] op_sel_hi:[1,1]
    v_pk_mul_f16 v191, v179, v84 op_sel:[0,1] op_sel_hi:[1,1]
    v_pk_fma_f16 v184, v176, v84, v184 op_sel:[0,0,0] op_sel_hi:[1,0,1]
    v_pk_mul_f16 v161, v157, v89 op_sel:[0,1] op_sel_hi:[1,1]
    v_pk_mul_f16 v164, v152, v89 op_sel:[0,1] op_sel_hi:[1,1]
    v_pk_fma_f16 v185, v177, v84, v185 op_sel:[0,0,0] op_sel_hi:[1,0,1]
    v_pk_fma_f16 v186, v178, v84, v186 op_sel:[0,0,0] op_sel_hi:[1,0,1]
    v_pk_mul_f16 v165, v153, v89 op_sel:[0,1] op_sel_hi:[1,1]
    v_pk_fma_f16 v160, v152, v89, v160 op_sel:[0,0,0] op_sel_hi:[1,0,1] neg_lo:[0,0,1] neg_hi:[0,0,1]
    v_pk_fma_f16 v187, v179, v84, v187 op_sel:[0,0,0] op_sel_hi:[1,0,1]
    v_pk_fma_f16 v188, v180, v84, v188 op_sel:[0,0,0] op_sel_hi:[1,0,1] neg_lo:[0,0,1] neg_hi:[0,0,1]
    v_pk_fma_f16 v161, v153, v89, v161 op_sel:[0,0,0] op_sel_hi:[1,0,1] neg_lo:[0,0,1] neg_hi:[0,0,1]
    v_pk_fma_f16 v164, v156, v89, v164 op_sel:[0,0,0] op_sel_hi:[1,0,1]
    v_pk_fma_f16 v189, v181, v84, v189 op_sel:[0,0,0] op_sel_hi:[1,0,1] neg_lo:[0,0,1] neg_hi:[0,0,1]
    v_pk_fma_f16 v190, v182, v84, v190 op_sel:[0,0,0] op_sel_hi:[1,0,1] neg_lo:[0,0,1] neg_hi:[0,0,1]
    v_pk_fma_f16 v165, v157, v89, v165 op_sel:[0,0,0] op_sel_hi:[1,0,1]
    v_cvt_pk_f16_f32 v91, v72, v73
    v_pk_fma_f16 v191, v183, v84, v191 op_sel:[0,0,0] op_sel_hi:[1,0,1] neg_lo:[0,0,1] neg_hi:[0,0,1]
    v_pk_mul_f16 v192, v180, v85 op_sel:[0,1] op_sel_hi:[1,1]
    v_cvt_pk_f16_f32 v92, v74, v75
    v_mul_f32 v72, v75, v71
    v_pk_mul_f16 v193, v181, v85 op_sel:[0,1] op_sel_hi:[1,1]
    v_pk_mul_f16 v194, v182, v85 op_sel:[0,1] op_sel_hi:[1,1]
    v_mul_f32 v73, v75, v70
    v_fma_f32 v72, v74, v70, -v72
    v_pk_mul_f16 v195, v183, v85 op_sel:[0,1] op_sel_hi:[1,1]
    v_pk_mul_f16 v196, v176, v85 op_sel:[0,1] op_sel_hi:[1,1]
    v_fmac_f32 v73, v74, v71
    v_mul_f32 v210, v75, v75
    v_pk_mul_f16 v197, v177, v85 op_sel:[0,1] op_sel_hi:[1,1]
    v_pk_mul_f16 v198, v178, v85 op_sel:[0,1] op_sel_hi:[1,1]
    v_mul_f32 v211, v75, v74
    v_fma_f32 v210, v74, v74, -v210
    v_pk_mul_f16 v199, v179, v85 op_sel:[0,1] op_sel_hi:[1,1]
    v_pk_fma_f16 v192, v176, v85, v192 op_sel:[0,0,0] op_sel_hi:[1,0,1]
    v_fmac_f32 v211, v74, v75
    v_pk_mul_f16 v162, v156, v90 op_sel:[0,1] op_sel_hi:[1,1]
    v_pk_fma_f16 v193, v177, v85, v193 op_sel:[0,0,0] op_sel_hi:[1,0,1]
    v_pk_fma_f16 v194, v178, v85, v194 op_sel:[0,0,0] op_sel_hi:[1,0,1]
    v_pk_mul_f16 v163, v156, v91 op_sel:[0,1] op_sel_hi:[1,1]
    v_pk_mul_f16 v166, v152, v90 op_sel:[0,1] op_sel_hi:[1,1]
    v_pk_fma_f16 v195, v179, v85, v195 op_sel:[0,0,0] op_sel_hi:[1,0,1]
    v_pk_fma_f16 v196, v180, v85, v196 op_sel:[0,0,0] op_sel_hi:[1,0,1] neg_lo:[0,0,1] neg_hi:[0,0,1]
    v_pk_mul_f16 v167, v152, v91 op_sel:[0,1] op_sel_hi:[1,1]
    v_pk_fma_f16 v162, v152, v90, v162 op_sel:[0,0,0] op_sel_hi:[1,0,1] neg_lo:[0,0,1] neg_hi:[0,0,1]
    v_pk_fma_f16 v197, v181, v85, v197 op_sel:[0,0,0] op_sel_hi:[1,0,1] neg_lo:[0,0,1] neg_hi:[0,0,1]
    v_pk_fma_f16 v198, v182, v85, v198 op_sel:[0,0,0] op_sel_hi:[1,0,1] neg_lo:[0,0,1] neg_hi:[0,0,1]
    v_pk_fma_f16 v163, v152, v91, v163 op_sel:[0,0,0] op_sel_hi:[1,0,1] neg_lo:[0,0,1] neg_hi:[0,0,1]
    v_pk_fma_f16 v166, v156, v90, v166 op_sel:[0,0,0] op_sel_hi:[1,0,1]
    v_pk_fma_f16 v199, v183, v85, v199 op_sel:[0,0,0] op_sel_hi:[1,0,1] neg_lo:[0,0,1] neg_hi:[0,0,1]
    v_pk_mul_f16 v200, v180, v86 op_sel:[0,1] op_sel_hi:[1,1]
    v_pk_fma_f16 v167, v156, v91, v167 op_sel:[0,0,0] op_sel_hi:[1,0,1]
    v_cvt_pk_f16_f32 v93, v72, v73
    v_pk_mul_f16 v201, v181, v86 op_sel:[0,1] op_sel_hi:[1,1]
    v_pk_mul_f16 v202, v182, v86 op_sel:[0,1] op_sel_hi:[1,1]
    v_cvt_pk_f16_f32 v94, v210, v211
    v_pk_mul_f16 v168, v175, v92 op_sel:[0,1] op_sel_hi:[1,1]
    v_pk_mul_f16 v203, v183, v86 op_sel:[0,1] op_sel_hi:[1,1]
    v_pk_mul_f16 v204, v176, v86 op_sel:[0,1] op_sel_hi:[1,1]
    v_pk_mul_f16 v169, v175, v93 op_sel:[0,1] op_sel_hi:[1,1]
    v_pk_mul_f16 v170, v175, v94 op_sel:[0,1] op_sel_hi:[1,1]
    v_pk_mul_f16 v205, v177, v86 op_sel:[0,1] op_sel_hi:[1,1]
    v_pk_mul_f16 v206, v178, v86 op_sel:[0,1] op_sel_hi:[1,1]
    v_pk_mul_f16 v172, v171, v92 op_sel:[0,1] op_sel_hi:[1,1]
    v_pk_mul_f16 v173, v171, v93 op_sel:[0,1] op_sel_hi:[1,1]
    v_pk_mul_f16 v207, v179, v86 op_sel:[0,1] op_sel_hi:[1,1]
    v_pk_fma_f16 v200, v176, v86, v200 op_sel:[0,0,0] op_sel_hi:[1,0,1]
    v_pk_mul_f16 v174, v171, v94 op_sel:[0,1] op_sel_hi:[1,1]
    v_pk_fma_f16 v168, v171, v92, v168 op_sel:[0,0,0] op_sel_hi:[1,0,1] neg_lo:[0,0,1] neg_hi:[0,0,1]
    v_pk_fma_f16 v201, v177, v86, v201 op_sel:[0,0,0] op_sel_hi:[1,0,1]
    v_pk_fma_f16 v202, v178, v86, v202 op_sel:[0,0,0] op_sel_hi:[1,0,1]
    v_pk_fma_f16 v169, v171, v93, v169 op_sel:[0,0,0] op_sel_hi:[1,0,1] neg_lo:[0,0,1] neg_hi:[0,0,1]
    v_pk_fma_f16 v170, v171, v94, v170 op_sel:[0,0,0] op_sel_hi:[1,0,1] neg_lo:[0,0,1] neg_hi:[0,0,1]
    v_pk_fma_f16 v203, v179, v86, v203 op_sel:[0,0,0] op_sel_hi:[1,0,1]
    v_pk_fma_f16 v204, v180, v86, v204 op_sel:[0,0,0] op_sel_hi:[1,0,1] neg_lo:[0,0,1] neg_hi:[0,0,1]
    v_pk_fma_f16 v172, v175, v92, v172 op_sel:[0,0,0] op_sel_hi:[1,0,1]
    v_pk_fma_f16 v173, v175, v93, v173 op_sel:[0,0,0] op_sel_hi:[1,0,1]
    v_pk_fma_f16 v205, v181, v86, v205 op_sel:[0,0,0] op_sel_hi:[1,0,1] neg_lo:[0,0,1] neg_hi:[0,0,1]
    v_pk_fma_f16 v206, v182, v86, v206 op_sel:[0,0,0] op_sel_hi:[1,0,1] neg_lo:[0,0,1] neg_hi:[0,0,1]
    v_pk_fma_f16 v174, v175, v94, v174 op_sel:[0,0,0] op_sel_hi:[1,0,1]
    v_pk_fma_f16 v207, v183, v86, v207 op_sel:[0,0,0] op_sel_hi:[1,0,1] neg_lo:[0,0,1] neg_hi:[0,0,1]
    s_cmp_lg_u32 s38, 0
    s_cbranch_scc1 L_nofxl
    buffer_load_dwordx2 v[68:69], v30, s[24:27], s35 offen sc1
L_nofxl:
    ds_write_b128 v233, v[152:155] offset:9280
    ds_write_b128 v233, v[156:159] offset:9328
    ds_write_b128 v233, v[160:163] offset:9296
    ds_write_b128 v233, v[164:167] offset:9344
    ds_write_b128 v233, v[168:171] offset:9312
    ds_write_b128 v233, v[172:175] offset:9360
    ds_write_b128 v233, v[176:179] offset:9376
    ds_write_b128 v233, v[180:183] offset:9440
    ds_write_b128 v233, v[184:187] offset:9392
    ds_write_b128 v233, v[188:191] offset:9456
    ds_write_b128 v233, v[192:195] offset:9408
    ds_write_b128 v233, v[196:199] offset:9472
    ds_write_b128 v233, v[200:203] offset:9424
    ds_write_b128 v233, v[204:207] offset:9488
    ds_read_b64_tr_b16 v[152:153], v232 offset:0
    ds_read_b64_tr_b16 v[154:155], v232 offset:48
    ds_read_b64_tr_b16 v[156:157], v232 offset:96
    ds_read_b64_tr_b16 v[158:159], v232 offset:160
    ds_read_b64_tr_b16 v[160:161], v232 offset:480
    ds_read_b64_tr_b16 v[162:163], v232 offset:528
    ds_read_b64_tr_b16 v[164:165], v232 offset:576
    ds_read_b64_tr_b16 v[166:167], v232 offset:640
    ds_read_b64_tr_b16 v[168:169], v232 offset:3840
    ds_read_b64_tr_b16 v[170:171], v232 offset:3888
    ds_read_b64_tr_b16 v[172:173], v232 offset:3936
    ds_read_b64_tr_b16 v[174:175], v232 offset:4000
    ds_read_b64_tr_b16 v[176:177], v232 offset:4320
    ds_read_b64_tr_b16 v[178:179], v232 offset:4368
    ds_read_b64_tr_b16 v[180:181], v232 offset:4416
    ds_read_b64_tr_b16 v[182:183], v232 offset:4480
    ds_read_b64_tr_b16 v[184:185], v232 offset:7680
    ds_read_b64_tr_b16 v[186:187], v232 offset:7728
    ds_read_b64_tr_b16 v[188:189], v232 offset:7776
    ds_read_b64_tr_b16 v[190:191], v232 offset:7840
    ds_read_b64_tr_b16 v[192:193], v232 offset:8160
    ds_read_b64_tr_b16 v[194:195], v232 offset:8208
    ds_read_b64_tr_b16 v[196:197], v232 offset:8256
    ds_read_b64_tr_b16 v[198:199], v232 offset:8320
    ds_read_b64_tr_b16 v[200:201], v232 offset:11520
    ds_read_b64_tr_b16 v[202:203], v232 offset:11568
    ds_read_b64_tr_b16 v[204:205], v232 offset:11616
    ds_read_b64_tr_b16 v[206:207], v232 offset:11680
    v_lshrrev_b32 v70, 1, v0
    v_and_b32 v71, 1, v0
    v_lshlrev_b32 v72, 6, v70
    v_lshl_add_u32 v72, v71, 4, v72
    v_mul_u32_u24 v71, 37888, v71
    v_lshl_add_u32 v71, v70, 4, v71
    s_lshr_b32 s50, s39, 1
    s_lshl_b32 s50, s50, 14
    s_and_b32 s51, s39, 1
    s_lshl_b32 s51, s51, 5
    s_add_u32 s50, s50, s51
    s_add_u32 s50, s50, 0x900000
    s_add_u32 s51, s50, 8192
    s_mov_b32 s52, 0x4000
    s_mov_b32 s53, 0x5000
    s_mov_b32 s54, 0x6000
    s_mov_b32 s55, 0x7000
    s_waitcnt lgkmcnt(15)
    v_mfma_f32_32x32x16_f16 v[96:111], v[152:155], v[156:159], 0
    ds_read_b64_tr_b16 v[152:153], v232 offset:12000
    ds_read_b64_tr_b16 v[154:155], v232 offset:12048
    ds_read_b64_tr_b16 v[156:157], v232 offset:12096
    ds_read_b64_tr_b16 v[158:159], v232 offset:12160
    s_waitcnt lgkmcnt(15)
    v_mfma_f32_32x32x16_f16 v[96:111], v[160:163], v[164:167], v[96:111]
    s_waitcnt lgkmcnt(15)
    v_mfma_f32_32x32x16_f16 v[96:111], v[168:171], v[172:175], v[96:111]
    s_waitcnt lgkmcnt(15)
    v_mfma_f32_32x32x16_f16 v[96:111], v[176:179], v[180:183], v[96:111]
    s_waitcnt lgkmcnt(12)
    v_mfma_f32_32x32x16_f16 v[96:111], v[184:187], v[188:191], v[96:111]
    s_waitcnt lgkmcnt(8)
    v_mfma_f32_32x32x16_f16 v[96:111], v[192:195], v[196:199], v[96:111]
    s_waitcnt lgkmcnt(4)
    v_mfma_f32_32x32x16_f16 v[96:111], v[200:203], v[204:207], v[96:111]
    s_waitcnt lgkmcnt(0)
    v_mfma_f32_32x32x16_f16 v[96:111], v[152:155], v[156:159], v[96:111]
    ds_write_b128 v235, v[240:243] offset:0
    ds_write_b128 v235, v[244:247] offset:1024
    ds_write_b128 v235, v[248:251] offset:2048
    s_nop 8
    ds_write_b128 v235, v[96:99] offset:3072
    ds_write_b128 v235, v[100:103] offset:4096
    ds_write_b128 v235, v[104:107] offset:5120
    s_cmp_lg_u32 s38, 0
    s_cbranch_scc1 L_fx_ok
    s_waitcnt vmcnt(0)
    v_cmp_ne_u64 s[62:63], v[68:69], s[36:37]
    s_nop 0
    s_cmp_eq_u64 s[62:63], 0
    s_cbranch_scc1 L_fx_ok
    s_mov_b32 s61, 16384
L_fx:
    buffer_load_dwordx2 v[68:69], v30, s[24:27], s35 offen sc1
    s_waitcnt vmcnt(0)
    v_cmp_ne_u64 s[62:63], v[68:69], s[36:37]
    s_nop 0
    s_cmp_eq_u64 s[62:63], 0
    s_cbranch_scc1 L_fx_ok
    s_sleep 8
    s_sub_u32 s61, s61, 1
    s_cbranch_scc0 L_fx
L_fx_ok:
    s_waitcnt lgkmcnt(0)
    s_barrier
    buffer_load_dwordx4 v[40:43], v72, s[24:27], s50 offen sc1
    buffer_load_dwordx4 v[44:47], v72, s[24:27], s51 offen sc1
    buffer_load_dwordx4 v[52:55], v236, s[24:27], s52 offen sc1
    buffer_load_dwordx4 v[56:59], v236, s[24:27], s53 offen sc1
    buffer_load_dwordx4 v[60:63], v236, s[24:27], s54 offen sc1
    buffer_load_dwordx4 v[64:67], v236, s[24:27], s55 offen sc1
    ds_read_b128 v[80:83], v236 offset:9280
    ds_read_b128 v[84:87], v236 offset:24640
    ds_read_b128 v[88:91], v236 offset:40000
    ds_read_b128 v[92:95], v236 offset:55360
    ds_read_b128 v[96:99], v236 offset:12352
    ds_read_b128 v[100:103], v236 offset:27712
    ds_read_b128 v[104:107], v236 offset:43072
    ds_read_b128 v[108:111], v236 offset:58432
    s_waitcnt lgkmcnt(4)
    v_add_f32 v80, v80, v84
    v_add_f32 v81, v81, v85
    v_add_f32 v82, v82, v86
    v_add_f32 v83, v83, v87
    v_add_f32 v88, v88, v92
    v_add_f32 v89, v89, v93
    v_add_f32 v90, v90, v94
    v_add_f32 v91, v91, v95
    v_add_f32 v80, v80, v88
    v_add_f32 v81, v81, v89
    v_add_f32 v82, v82, v90
    v_add_f32 v83, v83, v91
    v_cvt_pk_f16_f32 v84, v80, v81
    v_cvt_pk_f16_f32 v85, v82, v83
    ds_write_b16 v228, v84 offset:0
    ds_write_b16_d16_hi v229, v84 offset:0
    ds_write_b16 v230, v85 offset:0
    ds_write_b16_d16_hi v231, v85 offset:0
    s_waitcnt lgkmcnt(4)
    v_add_f32 v96, v96, v100
    v_add_f32 v97, v97, v101
    v_add_f32 v98, v98, v102
    v_add_f32 v99, v99, v103
    v_add_f32 v104, v104, v108
    v_add_f32 v105, v105, v109
    v_add_f32 v106, v106, v110
    v_add_f32 v107, v107, v111
    v_add_f32 v96, v96, v104
    v_add_f32 v97, v97, v105
    v_add_f32 v98, v98, v106
    v_add_f32 v99, v99, v107
    v_cvt_pk_f16_f32 v100, v96, v97
    v_cvt_pk_f16_f32 v101, v98, v99
    ds_write_b16 v228, v100 offset:4640
    ds_write_b16_d16_hi v229, v100 offset:4640
    ds_write_b16 v230, v101 offset:4640
    ds_write_b16_d16_hi v231, v101 offset:4640
    s_waitcnt lgkmcnt(0)
    s_barrier
    ds_read_u16 v144, v212 offset:0
    ds_read_u16 v145, v213 offset:0
    ds_read_u16 v146, v214 offset:0
    ds_read_u16 v147, v215 offset:0
    ds_read_u16 v148, v216 offset:0
    ds_read_u16 v149, v217 offset:0
    ds_read_u16 v150, v218 offset:0
    ds_read_u16 v151, v219 offset:0
    ds_read_u16 v152, v220 offset:0
    ds_read_u16 v153, v221 offset:0
    ds_read_u16 v154, v222 offset:0
    ds_read_u16 v160, v212 offset:4640
    ds_read_u16 v161, v213 offset:4640
    ds_read_u16 v162, v214 offset:4640
    ds_read_u16 v163, v215 offset:4640
    ds_read_u16 v164, v216 offset:4640
    ds_read_u16 v165, v217 offset:4640
    ds_read_u16 v166, v218 offset:4640
    ds_read_u16 v167, v219 offset:4640
    ds_read_u16 v168, v220 offset:4640
    ds_read_u16 v169, v221 offset:4640
    ds_read_u16 v170, v222 offset:4640
    s_waitcnt lgkmcnt(11)
    v_lshl_or_b32 v80, v145, 16, v144
    v_lshl_or_b32 v81, v147, 16, v146
    v_lshl_or_b32 v82, v149, 16, v148
    v_lshl_or_b32 v83, v151, 16, v150
    v_lshl_or_b32 v84, v146, 16, v145
    v_lshl_or_b32 v85, v148, 16, v147
    v_lshl_or_b32 v86, v150, 16, v149
    v_lshl_or_b32 v87, v152, 16, v151
    v_lshl_or_b32 v88, v147, 16, v146
    v_lshl_or_b32 v89, v149, 16, v148
    v_lshl_or_b32 v90, v151, 16, v150
    v_lshl_or_b32 v91, v153, 16, v152
    v_lshl_or_b32 v92, v148, 16, v147
    v_lshl_or_b32 v93, v150, 16, v149
    v_lshl_or_b32 v94, v152, 16, v151
    v_lshl_or_b32 v95, v154, 16, v153
    s_waitcnt lgkmcnt(0)
    v_lshl_or_b32 v96, v161, 16, v160
    v_lshl_or_b32 v97, v163, 16, v162
    v_lshl_or_b32 v98, v165, 16, v164
    v_lshl_or_b32 v99, v167, 16, v166
    v_lshl_or_b32 v100, v162, 16, v161
    v_lshl_or_b32 v101, v164, 16, v163
    v_lshl_or_b32 v102, v166, 16, v165
    v_lshl_or_b32 v103, v168, 16, v167
    v_lshl_or_b32 v104, v163, 16, v162
    v_lshl_or_b32 v105, v165, 16, v164
    v_lshl_or_b32 v106, v167, 16, v166
    v_lshl_or_b32 v107, v169, 16, v168
    v_lshl_or_b32 v108, v164, 16, v163
    v_lshl_or_b32 v109, v166, 16, v165
    v_lshl_or_b32 v110, v168, 16, v167
    v_lshl_or_b32 v111, v170, 16, v169
    s_barrier
    v_lshlrev_b32 v4, 4, v0
    v_add_u32 v5, 37888, v4
    ds_write_b128 v4, v[80:83] offset:0
    ds_write_b128 v4, v[84:87] offset:4128
    ds_write_b128 v4, v[88:91] offset:8256
    ds_write_b128 v4, v[92:95] offset:12384
    ds_write_b128 v5, v[96:99] offset:0
    ds_write_b128 v5, v[100:103] offset:4128
    ds_write_b128 v5, v[104:107] offset:8256
    ds_write_b128 v5, v[108:111] offset:12384
    s_mul_i32 s33, s40, 37888
    v_mov_b32 v8, 0
    v_mov_b32 v9, 0
    v_mov_b32 v10, 0
    v_mov_b32 v11, 0
    v_lshrrev_b32 v7, 1, v1
    v_add_u32 v7, s33, v7
    ds_write_b64 v7, v[8:9] offset:33280
    v_mul_u32_u24 v7, 4128, v3
    v_and_b32 v5, 7, v0
    v_lshl_add_u32 v7, v5, 2, v7
    v_add_u32 v7, s33, v7
    ds_write_b32 v7, v8 offset:4096
    v_sub_u32 v5, 3, v2
    v_and_b32 v5, 3, v5
    v_mul_u32_u24 v5, 4128, v5
    v_lshrrev_b32 v6, 2, v2
    v_lshl_add_u32 v5, v3, 4, v5
    v_lshlrev_b32 v6, 3, v6
    v_sub_u32 v5, v5, v6
    s_lshl_b32 s44, s41, 8
    s_sub_u32 s44, s33, s44
    s_add_u32 s45, s44, 280
    v_add_u32 v5, s45, v5
    v_add_u32 v7, 2048, v5
    v_lshlrev_b32 v6, 5, v2
    v_lshl_add_u32 v6, v3, 4, v6
    s_add_u32 s45, s44, 33568
    v_add_u32 v6, s45, v6
    s_cmp_eq_u32 s40, 1
    s_cselect_b64 vcc, -1, 0
    v_cndmask_b32 v14, v76, v77, vcc
    v_lshlrev_b32 v13, 16, v37
    v_and_b32 v12, 0xffff0000, v37
    v_cndmask_b32 v13, v13, v12, vcc
    s_waitcnt vmcnt(0)
    v_lshlrev_b32 v144, 16, v40
    v_and_b32 v145, 0xffff0000, v40
    v_lshlrev_b32 v146, 16, v41
    v_and_b32 v147, 0xffff0000, v41
    v_lshlrev_b32 v148, 16, v42
    v_and_b32 v149, 0xffff0000, v42
    v_lshlrev_b32 v150, 16, v43
    v_and_b32 v151, 0xffff0000, v43
    v_add_f32_dpp v144, v53, v144 quad_perm:[0,0,2,2] row_mask:0xf bank_mask:0xf
    v_add_f32_dpp v145, v55, v145 quad_perm:[0,0,2,2] row_mask:0xf bank_mask:0xf
    v_add_f32_dpp v146, v57, v146 quad_perm:[0,0,2,2] row_mask:0xf bank_mask:0xf
    v_add_f32_dpp v147, v59, v147 quad_perm:[0,0,2,2] row_mask:0xf bank_mask:0xf
    v_add_f32_dpp v148, v61, v148 quad_perm:[0,0,2,2] row_mask:0xf bank_mask:0xf
    v_add_f32_dpp v149, v63, v149 quad_perm:[0,0,2,2] row_mask:0xf bank_mask:0xf
    v_add_f32_dpp v150, v65, v150 quad_perm:[0,0,2,2] row_mask:0xf bank_mask:0xf
    v_add_f32_dpp v151, v67, v151 quad_perm:[0,0,2,2] row_mask:0xf bank_mask:0xf
    v_cvt_pk_bf16_f32 v144, 0, v144
    v_cvt_pk_bf16_f32 v145, 0, v145
    v_cvt_pk_bf16_f32 v146, 0, v146
    v_cvt_pk_bf16_f32 v147, 0, v147
    v_cvt_pk_bf16_f32 v148, 0, v148
    v_cvt_pk_bf16_f32 v149, 0, v149
    v_cvt_pk_bf16_f32 v150, 0, v150
    v_cvt_pk_bf16_f32 v151, 0, v151
    v_mul_f32_dpp v144, v52, v144 quad_perm:[0,0,2,2] row_mask:0xf bank_mask:0xf
    v_mul_f32_dpp v145, v54, v145 quad_perm:[0,0,2,2] row_mask:0xf bank_mask:0xf
    v_mul_f32_dpp v146, v56, v146 quad_perm:[0,0,2,2] row_mask:0xf bank_mask:0xf
    v_mul_f32_dpp v147, v58, v147 quad_perm:[0,0,2,2] row_mask:0xf bank_mask:0xf
    v_mul_f32_dpp v148, v60, v148 quad_perm:[0,0,2,2] row_mask:0xf bank_mask:0xf
    v_mul_f32_dpp v149, v62, v149 quad_perm:[0,0,2,2] row_mask:0xf bank_mask:0xf
    v_mul_f32_dpp v150, v64, v150 quad_perm:[0,0,2,2] row_mask:0xf bank_mask:0xf
    v_mul_f32_dpp v151, v66, v151 quad_perm:[0,0,2,2] row_mask:0xf bank_mask:0xf
    v_cvt_pk_bf16_f32 v144, 0, v144
    v_cvt_pk_bf16_f32 v145, 0, v145
    v_cvt_pk_bf16_f32 v146, 0, v146
    v_cvt_pk_bf16_f32 v147, 0, v147
    v_cvt_pk_bf16_f32 v148, 0, v148
    v_cvt_pk_bf16_f32 v149, 0, v149
    v_cvt_pk_bf16_f32 v150, 0, v150
    v_cvt_pk_bf16_f32 v151, 0, v151
    v_cvt_pk_f16_f32 v40, v144, v145
    v_cvt_pk_f16_f32 v41, v146, v147
    v_cvt_pk_f16_f32 v42, v148, v149
    v_cvt_pk_f16_f32 v43, v150, v151
    ds_write_b128 v71, v[40:43] offset:33792
    v_lshlrev_b32 v152, 16, v44
    v_and_b32 v153, 0xffff0000, v44
    v_lshlrev_b32 v154, 16, v45
    v_and_b32 v155, 0xffff0000, v45
    v_lshlrev_b32 v156, 16, v46
    v_and_b32 v157, 0xffff0000, v46
    v_lshlrev_b32 v158, 16, v47
    v_and_b32 v159, 0xffff0000, v47
    v_add_f32_dpp v152, v53, v152 quad_perm:[1,1,3,3] row_mask:0xf bank_mask:0xf
    v_add_f32_dpp v153, v55, v153 quad_perm:[1,1,3,3] row_mask:0xf bank_mask:0xf
    v_add_f32_dpp v154, v57, v154 quad_perm:[1,1,3,3] row_mask:0xf bank_mask:0xf
    v_add_f32_dpp v155, v59, v155 quad_perm:[1,1,3,3] row_mask:0xf bank_mask:0xf
    v_add_f32_dpp v156, v61, v156 quad_perm:[1,1,3,3] row_mask:0xf bank_mask:0xf
    v_add_f32_dpp v157, v63, v157 quad_perm:[1,1,3,3] row_mask:0xf bank_mask:0xf
    v_add_f32_dpp v158, v65, v158 quad_perm:[1,1,3,3] row_mask:0xf bank_mask:0xf
    v_add_f32_dpp v159, v67, v159 quad_perm:[1,1,3,3] row_mask:0xf bank_mask:0xf
    v_cvt_pk_bf16_f32 v152, 0, v152
    v_cvt_pk_bf16_f32 v153, 0, v153
    v_cvt_pk_bf16_f32 v154, 0, v154
    v_cvt_pk_bf16_f32 v155, 0, v155
    v_cvt_pk_bf16_f32 v156, 0, v156
    v_cvt_pk_bf16_f32 v157, 0, v157
    v_cvt_pk_bf16_f32 v158, 0, v158
    v_cvt_pk_bf16_f32 v159, 0, v159
    v_mul_f32_dpp v152, v52, v152 quad_perm:[1,1,3,3] row_mask:0xf bank_mask:0xf
    v_mul_f32_dpp v153, v54, v153 quad_perm:[1,1,3,3] row_mask:0xf bank_mask:0xf
    v_mul_f32_dpp v154, v56, v154 quad_perm:[1,1,3,3] row_mask:0xf bank_mask:0xf
    v_mul_f32_dpp v155, v58, v155 quad_perm:[1,1,3,3] row_mask:0xf bank_mask:0xf
    v_mul_f32_dpp v156, v60, v156 quad_perm:[1,1,3,3] row_mask:0xf bank_mask:0xf
    v_mul_f32_dpp v157, v62, v157 quad_perm:[1,1,3,3] row_mask:0xf bank_mask:0xf
    v_mul_f32_dpp v158, v64, v158 quad_perm:[1,1,3,3] row_mask:0xf bank_mask:0xf
    v_mul_f32_dpp v159, v66, v159 quad_perm:[1,1,3,3] row_mask:0xf bank_mask:0xf
    v_cvt_pk_bf16_f32 v152, 0, v152
    v_cvt_pk_bf16_f32 v153, 0, v153
    v_cvt_pk_bf16_f32 v154, 0, v154
    v_cvt_pk_bf16_f32 v155, 0, v155
    v_cvt_pk_bf16_f32 v156, 0, v156
    v_cvt_pk_bf16_f32 v157, 0, v157
    v_cvt_pk_bf16_f32 v158, 0, v158
    v_cvt_pk_bf16_f32 v159, 0, v159
    v_cvt_pk_f16_f32 v44, v152, v153
    v_cvt_pk_f16_f32 v45, v154, v155
    v_cvt_pk_f16_f32 v46, v156, v157
    v_cvt_pk_f16_f32 v47, v158, v159
    ds_write_b128 v71, v[44:47] offset:35840
    s_waitcnt lgkmcnt(0)
    s_barrier
    s_setprio 1
    ds_read2_b64 v[80:83], v7 offset0:216 offset1:217
    ds_read_b128 v[112:115], v6 offset:192
    ds_read2_b64 v[84:87], v7 offset0:152 offset1:153
    ds_read_b128 v[116:119], v6 offset:704
    ds_read2_b64 v[88:91], v7 offset0:88 offset1:89
    ds_read_b128 v[120:123], v6 offset:1216
    ds_read2_b64 v[92:95], v7 offset0:24 offset1:25
    ds_read_b128 v[124:127], v6 offset:1728
    ds_read2_b64 v[96:99], v5 offset0:216 offset1:217
    ds_read_b128 v[128:131], v6 offset:2240
    ds_read2_b64 v[100:103], v5 offset0:152 offset1:153
    ds_read_b128 v[132:135], v6 offset:2752
    s_waitcnt lgkmcnt(10)
    ds_read2_b64 v[104:107], v5 offset0:88 offset1:89
    ds_read_b128 v[136:139], v6 offset:3264
    v_mfma_f32_16x16x32_f16 v[208:211], v[80:83], v[112:115], 0
    s_waitcnt lgkmcnt(10)
    ds_read2_b64 v[108:111], v5 offset0:24 offset1:25
    ds_read_b128 v[140:143], v6 offset:3776
    v_mfma_f32_16x16x32_f16 v[212:215], v[84:87], v[112:115], 0
    v_mfma_f32_16x16x32_f16 v[216:219], v[84:87], v[116:119], 0
    v_mfma_f32_16x16x32_f16 v[212:215], v[80:83], v[116:119], v[212:215]
    s_waitcnt lgkmcnt(10)
    ds_read2_b64 v[144:147], v7 offset0:208 offset1:209
    ds_read_b128 v[176:179], v6 offset:128
    v_mfma_f32_16x16x32_f16 v[216:219], v[88:91], v[112:115], v[216:219]
    v_mfma_f32_16x16x32_f16 v[220:223], v[88:91], v[116:119], 0
    v_mfma_f32_16x16x32_f16 v[224:227], v[88:91], v[120:123], 0
    v_mfma_f32_16x16x32_f16 v[216:219], v[80:83], v[120:123], v[216:219]
    v_mfma_f32_16x16x32_f16 v[220:223], v[84:87], v[120:123], v[220:223]
    s_waitcnt lgkmcnt(10)
    ds_read2_b64 v[148:151], v7 offset0:144 offset1:145
    ds_read_b128 v[180:183], v6 offset:640
    v_mfma_f32_16x16x32_f16 v[220:223], v[92:95], v[112:115], v[220:223]
    v_mfma_f32_16x16x32_f16 v[224:227], v[92:95], v[116:119], v[224:227]
    v_mfma_f32_16x16x32_f16 v[228:231], v[92:95], v[120:123], 0
    v_mfma_f32_16x16x32_f16 v[232:235], v[92:95], v[124:127], 0
    v_mfma_f32_16x16x32_f16 v[220:223], v[80:83], v[124:127], v[220:223]
    v_mfma_f32_16x16x32_f16 v[224:227], v[84:87], v[124:127], v[224:227]
    v_mfma_f32_16x16x32_f16 v[228:231], v[88:91], v[124:127], v[228:231]
    s_waitcnt lgkmcnt(10)
    ds_read2_b64 v[152:155], v7 offset0:80 offset1:81
    ds_read_b128 v[184:187], v6 offset:1152
    v_mfma_f32_16x16x32_f16 v[224:227], v[96:99], v[112:115], v[224:227]
    v_mfma_f32_16x16x32_f16 v[228:231], v[96:99], v[116:119], v[228:231]
    v_mfma_f32_16x16x32_f16 v[232:235], v[96:99], v[120:123], v[232:235]
    v_mfma_f32_16x16x32_f16 v[236:239], v[96:99], v[124:127], 0
    v_mfma_f32_16x16x32_f16 v[224:227], v[80:83], v[128:131], v[224:227]
    v_mfma_f32_16x16x32_f16 v[228:231], v[84:87], v[128:131], v[228:231]
    v_mfma_f32_16x16x32_f16 v[232:235], v[88:91], v[128:131], v[232:235]
    v_mfma_f32_16x16x32_f16 v[236:239], v[92:95], v[128:131], v[236:239]
    s_waitcnt lgkmcnt(10)
    ds_read2_b64 v[156:159], v7 offset0:16 offset1:17
    ds_read_b128 v[188:191], v6 offset:1664
    v_mfma_f32_16x16x32_f16 v[228:231], v[100:103], v[112:115], v[228:231]
    v_mfma_f32_16x16x32_f16 v[232:235], v[100:103], v[116:119], v[232:235]
    v_mfma_f32_16x16x32_f16 v[236:239], v[100:103], v[120:123], v[236:239]
    v_mfma_f32_16x16x32_f16 v[228:231], v[80:83], v[132:135], v[228:231]
    v_mfma_f32_16x16x32_f16 v[232:235], v[84:87], v[132:135], v[232:235]
    v_mfma_f32_16x16x32_f16 v[236:239], v[88:91], v[132:135], v[236:239]
    s_waitcnt lgkmcnt(10)
    ds_read2_b64 v[160:163], v5 offset0:208 offset1:209
    ds_read_b128 v[192:195], v6 offset:2176
    v_mfma_f32_16x16x32_f16 v[232:235], v[104:107], v[112:115], v[232:235]
    v_mfma_f32_16x16x32_f16 v[236:239], v[104:107], v[116:119], v[236:239]
    v_mfma_f32_16x16x32_f16 v[232:235], v[80:83], v[136:139], v[232:235]
    v_mfma_f32_16x16x32_f16 v[236:239], v[84:87], v[136:139], v[236:239]
    s_waitcnt lgkmcnt(10)
    ds_read2_b64 v[164:167], v5 offset0:144 offset1:145
    ds_read_b128 v[196:199], v6 offset:2688
    v_mfma_f32_16x16x32_f16 v[236:239], v[108:111], v[112:115], v[236:239]
    v_mfma_f32_16x16x32_f16 v[236:239], v[80:83], v[140:143], v[236:239]
    s_waitcnt lgkmcnt(10)
    ds_read2_b64 v[168:171], v5 offset0:80 offset1:81
    ds_read_b128 v[200:203], v6 offset:3200
    v_mfma_f32_16x16x32_f16 v[208:211], v[144:147], v[176:179], v[208:211]
    s_waitcnt lgkmcnt(10)
    ds_read2_b64 v[172:175], v5 offset0:16 offset1:17
    ds_read_b128 v[204:207], v6 offset:3712
    v_mfma_f32_16x16x32_f16 v[212:215], v[148:151], v[176:179], v[212:215]
    v_mfma_f32_16x16x32_f16 v[216:219], v[148:151], v[180:183], v[216:219]
    v_mfma_f32_16x16x32_f16 v[212:215], v[144:147], v[180:183], v[212:215]
    s_waitcnt lgkmcnt(10)
    ds_read2_b64 v[80:83], v7 offset0:200 offset1:201
    ds_read_b128 v[112:115], v6 offset:64
    v_mfma_f32_16x16x32_f16 v[216:219], v[152:155], v[176:179], v[216:219]
    v_mfma_f32_16x16x32_f16 v[220:223], v[152:155], v[180:183], v[220:223]
    v_mfma_f32_16x16x32_f16 v[224:227], v[152:155], v[184:187], v[224:227]
    v_mfma_f32_16x16x32_f16 v[216:219], v[144:147], v[184:187], v[216:219]
    v_mfma_f32_16x16x32_f16 v[220:223], v[148:151], v[184:187], v[220:223]
    s_waitcnt lgkmcnt(10)
    ds_read2_b64 v[84:87], v7 offset0:136 offset1:137
    ds_read_b128 v[116:119], v6 offset:576
    v_mfma_f32_16x16x32_f16 v[220:223], v[156:159], v[176:179], v[220:223]
    v_mfma_f32_16x16x32_f16 v[224:227], v[156:159], v[180:183], v[224:227]
    v_mfma_f32_16x16x32_f16 v[228:231], v[156:159], v[184:187], v[228:231]
    v_mfma_f32_16x16x32_f16 v[232:235], v[156:159], v[188:191], v[232:235]
    v_mfma_f32_16x16x32_f16 v[220:223], v[144:147], v[188:191], v[220:223]
    v_mfma_f32_16x16x32_f16 v[224:227], v[148:151], v[188:191], v[224:227]
    v_mfma_f32_16x16x32_f16 v[228:231], v[152:155], v[188:191], v[228:231]
    s_waitcnt lgkmcnt(10)
    ds_read2_b64 v[88:91], v7 offset0:72 offset1:73
    ds_read_b128 v[120:123], v6 offset:1088
    v_mfma_f32_16x16x32_f16 v[224:227], v[160:163], v[176:179], v[224:227]
    v_mfma_f32_16x16x32_f16 v[228:231], v[160:163], v[180:183], v[228:231]
    v_mfma_f32_16x16x32_f16 v[232:235], v[160:163], v[184:187], v[232:235]
    v_mfma_f32_16x16x32_f16 v[236:239], v[160:163], v[188:191], v[236:239]
    v_mfma_f32_16x16x32_f16 v[224:227], v[144:147], v[192:195], v[224:227]
    v_mfma_f32_16x16x32_f16 v[228:231], v[148:151], v[192:195], v[228:231]
    v_mfma_f32_16x16x32_f16 v[232:235], v[152:155], v[192:195], v[232:235]
    v_mfma_f32_16x16x32_f16 v[236:239], v[156:159], v[192:195], v[236:239]
    s_waitcnt lgkmcnt(10)
    ds_read2_b64 v[92:95], v7 offset0:8 offset1:9
    ds_read_b128 v[124:127], v6 offset:1600
    v_mfma_f32_16x16x32_f16 v[228:231], v[164:167], v[176:179], v[228:231]
    v_mfma_f32_16x16x32_f16 v[232:235], v[164:167], v[180:183], v[232:235]
    v_mfma_f32_16x16x32_f16 v[236:239], v[164:167], v[184:187], v[236:239]
    v_mfma_f32_16x16x32_f16 v[228:231], v[144:147], v[196:199], v[228:231]
    v_mfma_f32_16x16x32_f16 v[232:235], v[148:151], v[196:199], v[232:235]
    v_mfma_f32_16x16x32_f16 v[236:239], v[152:155], v[196:199], v[236:239]
    s_waitcnt lgkmcnt(10)
    ds_read2_b64 v[96:99], v5 offset0:200 offset1:201
    ds_read_b128 v[128:131], v6 offset:2112
    v_mfma_f32_16x16x32_f16 v[232:235], v[168:171], v[176:179], v[232:235]
    v_mfma_f32_16x16x32_f16 v[236:239], v[168:171], v[180:183], v[236:239]
    v_mfma_f32_16x16x32_f16 v[232:235], v[144:147], v[200:203], v[232:235]
    v_mfma_f32_16x16x32_f16 v[236:239], v[148:151], v[200:203], v[236:239]
    s_waitcnt lgkmcnt(10)
    ds_read2_b64 v[100:103], v5 offset0:136 offset1:137
    ds_read_b128 v[132:135], v6 offset:2624
    v_mfma_f32_16x16x32_f16 v[236:239], v[172:175], v[176:179], v[236:239]
    v_mfma_f32_16x16x32_f16 v[236:239], v[144:147], v[204:207], v[236:239]
    s_waitcnt lgkmcnt(10)
    ds_read2_b64 v[104:107], v5 offset0:72 offset1:73
    ds_read_b128 v[136:139], v6 offset:3136
    v_mfma_f32_16x16x32_f16 v[208:211], v[80:83], v[112:115], v[208:211]
    s_waitcnt lgkmcnt(10)
    ds_read2_b64 v[108:111], v5 offset0:8 offset1:9
    ds_read_b128 v[140:143], v6 offset:3648
    v_mfma_f32_16x16x32_f16 v[212:215], v[84:87], v[112:115], v[212:215]
    v_mfma_f32_16x16x32_f16 v[216:219], v[84:87], v[116:119], v[216:219]
    v_mfma_f32_16x16x32_f16 v[212:215], v[80:83], v[116:119], v[212:215]
    s_waitcnt lgkmcnt(10)
    ds_read2_b64 v[144:147], v7 offset0:192 offset1:193
    ds_read_b128 v[176:179], v6 offset:0
    v_mfma_f32_16x16x32_f16 v[216:219], v[88:91], v[112:115], v[216:219]
    v_mfma_f32_16x16x32_f16 v[220:223], v[88:91], v[116:119], v[220:223]
    v_mfma_f32_16x16x32_f16 v[224:227], v[88:91], v[120:123], v[224:227]
    v_mfma_f32_16x16x32_f16 v[216:219], v[80:83], v[120:123], v[216:219]
    v_mfma_f32_16x16x32_f16 v[220:223], v[84:87], v[120:123], v[220:223]
    s_waitcnt lgkmcnt(10)
    ds_read2_b64 v[148:151], v7 offset0:128 offset1:129
    ds_read_b128 v[180:183], v6 offset:512
    v_mfma_f32_16x16x32_f16 v[220:223], v[92:95], v[112:115], v[220:223]
    v_mfma_f32_16x16x32_f16 v[224:227], v[92:95], v[116:119], v[224:227]
    v_mfma_f32_16x16x32_f16 v[228:231], v[92:95], v[120:123], v[228:231]
    v_mfma_f32_16x16x32_f16 v[232:235], v[92:95], v[124:127], v[232:235]
    v_mfma_f32_16x16x32_f16 v[220:223], v[80:83], v[124:127], v[220:223]
    v_mfma_f32_16x16x32_f16 v[224:227], v[84:87], v[124:127], v[224:227]
    v_mfma_f32_16x16x32_f16 v[228:231], v[88:91], v[124:127], v[228:231]
    s_waitcnt lgkmcnt(10)
    ds_read2_b64 v[152:155], v7 offset0:64 offset1:65
    ds_read_b128 v[184:187], v6 offset:1024
    v_mfma_f32_16x16x32_f16 v[224:227], v[96:99], v[112:115], v[224:227]
    v_mfma_f32_16x16x32_f16 v[228:231], v[96:99], v[116:119], v[228:231]
    v_mfma_f32_16x16x32_f16 v[232:235], v[96:99], v[120:123], v[232:235]
    v_mfma_f32_16x16x32_f16 v[236:239], v[96:99], v[124:127], v[236:239]
    v_mfma_f32_16x16x32_f16 v[224:227], v[80:83], v[128:131], v[224:227]
    v_mfma_f32_16x16x32_f16 v[228:231], v[84:87], v[128:131], v[228:231]
    v_mfma_f32_16x16x32_f16 v[232:235], v[88:91], v[128:131], v[232:235]
    v_mfma_f32_16x16x32_f16 v[236:239], v[92:95], v[128:131], v[236:239]
    s_waitcnt lgkmcnt(10)
    ds_read2_b64 v[156:159], v7 offset0:0 offset1:1
    ds_read_b128 v[188:191], v6 offset:1536
    v_mfma_f32_16x16x32_f16 v[228:231], v[100:103], v[112:115], v[228:231]
    v_mfma_f32_16x16x32_f16 v[232:235], v[100:103], v[116:119], v[232:235]
    v_mfma_f32_16x16x32_f16 v[236:239], v[100:103], v[120:123], v[236:239]
    v_mfma_f32_16x16x32_f16 v[228:231], v[80:83], v[132:135], v[228:231]
    v_mfma_f32_16x16x32_f16 v[232:235], v[84:87], v[132:135], v[232:235]
    v_mfma_f32_16x16x32_f16 v[236:239], v[88:91], v[132:135], v[236:239]
    s_waitcnt lgkmcnt(10)
    ds_read2_b64 v[160:163], v5 offset0:192 offset1:193
    ds_read_b128 v[192:195], v6 offset:2048
    v_mfma_f32_16x16x32_f16 v[232:235], v[104:107], v[112:115], v[232:235]
    v_mfma_f32_16x16x32_f16 v[236:239], v[104:107], v[116:119], v[236:239]
    v_mfma_f32_16x16x32_f16 v[232:235], v[80:83], v[136:139], v[232:235]
    v_mfma_f32_16x16x32_f16 v[236:239], v[84:87], v[136:139], v[236:239]
    s_waitcnt lgkmcnt(10)
    ds_read2_b64 v[164:167], v5 offset0:128 offset1:129
    ds_read_b128 v[196:199], v6 offset:2560
    v_mfma_f32_16x16x32_f16 v[236:239], v[108:111], v[112:115], v[236:239]
    v_mfma_f32_16x16x32_f16 v[236:239], v[80:83], v[140:143], v[236:239]
    s_waitcnt lgkmcnt(10)
    ds_read2_b64 v[168:171], v5 offset0:64 offset1:65
    ds_read_b128 v[200:203], v6 offset:3072
    v_mfma_f32_16x16x32_f16 v[208:211], v[144:147], v[176:179], v[208:211]
    s_waitcnt lgkmcnt(10)
    ds_read2_b64 v[172:175], v5 offset0:0 offset1:1
    ds_read_b128 v[204:207], v6 offset:3584
    v_mfma_f32_16x16x32_f16 v[212:215], v[148:151], v[176:179], v[212:215]
    v_mfma_f32_16x16x32_f16 v[216:219], v[148:151], v[180:183], v[216:219]
    v_mfma_f32_16x16x32_f16 v[212:215], v[144:147], v[180:183], v[212:215]
    s_waitcnt lgkmcnt(10)
    v_mfma_f32_16x16x32_f16 v[216:219], v[152:155], v[176:179], v[216:219]
    v_mfma_f32_16x16x32_f16 v[220:223], v[152:155], v[180:183], v[220:223]
    v_mfma_f32_16x16x32_f16 v[224:227], v[152:155], v[184:187], v[224:227]
    v_mfma_f32_16x16x32_f16 v[216:219], v[144:147], v[184:187], v[216:219]
    v_mfma_f32_16x16x32_f16 v[220:223], v[148:151], v[184:187], v[220:223]
    s_waitcnt lgkmcnt(8)
    v_mfma_f32_16x16x32_f16 v[220:223], v[156:159], v[176:179], v[220:223]
    v_mfma_f32_16x16x32_f16 v[224:227], v[156:159], v[180:183], v[224:227]
    v_mfma_f32_16x16x32_f16 v[228:231], v[156:159], v[184:187], v[228:231]
    v_mfma_f32_16x16x32_f16 v[232:235], v[156:159], v[188:191], v[232:235]
    v_mfma_f32_16x16x32_f16 v[220:223], v[144:147], v[188:191], v[220:223]
    v_mfma_f32_16x16x32_f16 v[224:227], v[148:151], v[188:191], v[224:227]
    v_mfma_f32_16x16x32_f16 v[228:231], v[152:155], v[188:191], v[228:231]
    s_waitcnt lgkmcnt(6)
    v_mfma_f32_16x16x32_f16 v[224:227], v[160:163], v[176:179], v[224:227]
    v_mfma_f32_16x16x32_f16 v[228:231], v[160:163], v[180:183], v[228:231]
    v_mfma_f32_16x16x32_f16 v[232:235], v[160:163], v[184:187], v[232:235]
    v_mfma_f32_16x16x32_f16 v[236:239], v[160:163], v[188:191], v[236:239]
    v_mfma_f32_16x16x32_f16 v[224:227], v[144:147], v[192:195], v[224:227]
    v_mfma_f32_16x16x32_f16 v[228:231], v[148:151], v[192:195], v[228:231]
    v_mfma_f32_16x16x32_f16 v[232:235], v[152:155], v[192:195], v[232:235]
    v_mfma_f32_16x16x32_f16 v[236:239], v[156:159], v[192:195], v[236:239]
    s_waitcnt lgkmcnt(4)
    v_mfma_f32_16x16x32_f16 v[228:231], v[164:167], v[176:179], v[228:231]
    v_mfma_f32_16x16x32_f16 v[232:235], v[164:167], v[180:183], v[232:235]
    v_mfma_f32_16x16x32_f16 v[236:239], v[164:167], v[184:187], v[236:239]
    v_mfma_f32_16x16x32_f16 v[228:231], v[144:147], v[196:199], v[228:231]
    v_mfma_f32_16x16x32_f16 v[232:235], v[148:151], v[196:199], v[232:235]
    v_mfma_f32_16x16x32_f16 v[236:239], v[152:155], v[196:199], v[236:239]
    s_waitcnt lgkmcnt(2)
    v_mfma_f32_16x16x32_f16 v[232:235], v[168:171], v[176:179], v[232:235]
    v_mfma_f32_16x16x32_f16 v[236:239], v[168:171], v[180:183], v[236:239]
    v_mfma_f32_16x16x32_f16 v[232:235], v[144:147], v[200:203], v[232:235]
    v_mfma_f32_16x16x32_f16 v[236:239], v[148:151], v[200:203], v[236:239]
    s_waitcnt lgkmcnt(0)
    v_mfma_f32_16x16x32_f16 v[236:239], v[172:175], v[176:179], v[236:239]
    v_mfma_f32_16x16x32_f16 v[236:239], v[144:147], v[204:207], v[236:239]
    s_lshl_b32 s44, s41, 13
    s_add_u32 s44, s44, s33
    v_add_u32 v4, s44, v1
    s_cmp_eq_u32 s41, 1
    s_cbranch_scc1 L_xw1
    ds_write_b128 v4, v[224:227] offset:16640
    ds_write_b128 v4, v[228:231] offset:17664
    ds_write_b128 v4, v[232:235] offset:18688
    ds_write_b128 v4, v[236:239] offset:19712
    s_branch L_xw2
L_xw1:
    ds_write_b128 v4, v[208:211] offset:12544
    ds_write_b128 v4, v[212:215] offset:13568
    ds_write_b128 v4, v[216:219] offset:14592
    ds_write_b128 v4, v[220:223] offset:15616
L_xw2:
    s_lshl_b32 s44, s41, 12
    s_add_u32 s44, s44, s33
    v_add_u32 v4, s44, v1
    v_lshlrev_b32 v5, 5, v2
    v_lshl_add_u32 v5, v3, 3, v5
    s_lshl_b32 s45, s41, 11
    s_add_u32 s46, s45, s33
    v_add_u32 v6, s46, v5
    v_lshrrev_b32 v5, 1, v2
    v_lshlrev_b32 v5, 1, v5
    v_and_b32 v7, 1, v3
    v_add_u32 v5, v5, v7
    v_and_b32 v7, 1, v2
    v_lshl_add_u32 v5, v5, 1, v7
    v_lshrrev_b32 v7, 1, v3
    v_lshl_add_u32 v5, v5, 1, v7
    v_lshlrev_b32 v5, 3, v5
    s_lshl_b32 s46, s39, 1
    s_add_u32 s46, s46, s40
    s_mul_i32 s46, s46, 4096
    s_add_u32 s46, s46, s45
    s_add_u32 s46, s46, 0xb00000
    s_waitcnt lgkmcnt(0)
    s_barrier
    s_cmp_eq_u32 s41, 1
    s_cbranch_scc1 L_fin1
    ds_read_b128 v[80:83], v4 offset:20736
    ds_read_b64 v[88:89], v6 offset:33792
    ds_read_b128 v[92:95], v4 offset:21760
    ds_read_b64 v[100:101], v6 offset:34304
    ds_read_b128 v[104:107], v4 offset:22784
    ds_read_b64 v[112:113], v6 offset:34816
    ds_read_b128 v[116:119], v4 offset:23808
    ds_read_b64 v[124:125], v6 offset:35328
    s_waitcnt lgkmcnt(6)
    v_add_f32 v80, v80, v208
    v_add_f32 v81, v81, v209
    v_add_f32 v82, v82, v210
    v_add_f32 v83, v83, v211
    v_mul_f32 v80, v80, v14
    v_mul_f32 v81, v81, v14
    v_mul_f32 v82, v82, v14
    v_mul_f32 v83, v83, v14
    v_fma_mix_f32 v84, v88, v13, 0 op_sel:[0,0,0] op_sel_hi:[1,0,0]
    v_fma_mix_f32 v85, v88, v13, 0 op_sel:[1,0,0] op_sel_hi:[1,0,0]
    v_fma_mix_f32 v86, v89, v13, 0 op_sel:[0,0,0] op_sel_hi:[1,0,0]
    v_fma_mix_f32 v87, v89, v13, 0 op_sel:[1,0,0] op_sel_hi:[1,0,0]
    v_cvt_pk_bf16_f32 v80, 0, v80
    v_cvt_pk_bf16_f32 v81, 0, v81
    v_cvt_pk_bf16_f32 v82, 0, v82
    v_cvt_pk_bf16_f32 v83, 0, v83
    v_cvt_pk_bf16_f32 v84, 0, v84
    v_cvt_pk_bf16_f32 v85, 0, v85
    v_cvt_pk_bf16_f32 v86, 0, v86
    v_cvt_pk_bf16_f32 v87, 0, v87
    v_add_f32 v80, v80, v84
    v_add_f32 v81, v81, v85
    v_add_f32 v82, v82, v86
    v_add_f32 v83, v83, v87
    v_cvt_pk_bf16_f32 v88, v80, v81
    v_cvt_pk_bf16_f32 v89, v82, v83
    buffer_store_dwordx2 v[88:89], v5, s[24:27], s46 offen offset:0 sc1
    s_waitcnt lgkmcnt(4)
    v_add_f32 v92, v92, v212
    v_add_f32 v93, v93, v213
    v_add_f32 v94, v94, v214
    v_add_f32 v95, v95, v215
    v_mul_f32 v92, v92, v14
    v_mul_f32 v93, v93, v14
    v_mul_f32 v94, v94, v14
    v_mul_f32 v95, v95, v14
    v_fma_mix_f32 v96, v100, v13, 0 op_sel:[0,0,0] op_sel_hi:[1,0,0]
    v_fma_mix_f32 v97, v100, v13, 0 op_sel:[1,0,0] op_sel_hi:[1,0,0]
    v_fma_mix_f32 v98, v101, v13, 0 op_sel:[0,0,0] op_sel_hi:[1,0,0]
    v_fma_mix_f32 v99, v101, v13, 0 op_sel:[1,0,0] op_sel_hi:[1,0,0]
    v_cvt_pk_bf16_f32 v92, 0, v92
    v_cvt_pk_bf16_f32 v93, 0, v93
    v_cvt_pk_bf16_f32 v94, 0, v94
    v_cvt_pk_bf16_f32 v95, 0, v95
    v_cvt_pk_bf16_f32 v96, 0, v96
    v_cvt_pk_bf16_f32 v97, 0, v97
    v_cvt_pk_bf16_f32 v98, 0, v98
    v_cvt_pk_bf16_f32 v99, 0, v99
    v_add_f32 v92, v92, v96
    v_add_f32 v93, v93, v97
    v_add_f32 v94, v94, v98
    v_add_f32 v95, v95, v99
    v_cvt_pk_bf16_f32 v100, v92, v93
    v_cvt_pk_bf16_f32 v101, v94, v95
    buffer_store_dwordx2 v[100:101], v5, s[24:27], s46 offen offset:512 sc1
    s_waitcnt lgkmcnt(2)
    v_add_f32 v104, v104, v216
    v_add_f32 v105, v105, v217
    v_add_f32 v106, v106, v218
    v_add_f32 v107, v107, v219
    v_mul_f32 v104, v104, v14
    v_mul_f32 v105, v105, v14
    v_mul_f32 v106, v106, v14
    v_mul_f32 v107, v107, v14
    v_fma_mix_f32 v108, v112, v13, 0 op_sel:[0,0,0] op_sel_hi:[1,0,0]
    v_fma_mix_f32 v109, v112, v13, 0 op_sel:[1,0,0] op_sel_hi:[1,0,0]
    v_fma_mix_f32 v110, v113, v13, 0 op_sel:[0,0,0] op_sel_hi:[1,0,0]
    v_fma_mix_f32 v111, v113, v13, 0 op_sel:[1,0,0] op_sel_hi:[1,0,0]
    v_cvt_pk_bf16_f32 v104, 0, v104
    v_cvt_pk_bf16_f32 v105, 0, v105
    v_cvt_pk_bf16_f32 v106, 0, v106
    v_cvt_pk_bf16_f32 v107, 0, v107
    v_cvt_pk_bf16_f32 v108, 0, v108
    v_cvt_pk_bf16_f32 v109, 0, v109
    v_cvt_pk_bf16_f32 v110, 0, v110
    v_cvt_pk_bf16_f32 v111, 0, v111
    v_add_f32 v104, v104, v108
    v_add_f32 v105, v105, v109
    v_add_f32 v106, v106, v110
    v_add_f32 v107, v107, v111
    v_cvt_pk_bf16_f32 v112, v104, v105
    v_cvt_pk_bf16_f32 v113, v106, v107
    buffer_store_dwordx2 v[112:113], v5, s[24:27], s46 offen offset:1024 sc1
    s_waitcnt lgkmcnt(0)
    v_add_f32 v116, v116, v220
    v_add_f32 v117, v117, v221
    v_add_f32 v118, v118, v222
    v_add_f32 v119, v119, v223
    v_mul_f32 v116, v116, v14
    v_mul_f32 v117, v117, v14
    v_mul_f32 v118, v118, v14
    v_mul_f32 v119, v119, v14
    v_fma_mix_f32 v120, v124, v13, 0 op_sel:[0,0,0] op_sel_hi:[1,0,0]
    v_fma_mix_f32 v121, v124, v13, 0 op_sel:[1,0,0] op_sel_hi:[1,0,0]
    v_fma_mix_f32 v122, v125, v13, 0 op_sel:[0,0,0] op_sel_hi:[1,0,0]
    v_fma_mix_f32 v123, v125, v13, 0 op_sel:[1,0,0] op_sel_hi:[1,0,0]
    v_cvt_pk_bf16_f32 v116, 0, v116
    v_cvt_pk_bf16_f32 v117, 0, v117
    v_cvt_pk_bf16_f32 v118, 0, v118
    v_cvt_pk_bf16_f32 v119, 0, v119
    v_cvt_pk_bf16_f32 v120, 0, v120
    v_cvt_pk_bf16_f32 v121, 0, v121
    v_cvt_pk_bf16_f32 v122, 0, v122
    v_cvt_pk_bf16_f32 v123, 0, v123
    v_add_f32 v116, v116, v120
    v_add_f32 v117, v117, v121
    v_add_f32 v118, v118, v122
    v_add_f32 v119, v119, v123
    v_cvt_pk_bf16_f32 v124, v116, v117
    v_cvt_pk_bf16_f32 v125, v118, v119
    buffer_store_dwordx2 v[124:125], v5, s[24:27], s46 offen offset:1536 sc1
    s_branch L_fin2
L_fin1:
    ds_read_b128 v[80:83], v4 offset:12544
    ds_read_b64 v[88:89], v6 offset:33792
    ds_read_b128 v[92:95], v4 offset:13568
    ds_read_b64 v[100:101], v6 offset:34304
    ds_read_b128 v[104:107], v4 offset:14592
    ds_read_b64 v[112:113], v6 offset:34816
    ds_read_b128 v[116:119], v4 offset:15616
    ds_read_b64 v[124:125], v6 offset:35328
    s_waitcnt lgkmcnt(6)
    v_add_f32 v80, v80, v224
    v_add_f32 v81, v81, v225
    v_add_f32 v82, v82, v226
    v_add_f32 v83, v83, v227
    v_mul_f32 v80, v80, v14
    v_mul_f32 v81, v81, v14
    v_mul_f32 v82, v82, v14
    v_mul_f32 v83, v83, v14
    v_fma_mix_f32 v84, v88, v13, 0 op_sel:[0,0,0] op_sel_hi:[1,0,0]
    v_fma_mix_f32 v85, v88, v13, 0 op_sel:[1,0,0] op_sel_hi:[1,0,0]
    v_fma_mix_f32 v86, v89, v13, 0 op_sel:[0,0,0] op_sel_hi:[1,0,0]
    v_fma_mix_f32 v87, v89, v13, 0 op_sel:[1,0,0] op_sel_hi:[1,0,0]
    v_cvt_pk_bf16_f32 v80, 0, v80
    v_cvt_pk_bf16_f32 v81, 0, v81
    v_cvt_pk_bf16_f32 v82, 0, v82
    v_cvt_pk_bf16_f32 v83, 0, v83
    v_cvt_pk_bf16_f32 v84, 0, v84
    v_cvt_pk_bf16_f32 v85, 0, v85
    v_cvt_pk_bf16_f32 v86, 0, v86
    v_cvt_pk_bf16_f32 v87, 0, v87
    v_add_f32 v80, v80, v84
    v_add_f32 v81, v81, v85
    v_add_f32 v82, v82, v86
    v_add_f32 v83, v83, v87
    v_cvt_pk_bf16_f32 v88, v80, v81
    v_cvt_pk_bf16_f32 v89, v82, v83
    buffer_store_dwordx2 v[88:89], v5, s[24:27], s46 offen offset:0 sc1
    s_waitcnt lgkmcnt(4)
    v_add_f32 v92, v92, v228
    v_add_f32 v93, v93, v229
    v_add_f32 v94, v94, v230
    v_add_f32 v95, v95, v231
    v_mul_f32 v92, v92, v14
    v_mul_f32 v93, v93, v14
    v_mul_f32 v94, v94, v14
    v_mul_f32 v95, v95, v14
    v_fma_mix_f32 v96, v100, v13, 0 op_sel:[0,0,0] op_sel_hi:[1,0,0]
    v_fma_mix_f32 v97, v100, v13, 0 op_sel:[1,0,0] op_sel_hi:[1,0,0]
    v_fma_mix_f32 v98, v101, v13, 0 op_sel:[0,0,0] op_sel_hi:[1,0,0]
    v_fma_mix_f32 v99, v101, v13, 0 op_sel:[1,0,0] op_sel_hi:[1,0,0]
    v_cvt_pk_bf16_f32 v92, 0, v92
    v_cvt_pk_bf16_f32 v93, 0, v93
    v_cvt_pk_bf16_f32 v94, 0, v94
    v_cvt_pk_bf16_f32 v95, 0, v95
    v_cvt_pk_bf16_f32 v96, 0, v96
    v_cvt_pk_bf16_f32 v97, 0, v97
    v_cvt_pk_bf16_f32 v98, 0, v98
    v_cvt_pk_bf16_f32 v99, 0, v99
    v_add_f32 v92, v92, v96
    v_add_f32 v93, v93, v97
    v_add_f32 v94, v94, v98
    v_add_f32 v95, v95, v99
    v_cvt_pk_bf16_f32 v100, v92, v93
    v_cvt_pk_bf16_f32 v101, v94, v95
    buffer_store_dwordx2 v[100:101], v5, s[24:27], s46 offen offset:512 sc1
    s_waitcnt lgkmcnt(2)
    v_add_f32 v104, v104, v232
    v_add_f32 v105, v105, v233
    v_add_f32 v106, v106, v234
    v_add_f32 v107, v107, v235
    v_mul_f32 v104, v104, v14
    v_mul_f32 v105, v105, v14
    v_mul_f32 v106, v106, v14
    v_mul_f32 v107, v107, v14
    v_fma_mix_f32 v108, v112, v13, 0 op_sel:[0,0,0] op_sel_hi:[1,0,0]
    v_fma_mix_f32 v109, v112, v13, 0 op_sel:[1,0,0] op_sel_hi:[1,0,0]
    v_fma_mix_f32 v110, v113, v13, 0 op_sel:[0,0,0] op_sel_hi:[1,0,0]
    v_fma_mix_f32 v111, v113, v13, 0 op_sel:[1,0,0] op_sel_hi:[1,0,0]
    v_cvt_pk_bf16_f32 v104, 0, v104
    v_cvt_pk_bf16_f32 v105, 0, v105
    v_cvt_pk_bf16_f32 v106, 0, v106
    v_cvt_pk_bf16_f32 v107, 0, v107
    v_cvt_pk_bf16_f32 v108, 0, v108
    v_cvt_pk_bf16_f32 v109, 0, v109
    v_cvt_pk_bf16_f32 v110, 0, v110
    v_cvt_pk_bf16_f32 v111, 0, v111
    v_add_f32 v104, v104, v108
    v_add_f32 v105, v105, v109
    v_add_f32 v106, v106, v110
    v_add_f32 v107, v107, v111
    v_cvt_pk_bf16_f32 v112, v104, v105
    v_cvt_pk_bf16_f32 v113, v106, v107
    buffer_store_dwordx2 v[112:113], v5, s[24:27], s46 offen offset:1024 sc1
    s_waitcnt lgkmcnt(0)
    v_add_f32 v116, v116, v236
    v_add_f32 v117, v117, v237
    v_add_f32 v118, v118, v238
    v_add_f32 v119, v119, v239
    v_mul_f32 v116, v116, v14
    v_mul_f32 v117, v117, v14
    v_mul_f32 v118, v118, v14
    v_mul_f32 v119, v119, v14
    v_fma_mix_f32 v120, v124, v13, 0 op_sel:[0,0,0] op_sel_hi:[1,0,0]
    v_fma_mix_f32 v121, v124, v13, 0 op_sel:[1,0,0] op_sel_hi:[1,0,0]
    v_fma_mix_f32 v122, v125, v13, 0 op_sel:[0,0,0] op_sel_hi:[1,0,0]
    v_fma_mix_f32 v123, v125, v13, 0 op_sel:[1,0,0] op_sel_hi:[1,0,0]
    v_cvt_pk_bf16_f32 v116, 0, v116
    v_cvt_pk_bf16_f32 v117, 0, v117
    v_cvt_pk_bf16_f32 v118, 0, v118
    v_cvt_pk_bf16_f32 v119, 0, v119
    v_cvt_pk_bf16_f32 v120, 0, v120
    v_cvt_pk_bf16_f32 v121, 0, v121
    v_cvt_pk_bf16_f32 v122, 0, v122
    v_cvt_pk_bf16_f32 v123, 0, v123
    v_add_f32 v116, v116, v120
    v_add_f32 v117, v117, v121
    v_add_f32 v118, v118, v122
    v_add_f32 v119, v119, v123
    v_cvt_pk_bf16_f32 v124, v116, v117
    v_cvt_pk_bf16_f32 v125, v118, v119
    buffer_store_dwordx2 v[124:125], v5, s[24:27], s46 offen offset:1536 sc1
L_fin2:
    s_waitcnt vmcnt(0)
    s_barrier
    s_cmp_lg_u32 s38, 0
    s_cbranch_scc1 L_s_nofs
    s_mov_b64 exec, 1
    buffer_store_dwordx2 v[78:79], v1, s[24:27], s59 offen sc1
    s_mov_b64 exec, -1
L_s_nofs:
    s_endpgm
L_end:
L_last:
    s_endpgm
.section .rodata,"a"
.p2align 6
.amdhsa_kernel recurrent_scan__ssm_conv_s4d__mixer_gmlp__prompt_kernel
  .amdhsa_next_free_vgpr 256
  .amdhsa_next_free_sgpr 102
  .amdhsa_accum_offset 256
  .amdhsa_group_segment_fixed_size 0
  .amdhsa_kernarg_size 120
  .amdhsa_user_sgpr_count 2
  .amdhsa_user_sgpr_kernarg_segment_ptr 1
  .amdhsa_system_sgpr_workgroup_id_x 1
.end_amdhsa_kernel
```
